```python
import torch

def _softmax(x, axis=-1):
    return torch.softmax(x, dim=axis)
def _gelu(x):
    return torch.nn.functional.gelu(x, approximate="tanh")
def _silu(x):
    return torch.nn.functional.silu(x)
def _sigmoid(x):
    return torch.sigmoid(x)
def _layernorm(x, axis=-1, eps=1e-5):
    m = x.mean(dim=axis, keepdim=True)
    v = x.var(dim=axis, keepdim=True, unbiased=False)
    return (x - m) / torch.sqrt(v + eps)
def _scatter_add(tgt, idx, src, axis=0):
    return tgt.clone().index_add_(axis, idx, src)
def _segment_sum(src, seg, n):
    out = torch.zeros((n,) + src.shape[1:], dtype=src.dtype)
    return out.index_add_(0, seg, src)
def _pad(x, pw):
    flat = tuple(v for pair in reversed(pw) for v in pair)
    return torch.nn.functional.pad(x, flat)

kernel_name = 'sequential_preLN__mha_block__mixer_token_mlp__prompt'

def setup_inputs():

    _w = (lambda a: (lambda t: t.to(torch.bfloat16) if t.is_floating_point() else t)(torch.as_tensor(a)))
    def _A_setup():
        B, S, D, H = 1, 2048, 448, 16
        return {
            "x": _w((lambda *s: torch.randn(*s, dtype=torch.bfloat16) * 0.05)(B, S, D)),
            "wqkv": _w((lambda *s: torch.randn(*s, dtype=torch.bfloat16) * 0.05)(D, 3 * D)),
            "wo": _w((lambda *s: torch.randn(*s, dtype=torch.bfloat16) * 0.05)(D, D)),
        }
    _A_in = _A_setup()

    def _B_setup():
        B, S, D, F = 1, 2048, 448, 1792
        return {
            "x": _w((lambda *s: torch.randn(*s, dtype=torch.bfloat16) * 0.05)(B, S, D)),
            "w1": _w((lambda *s: torch.randn(*s, dtype=torch.bfloat16) * 0.8)(S, F) * (S ** -0.5)),
            "b1": _w((lambda *s: torch.randn(*s, dtype=torch.bfloat16) * 12.8)(F) * 0.02),
            "w2": _w((lambda *s: torch.randn(*s, dtype=torch.bfloat16) * 0.2)(F, S) * (F ** -0.5)),
            "b2": _w((lambda *s: torch.randn(*s, dtype=torch.bfloat16) * 1.6)(S) * 0.02),
        }
    _B_in = _B_setup()

    return {
        "A_x": _A_in["x"],
        "A_wqkv": _A_in["wqkv"],
        "A_wo": _A_in["wo"],
        "B_x": _B_in["x"],
        "B_w1": _B_in["w1"],
        "B_b1": _B_in["b1"],
        "B_w2": _B_in["w2"],
        "B_b2": _B_in["b2"],
    }

def reference(A_x, A_wqkv, A_wo, B_x, B_w1, B_b1, B_w2, B_b2):
    def _A_ref(x, wqkv, wo):
        B, S, D = x.shape
        H = 16
        Dh = D // H
        qkv = (lambda x, *d: x.permute(*d))((x @ wqkv).reshape(B, S, 3, H, Dh), 2, 0, 3, 1, 4)
        q, k, v = qkv[0], qkv[1], qkv[2]
        scores = torch.einsum("bhqd,bhkd->bhqk", q, k) * (Dh ** -0.5)
        p = _softmax(scores, axis=-1)
        o = torch.einsum("bhqk,bhkd->bhqd", p, v)
        return (lambda x, *d: x.permute(*d))(o, 0, 2, 1, 3).reshape(B, S, D) @ wo

    def _B_ref(x, w1, b1, w2, b2):
        B, S, D = x.shape
        h = _layernorm(x, axis=-1)
        u = torch.einsum("bsd,sf->bdf", h, w1) + b1
        u = _gelu(u)
        y = torch.einsum("bdf,fs->bds", u, w2) + b2
        return (lambda x, *d: x.permute(*d))(y, 0, 2, 1)

    x = A_x
    h = x + _A_ref(_layernorm(x, axis=-1), A_wqkv, A_wo)
    h2 = h + _B_ref(_layernorm(h, axis=-1), B_w1, B_b1, B_w2, B_b2)
    return h2
```

```asm
; @launch grid=(256,1,1) block=(512,1,1) lds=163840
.amdgcn_target "amdgcn-amd-amdhsa--gfx950"
.text
.globl sequential_preLN__mha_block__mixer_token_mlp__prompt_kernel
.p2align 8
.type sequential_preLN__mha_block__mixer_token_mlp__prompt_kernel,@function
sequential_preLN__mha_block__mixer_token_mlp__prompt_kernel:
    s_load_dwordx2 s[8:9], s[0:1], 0
    s_load_dwordx2 s[12:13], s[0:1], 8
    s_cmp_ge_u32 s2, 256
    s_cbranch_scc1 K_END
    v_and_b32 v1, 63, v0
    v_lshrrev_b32 v3, 6, v0
    v_lshlrev_b32 v2, 4, v1
    v_readfirstlane_b32 s93, v3
    v_and_b32 v0, 255, v0
    s_mov_b32 s10, 1835008
    s_mov_b32 s11, 0x20000
    s_mov_b32 s14, 1204224
    s_mov_b32 s15, 0x20000
    s_and_b32 s48, s93, 3
    s_lshr_b32 s51, s2, 3
    s_bfe_u32 s63, s2, 0x20001
    s_and_b32 s64, s2, 1
    s_lshl_b32 s50, s63, 2
    s_and_b32 s65, s51, 3
    s_add_u32 s50, s50, s65
    s_lshr_b32 s3, s51, 3
    s_bfe_u32 s92, s51, 0x10002
    s_lshl_b32 s65, s64, 1
    s_add_u32 s92, s92, s65
    s_cmp_ge_u32 s51, 24
    s_cbranch_scc1 P1_HELP
    s_cmp_lt_u32 s93, 4
    s_cbranch_scc1 A_P1
B_P1:
    s_mul_i32 s66, s3, 896
    s_mul_i32 s63, s92, 224
    s_add_u32 s66, s66, s63
    s_lshl_b32 s70, s50, 2
    s_add_u32 s70, s70, s48
    s_lshl_b32 s68, s48, 14
    s_add_u32 s68, s68, 98304
    s_mul_i32 s67, s70, 28672
    s_lshl_b32 s69, s48, 10
    v_lshrrev_b32 v4, 3, v1
    v_mul_u32_u24 v6, 896, v4
    v_lshrrev_b32 v4, 4, v1
    v_and_b32 v5, 7, v1
    v_xor_b32 v5, v5, v4
    v_xor_b32 v7, 0, v5
    v_lshl_add_u32 v7, v7, 4, v6
    v_add_u32 v16, 0, v7
    v_xor_b32 v7, 4, v5
    v_lshl_add_u32 v7, v7, 4, v6
    v_add_u32 v17, 6144, v7
    v_xor_b32 v7, 0, v5
    v_lshl_add_u32 v7, v7, 4, v6
    v_add_u32 v18, 12288, v7
    v_xor_b32 v7, 4, v5
    v_lshl_add_u32 v7, v7, 4, v6
    v_add_u32 v19, 18432, v7
    s_lshr_b32 s63, s51, 2
    s_and_b32 s64, s51, 3
    s_add_u32 s63, s63, s64
    s_mul_i32 s64, s63, 11
    s_lshr_b32 s64, s64, 5
    s_mul_i32 s64, s64, 3
    s_sub_u32 s63, s63, s64
    s_lshl_b32 s64, s63, 8
    s_add_u32 s99, s67, s64
    s_mul_i32 s64, s63, 344064
    s_add_u32 s96, s66, s64
    s_add_u32 s63, s63, 1
    s_cmp_eq_u32 s63, 3
    s_cselect_b32 s63, 0, s63
    s_lshl_b32 s64, s63, 8
    s_add_u32 s100, s67, s64
    s_mul_i32 s64, s63, 344064
    s_add_u32 s97, s66, s64
    s_add_u32 s63, s63, 1
    s_cmp_eq_u32 s63, 3
    s_cselect_b32 s63, 0, s63
    s_lshl_b32 s64, s63, 8
    s_add_u32 s101, s67, s64
    s_mul_i32 s64, s63, 344064
    s_add_u32 s98, s66, s64
    s_waitcnt lgkmcnt(0)
    s_add_u32 m0, s68, 4096
    s_add_u32 s65, s99, 0
    buffer_load_dwordx4 v16, s[8:11], s65 offen offset:0 lds
    buffer_load_dwordx4 v17, s[8:11], s65 offen offset:1024 lds
    buffer_load_dwordx4 v18, s[8:11], s65 offen offset:2048 lds
    buffer_load_dwordx4 v19, s[8:11], s65 offen offset:3072 lds
    v_add_u32 v4, 0, v0
    v_mul_u32_u24 v5, 4682, v4
    v_lshrrev_b32 v5, 16, v5
    v_mul_u32_u24 v6, 14, v5
    v_sub_u32 v4, v4, v6
    v_and_b32 v6, 0xf8, v5
    v_and_b32 v7, 1, v5
    v_lshl_add_u32 v6, v7, 2, v6
    v_bfe_u32 v7, v5, 1, 2
    v_add_u32 v6, v6, v7
    v_mul_u32_u24 v6, 2688, v6
    v_lshl_add_u32 v22, v4, 4, v6
    s_add_u32 m0, s69, 0
    s_nop 0
    buffer_load_dwordx4 v22, s[12:15], s96 offen lds
    v_add_u32 v4, 256, v0
    v_mul_u32_u24 v5, 4682, v4
    v_lshrrev_b32 v5, 16, v5
    v_mul_u32_u24 v6, 14, v5
    v_sub_u32 v4, v4, v6
    v_and_b32 v6, 0xf8, v5
    v_and_b32 v7, 1, v5
    v_lshl_add_u32 v6, v7, 2, v6
    v_bfe_u32 v7, v5, 1, 2
    v_add_u32 v6, v6, v7
    v_mul_u32_u24 v6, 2688, v6
    v_lshl_add_u32 v23, v4, 4, v6
    s_add_u32 m0, s69, 4096
    s_nop 0
    buffer_load_dwordx4 v23, s[12:15], s96 offen lds
    v_add_u32 v4, 512, v0
    v_mul_u32_u24 v5, 4682, v4
    v_lshrrev_b32 v5, 16, v5
    v_mul_u32_u24 v6, 14, v5
    v_sub_u32 v4, v4, v6
    v_and_b32 v6, 0xf8, v5
    v_and_b32 v7, 1, v5
    v_lshl_add_u32 v6, v7, 2, v6
    v_bfe_u32 v7, v5, 1, 2
    v_add_u32 v6, v6, v7
    v_mul_u32_u24 v6, 2688, v6
    v_lshl_add_u32 v24, v4, 4, v6
    s_add_u32 m0, s69, 8192
    s_nop 0
    buffer_load_dwordx4 v24, s[12:15], s96 offen lds
    v_add_u32 v4, 768, v0
    v_mul_u32_u24 v5, 4682, v4
    v_lshrrev_b32 v5, 16, v5
    v_mul_u32_u24 v6, 14, v5
    v_sub_u32 v4, v4, v6
    v_and_b32 v6, 0xf8, v5
    v_and_b32 v7, 1, v5
    v_lshl_add_u32 v6, v7, 2, v6
    v_bfe_u32 v7, v5, 1, 2
    v_add_u32 v6, v6, v7
    v_mul_u32_u24 v6, 2688, v6
    v_lshl_add_u32 v25, v4, 4, v6
    s_add_u32 m0, s69, 12288
    s_nop 0
    buffer_load_dwordx4 v25, s[12:15], s96 offen lds
    s_add_u32 m0, s68, 8192
    s_add_u32 s65, s99, 128
    buffer_load_dwordx4 v16, s[8:11], s65 offen offset:0 lds
    buffer_load_dwordx4 v17, s[8:11], s65 offen offset:1024 lds
    buffer_load_dwordx4 v18, s[8:11], s65 offen offset:2048 lds
    buffer_load_dwordx4 v19, s[8:11], s65 offen offset:3072 lds
    v_add_u32 v4, 1024, v0
    v_mul_u32_u24 v5, 4682, v4
    v_lshrrev_b32 v5, 16, v5
    v_mul_u32_u24 v6, 14, v5
    v_sub_u32 v4, v4, v6
    v_and_b32 v6, 0xf8, v5
    v_and_b32 v7, 1, v5
    v_lshl_add_u32 v6, v7, 2, v6
    v_bfe_u32 v7, v5, 1, 2
    v_add_u32 v6, v6, v7
    v_mul_u32_u24 v6, 2688, v6
    v_lshl_add_u32 v26, v4, 4, v6
    s_add_u32 m0, s69, 16384
    s_nop 0
    buffer_load_dwordx4 v26, s[12:15], s96 offen lds
    v_add_u32 v4, 1280, v0
    v_mul_u32_u24 v5, 4682, v4
    v_lshrrev_b32 v5, 16, v5
    v_mul_u32_u24 v6, 14, v5
    v_sub_u32 v4, v4, v6
    v_and_b32 v6, 0xf8, v5
    v_and_b32 v7, 1, v5
    v_lshl_add_u32 v6, v7, 2, v6
    v_bfe_u32 v7, v5, 1, 2
    v_add_u32 v6, v6, v7
    v_mul_u32_u24 v6, 2688, v6
    v_lshl_add_u32 v27, v4, 4, v6
    s_add_u32 m0, s69, 20480
    s_nop 0
    buffer_load_dwordx4 v27, s[12:15], s96 offen lds
    v_add_u32 v4, 1536, v0
    v_mul_u32_u24 v5, 4682, v4
    v_lshrrev_b32 v5, 16, v5
    v_mul_u32_u24 v6, 14, v5
    v_sub_u32 v4, v4, v6
    v_and_b32 v6, 0xf8, v5
    v_and_b32 v7, 1, v5
    v_lshl_add_u32 v6, v7, 2, v6
    v_bfe_u32 v7, v5, 1, 2
    v_add_u32 v6, v6, v7
    v_mul_u32_u24 v6, 2688, v6
    v_lshl_add_u32 v28, v4, 4, v6
    s_add_u32 m0, s69, 24576
    s_nop 0
    buffer_load_dwordx4 v28, s[12:15], s96 offen lds
    s_add_u32 m0, s68, 12288
    s_add_u32 s65, s100, 0
    buffer_load_dwordx4 v16, s[8:11], s65 offen offset:0 lds
    buffer_load_dwordx4 v17, s[8:11], s65 offen offset:1024 lds
    buffer_load_dwordx4 v18, s[8:11], s65 offen offset:2048 lds
    buffer_load_dwordx4 v19, s[8:11], s65 offen offset:3072 lds
    s_load_dwordx2 s[44:45], s[0:1], 80
    s_load_dwordx2 s[40:41], s[0:1], 72
    s_load_dwordx2 s[16:17], s[0:1], 16
    s_load_dwordx2 s[20:21], s[0:1], 32
    s_load_dwordx2 s[24:25], s[0:1], 40
    s_load_dwordx2 s[28:29], s[0:1], 48
    s_load_dwordx2 s[32:33], s[0:1], 56
    s_load_dwordx2 s[36:37], s[0:1], 64
    s_memrealtime s[58:59]
    s_mov_b32 s46, 16777216
    s_mov_b32 s47, 0x20000
    s_mov_b32 s42, 256
    s_mov_b32 s43, 0x20000
    s_mov_b32 s18, 401408
    s_mov_b32 s19, 0x20000
    s_mov_b32 s22, 7340032
    s_mov_b32 s23, 0x20000
    s_mov_b32 s26, 3584
    s_mov_b32 s27, 0x20000
    s_mov_b32 s30, 7340032
    s_mov_b32 s31, 0x20000
    s_mov_b32 s34, 4096
    s_mov_b32 s35, 0x20000
    s_mov_b32 s38, 1835008
    s_mov_b32 s39, 0x20000
    s_mov_b32 s60, 0
    s_mov_b32 s61, -1
    s_mov_b32 s62, 0x3f803f80
    s_mov_b32 s71, 0
    s_mul_i32 s94, s48, 12288
    s_add_u32 s94, s94, 114688
    s_mul_i32 s95, s48, 28672
    v_and_b32 v10, 31, v1
    v_lshlrev_b32 v10, 4, v10
    v_min_u32 v5, 55, v1
    v_lshlrev_b32 v5, 4, v5
    v_add_u32 v6, 10752, v5
    v_add_u32 v7, 21504, v5
    v_add_u32 v8, 32256, v5
    v_mov_b32 v9, 0
    s_add_u32 m0, s69, 28672
    s_nop 0
    buffer_load_dwordx4 v22, s[12:15], s97 offen lds
    s_add_u32 m0, s69, 32768
    s_nop 0
    buffer_load_dwordx4 v23, s[12:15], s97 offen lds
    s_add_u32 m0, s69, 36864
    s_nop 0
    buffer_load_dwordx4 v24, s[12:15], s97 offen lds
    s_add_u32 m0, s69, 40960
    s_nop 0
    buffer_load_dwordx4 v25, s[12:15], s97 offen lds
    s_waitcnt vmcnt(15)
    s_barrier
    s_add_u32 m0, s68, 0
    s_add_u32 s65, s100, 128
    buffer_load_dwordx4 v16, s[8:11], s65 offen offset:0 lds
    buffer_load_dwordx4 v17, s[8:11], s65 offen offset:1024 lds
    buffer_load_dwordx4 v18, s[8:11], s65 offen offset:2048 lds
    buffer_load_dwordx4 v19, s[8:11], s65 offen offset:3072 lds
    s_add_u32 m0, s69, 45056
    s_nop 0
    buffer_load_dwordx4 v26, s[12:15], s97 offen lds
    s_add_u32 m0, s69, 49152
    s_nop 0
    buffer_load_dwordx4 v27, s[12:15], s97 offen lds
    s_add_u32 m0, s69, 53248
    s_nop 0
    buffer_load_dwordx4 v28, s[12:15], s97 offen lds
    s_waitcnt vmcnt(15)
    s_barrier
    s_add_u32 m0, s68, 4096
    s_add_u32 s65, s101, 0
    buffer_load_dwordx4 v16, s[8:11], s65 offen offset:0 lds
    buffer_load_dwordx4 v17, s[8:11], s65 offen offset:1024 lds
    buffer_load_dwordx4 v18, s[8:11], s65 offen offset:2048 lds
    buffer_load_dwordx4 v19, s[8:11], s65 offen offset:3072 lds
    s_add_u32 m0, s69, 57344
    s_nop 0
    buffer_load_dwordx4 v22, s[12:15], s98 offen lds
    s_add_u32 m0, s69, 61440
    s_nop 0
    buffer_load_dwordx4 v23, s[12:15], s98 offen lds
    s_add_u32 m0, s69, 65536
    s_nop 0
    buffer_load_dwordx4 v24, s[12:15], s98 offen lds
    s_add_u32 m0, s69, 69632
    s_nop 0
    buffer_load_dwordx4 v25, s[12:15], s98 offen lds
    s_waitcnt vmcnt(15)
    s_barrier
    s_add_u32 m0, s68, 8192
    s_add_u32 s65, s101, 128
    buffer_load_dwordx4 v16, s[8:11], s65 offen offset:0 lds
    buffer_load_dwordx4 v17, s[8:11], s65 offen offset:1024 lds
    buffer_load_dwordx4 v18, s[8:11], s65 offen offset:2048 lds
    buffer_load_dwordx4 v19, s[8:11], s65 offen offset:3072 lds
    s_add_u32 m0, s69, 73728
    s_nop 0
    buffer_load_dwordx4 v26, s[12:15], s98 offen lds
    s_add_u32 m0, s69, 77824
    s_nop 0
    buffer_load_dwordx4 v27, s[12:15], s98 offen lds
    s_add_u32 m0, s69, 81920
    s_nop 0
    buffer_load_dwordx4 v28, s[12:15], s98 offen lds
    s_waitcnt vmcnt(15)
    s_barrier
    s_add_u32 m0, s68, 12288
    s_add_u32 s65, s67, 768
    buffer_load_dwordx4 v16, s[8:11], s65 offen offset:0 lds
    buffer_load_dwordx4 v17, s[8:11], s65 offen offset:1024 lds
    buffer_load_dwordx4 v18, s[8:11], s65 offen offset:2048 lds
    buffer_load_dwordx4 v19, s[8:11], s65 offen offset:3072 lds
    s_add_u32 s63, s66, 1032192
    s_add_u32 m0, s69, 86016
    s_nop 0
    buffer_load_dwordx4 v22, s[12:15], s63 offen lds
    s_add_u32 m0, s69, 90112
    s_nop 0
    buffer_load_dwordx4 v23, s[12:15], s63 offen lds
    s_add_u32 m0, s69, 94208
    s_nop 0
    buffer_load_dwordx4 v24, s[12:15], s63 offen lds
    s_waitcnt vmcnt(14)
    s_barrier
    s_waitcnt lgkmcnt(0)
    s_lshl_b32 s64, s70, 9
    s_add_u32 s64, s64, 14417920
    s_lshl_b32 s7, s66, 2
    s_add_u32 s7, s7, 14483456
    buffer_load_dwordx2 v[30:31], v9, s[40:43], 0 offen sc1
    buffer_load_dwordx4 v[32:35], v10, s[44:47], s64 offen sc1
    buffer_load_dwordx4 v[36:39], v5, s[44:47], s7 offen sc1
    buffer_load_dwordx4 v[40:43], v6, s[44:47], s7 offen sc1
    buffer_load_dwordx4 v[44:47], v7, s[44:47], s7 offen sc1
    buffer_load_dwordx4 v[48:51], v8, s[44:47], s7 offen sc1
    s_add_u32 m0, s69, 98304
    s_nop 0
    buffer_load_dwordx4 v25, s[12:15], s63 offen lds
    s_waitcnt vmcnt(14)
    s_barrier
    s_setprio 2
    s_waitcnt vmcnt(1)
    v_readfirstlane_b32 s58, v30
    v_readfirstlane_b32 s59, v31
    s_nop 0
    s_or_b32 s57, s58, s59
    s_cbranch_scc1 B_T_ok
    s_mov_b32 s57, 0x40000
    v_mov_b32 v4, 0
B_T_l:
    buffer_load_dwordx2 v[30:31], v4, s[40:43], 0 offen sc1
    s_sub_u32 s57, s57, 1
    s_waitcnt vmcnt(0)
    s_cbranch_scc1 B_T_ok
    v_readfirstlane_b32 s58, v30
    v_readfirstlane_b32 s59, v31
    s_nop 0
    s_cmp_eq_u64 s[58:59], 0
    s_cbranch_scc1 B_T_l
B_T_ok:
    s_mov_b32 s57, 0x40000
    s_branch B_GC
B_GL:
    buffer_load_dwordx4 v[32:35], v10, s[44:47], s64 offen sc1
    buffer_load_dwordx4 v[36:39], v5, s[44:47], s7 offen sc1
    buffer_load_dwordx4 v[40:43], v6, s[44:47], s7 offen sc1
    buffer_load_dwordx4 v[44:47], v7, s[44:47], s7 offen sc1
    buffer_load_dwordx4 v[48:51], v8, s[44:47], s7 offen sc1
    s_sub_u32 s57, s57, 1
    s_waitcnt vmcnt(0)
    s_cbranch_scc1 B_GX
B_GC:
    v_xor_b32 v11, s58, v33
    v_xor_b32 v12, s59, v35
    v_or_b32 v11, v11, v12
    v_xor_b32 v12, s58, v37
    v_xor_b32 v13, s59, v39
    v_or3_b32 v11, v11, v12, v13
    v_xor_b32 v12, s58, v41
    v_xor_b32 v13, s59, v43
    v_or3_b32 v11, v11, v12, v13
    v_xor_b32 v12, s58, v45
    v_xor_b32 v13, s59, v47
    v_or3_b32 v11, v11, v12, v13
    v_xor_b32 v12, s58, v49
    v_xor_b32 v13, s59, v51
    v_or3_b32 v11, v11, v12, v13
    v_cmp_ne_u32 vcc, 0, v11
    s_cbranch_vccnz B_GL
B_GX:
    v_add_f32 v36, v36, v40
    v_add_f32 v44, v44, v48
    v_add_f32 v38, v38, v42
    v_add_f32 v46, v46, v50
    v_add_f32 v36, v36, v44
    v_add_f32 v37, v38, v46
    s_cmp_eq_u32 s3, 0
    s_cselect_b32 s65, 0x3e8b97f6, 1.0
    v_cndmask_b32 v6, v34, v32, s[60:61]
    v_mul_f32 v6, s65, v6
    v_lshl_add_u32 v4, v1, 3, s69
    ds_write_b64 v4, v[36:37]
    v_lshl_add_u32 v4, v1, 2, s69
    ds_write_b32 v4, v6 offset:512
    s_setprio 0
    s_waitcnt vmcnt(0) lgkmcnt(0)
    s_barrier
    s_branch B_P2
P1_HELP:
    s_load_dwordx2 s[44:45], s[0:1], 80
    s_load_dwordx2 s[40:41], s[0:1], 72
    s_load_dwordx2 s[16:17], s[0:1], 16
    s_load_dwordx2 s[20:21], s[0:1], 32
    s_load_dwordx2 s[24:25], s[0:1], 40
    s_load_dwordx2 s[28:29], s[0:1], 48
    s_load_dwordx2 s[32:33], s[0:1], 56
    s_load_dwordx2 s[36:37], s[0:1], 64
    s_memrealtime s[58:59]
    s_mov_b32 s46, 16777216
    s_mov_b32 s47, 0x20000
    s_mov_b32 s42, 256
    s_mov_b32 s43, 0x20000
    s_mov_b32 s18, 401408
    s_mov_b32 s19, 0x20000
    s_mov_b32 s22, 7340032
    s_mov_b32 s23, 0x20000
    s_mov_b32 s26, 3584
    s_mov_b32 s27, 0x20000
    s_mov_b32 s30, 7340032
    s_mov_b32 s31, 0x20000
    s_mov_b32 s34, 4096
    s_mov_b32 s35, 0x20000
    s_mov_b32 s38, 1835008
    s_mov_b32 s39, 0x20000
    s_mov_b32 s60, 0
    s_mov_b32 s61, -1
    s_mov_b32 s62, 0x3f803f80
    s_mov_b32 s71, 0
    s_mul_i32 s94, s48, 12288
    s_add_u32 s94, s94, 114688
    s_mul_i32 s95, s48, 28672
    s_and_b32 s66, s2, 7
    s_lshl_b32 s66, s66, 3
    s_add_u32 s66, s66, s51
    s_sub_u32 s66, s66, 24
    v_lshrrev_b32 v4, 3, v1
    v_and_b32 v5, 7, v1
    v_lshlrev_b32 v5, 4, v5
    v_mov_b32 v7, 0
    s_cmp_ge_u32 s93, 4
    s_cbranch_scc1 H_CS
    v_mul_u32_u24 v6, 896, v4
    v_add_u32 v6, v6, v5
    s_lshl_b32 s67, s66, 2
    s_add_u32 s67, s67, s48
    s_mul_i32 s63, s67, 7168
    s_waitcnt lgkmcnt(0)
    buffer_load_dwordx4 v[16:19], v6, s[8:11], s63 offen offset:0
    buffer_load_dwordx4 v[20:23], v6, s[8:11], s63 offen offset:128
    buffer_load_dwordx4 v[24:27], v6, s[8:11], s63 offen offset:256
    buffer_load_dwordx4 v[28:31], v6, s[8:11], s63 offen offset:384
    buffer_load_dwordx4 v[32:35], v6, s[8:11], s63 offen offset:512
    buffer_load_dwordx4 v[36:39], v6, s[8:11], s63 offen offset:640
    buffer_load_dwordx4 v[40:43], v6, s[8:11], s63 offen offset:768
    v_mov_b32 v80, 0
    v_mov_b32 v82, 0
    v_mov_b32 v84, 0
    v_mov_b32 v86, 0
    s_waitcnt vmcnt(0)
    buffer_load_dwordx2 v[14:15], v7, s[40:43], 0 offen sc1
    v_dot2c_f32_bf16 v80, s62, v16
    v_dot2c_f32_bf16 v82, v16, v16
    v_dot2c_f32_bf16 v84, s62, v17
    v_dot2c_f32_bf16 v86, v17, v17
    v_dot2c_f32_bf16 v80, s62, v18
    v_dot2c_f32_bf16 v82, v18, v18
    v_dot2c_f32_bf16 v84, s62, v19
    v_dot2c_f32_bf16 v86, v19, v19
    v_dot2c_f32_bf16 v80, s62, v20
    v_dot2c_f32_bf16 v82, v20, v20
    v_dot2c_f32_bf16 v84, s62, v21
    v_dot2c_f32_bf16 v86, v21, v21
    v_dot2c_f32_bf16 v80, s62, v22
    v_dot2c_f32_bf16 v82, v22, v22
    v_dot2c_f32_bf16 v84, s62, v23
    v_dot2c_f32_bf16 v86, v23, v23
    v_dot2c_f32_bf16 v80, s62, v24
    v_dot2c_f32_bf16 v82, v24, v24
    v_dot2c_f32_bf16 v84, s62, v25
    v_dot2c_f32_bf16 v86, v25, v25
    v_dot2c_f32_bf16 v80, s62, v26
    v_dot2c_f32_bf16 v82, v26, v26
    v_dot2c_f32_bf16 v84, s62, v27
    v_dot2c_f32_bf16 v86, v27, v27
    v_dot2c_f32_bf16 v80, s62, v28
    v_dot2c_f32_bf16 v82, v28, v28
    v_dot2c_f32_bf16 v84, s62, v29
    v_dot2c_f32_bf16 v86, v29, v29
    v_dot2c_f32_bf16 v80, s62, v30
    v_dot2c_f32_bf16 v82, v30, v30
    v_dot2c_f32_bf16 v84, s62, v31
    v_dot2c_f32_bf16 v86, v31, v31
    v_dot2c_f32_bf16 v80, s62, v32
    v_dot2c_f32_bf16 v82, v32, v32
    v_dot2c_f32_bf16 v84, s62, v33
    v_dot2c_f32_bf16 v86, v33, v33
    v_dot2c_f32_bf16 v80, s62, v34
    v_dot2c_f32_bf16 v82, v34, v34
    v_dot2c_f32_bf16 v84, s62, v35
    v_dot2c_f32_bf16 v86, v35, v35
    v_dot2c_f32_bf16 v80, s62, v36
    v_dot2c_f32_bf16 v82, v36, v36
    v_dot2c_f32_bf16 v84, s62, v37
    v_dot2c_f32_bf16 v86, v37, v37
    v_dot2c_f32_bf16 v80, s62, v38
    v_dot2c_f32_bf16 v82, v38, v38
    v_dot2c_f32_bf16 v84, s62, v39
    v_dot2c_f32_bf16 v86, v39, v39
    v_dot2c_f32_bf16 v80, s62, v40
    v_dot2c_f32_bf16 v82, v40, v40
    v_dot2c_f32_bf16 v84, s62, v41
    v_dot2c_f32_bf16 v86, v41, v41
    v_dot2c_f32_bf16 v80, s62, v42
    v_dot2c_f32_bf16 v82, v42, v42
    v_dot2c_f32_bf16 v84, s62, v43
    v_dot2c_f32_bf16 v86, v43, v43
    s_nop 1
    v_add_f32 v80, v80, v84
    v_add_f32 v82, v82, v86
    s_nop 0
    v_add_f32_dpp v80, v80, v80 quad_perm:[1,0,3,2] row_mask:0xf bank_mask:0xf
    v_add_f32_dpp v82, v82, v82 quad_perm:[1,0,3,2] row_mask:0xf bank_mask:0xf
    s_nop 0
    v_add_f32_dpp v80, v80, v80 quad_perm:[2,3,0,1] row_mask:0xf bank_mask:0xf
    v_add_f32_dpp v82, v82, v82 quad_perm:[2,3,0,1] row_mask:0xf bank_mask:0xf
    s_nop 0
    v_add_f32_dpp v80, v80, v80 row_half_mirror row_mask:0xf bank_mask:0xf
    v_add_f32_dpp v82, v82, v82 row_half_mirror row_mask:0xf bank_mask:0xf
    v_mul_f32 v80, 0x3b124925, v80
    v_mul_f32 v82, 0x3b124925, v82
    v_fma_f32 v82, -v80, v80, v82
    v_max_f32 v82, 0, v82
    v_add_f32 v82, 0x3727c5ac, v82
    v_rsq_f32 v82, v82
    v_lshlrev_b32 v6, 4, v4
    v_mul_f32 v80, v80, v82
    v_sub_f32 v80, 0, v80
    s_waitcnt vmcnt(0)
    v_readfirstlane_b32 s58, v14
    v_readfirstlane_b32 s59, v15
    s_nop 0
    s_or_b32 s57, s58, s59
    s_cbranch_scc1 H_T1_ok
    s_mov_b32 s57, 0x40000
    v_mov_b32 v4, 0
H_T1_l:
    buffer_load_dwordx2 v[14:15], v4, s[40:43], 0 offen sc1
    s_sub_u32 s57, s57, 1
    s_waitcnt vmcnt(0)
    s_cbranch_scc1 H_T1_ok
    v_readfirstlane_b32 s58, v14
    v_readfirstlane_b32 s59, v15
    s_nop 0
    s_cmp_eq_u64 s[58:59], 0
    s_cbranch_scc1 H_T1_l
H_T1_ok:
    v_mov_b32 v81, s58
    v_mov_b32 v83, s59
    s_lshl_b32 s63, s67, 7
    s_add_u32 s63, s63, 14417920
    s_mov_b32 exec_lo, 0x01010101
    s_mov_b32 exec_hi, 0x01010101
    buffer_store_dwordx4 v[80:83], v6, s[44:47], s63 offen sc1
    s_mov_b64 exec, -1
    s_barrier
    s_bfe_u32 s63, s2, 0x20001
    s_and_b32 s64, s2, 1
    s_sub_u32 s65, 25, s64
    s_cmp_lt_u32 s51, s65
    s_cselect_b32 s56, 1, 0
    s_cselect_b32 s65, s51, 0
    s_mul_i32 s52, s64, 25
    s_add_u32 s65, s65, s52
    s_mul_i32 s53, s65, 9363
    s_lshr_b32 s53, s53, 16
    s_mul_i32 s52, s53, 7
    s_sub_u32 s65, s65, s52
    s_mul_i32 s52, s63, 7
    s_add_u32 s52, s65, s52
    s_cmp_lt_u32 s51, 28
    s_cselect_b32 s65, s51, 0
    s_mul_i32 s54, s64, 28
    s_add_u32 s65, s65, s54
    s_lshr_b32 s55, s65, 3
    s_and_b32 s65, s65, 7
    s_lshl_b32 s54, s63, 3
    s_add_u32 s54, s54, s65
    s_lshl_b32 s63, s92, 2
    s_add_u32 s63, s63, s3
    s_lshl_b32 s63, s63, 4
    s_add_u32 s63, s63, s50
    s_lshl_b32 s63, s63, 7
    s_add_u32 s4, s63, 15204352
    s_and_b32 s63, s2, 7
    s_lshl_b32 s63, s63, 1
    s_and_b32 s49, s51, 1
    s_add_u32 s49, s49, s63
    s_lshr_b32 s50, s51, 1
    s_lshr_b32 s1, s51, 4
    s_add_u32 s1, s1, s63
    s_lshl_b32 s1, s1, 2
    s_add_u32 s1, s1, s48
    s_and_b32 s0, s51, 15
    s_lshl_b32 s63, s2, 3
    s_add_u32 s5, s63, 15335424
    s_lshl_b32 s65, s1, 4
    s_add_u32 s65, s65, s0
    s_lshl_b32 s65, s65, 9
    s_add_u32 s65, s65, 14680064
    v_lshl_add_u32 v4, v1, 7, s65
    v_writelane_b32 v4, s4, 4
    v_writelane_b32 v4, s5, 5
    s_mov_b64 exec, 63
    buffer_load_dword v126, v4, s[44:47], 0 offen sc1
    s_mov_b64 exec, -1
    v_lshrrev_b32 v4, 5, v1
    v_mul_u32_u24 v4, 512, v4
    v_bfe_u32 v5, v1, 2, 2
    v_mul_u32_u24 v5, 128, v5
    v_add_u32 v4, v4, v5
    v_bfe_u32 v5, v1, 4, 1
    v_lshl_add_u32 v4, v5, 5, v4
    v_and_b32 v5, 3, v1
    v_lshl_add_u32 v4, v5, 3, v4
    s_and_b32 s63, s48, 1
    s_lshl_b32 s63, s63, 5
    v_xor_b32 v4, s63, v4
    v_bfe_u32 v5, v1, 3, 1
    s_lshr_b32 s63, s48, 1
    v_xor_b32 v5, s63, v5
    v_lshl_add_u32 v6, v5, 6, v4
    v_xor_b32 v5, 1, v5
    v_lshl_add_u32 v7, v5, 6, v4
    v_add_u32 v240, s95, v6
    v_add_u32 v241, s95, v7
    v_mov_b32 v244, 0x3f80
    v_mov_b32 v245, 1.0
    s_lshl_b32 s63, s49, 2
    s_add_u32 s63, s63, s48
    s_lshl_b32 s63, s63, 16
    s_add_u32 s63, s63, 2097152
    v_add_u32 v243, s63, v2
    v_lshrrev_b32 v248, 5, v1
    v_mul_u32_u24 v248, 256, v248
    v_bfe_u32 v4, v1, 2, 2
    v_mul_u32_u24 v4, 64, v4
    v_add_u32 v248, v248, v4
    v_bfe_u32 v4, v1, 4, 1
    v_lshl_add_u32 v248, v4, 5, v248
    v_and_b32 v4, 3, v1
    v_lshl_add_u32 v248, v4, 3, v248
    v_add_u32 v248, 114688, v248
    v_add_u32 v249, s94, v2
    s_add_u32 s63, s48, 1
    s_and_b32 s63, s63, 3
    s_mul_i32 s63, s63, 12288
    s_add_u32 s63, s63, 114688
    v_add_u32 v250, s63, v2
    s_add_u32 s63, s48, 2
    s_and_b32 s63, s63, 3
    s_mul_i32 s63, s63, 12288
    s_add_u32 s63, s63, 114688
    v_add_u32 v251, s63, v2
    s_add_u32 s63, s48, 3
    s_and_b32 s63, s63, 3
    s_mul_i32 s63, s63, 12288
    s_add_u32 s63, s63, 114688
    v_add_u32 v252, s63, v2
    v_and_b32 v4, 31, v1
    v_lshrrev_b32 v5, 5, v1
    v_lshlrev_b32 v6, 3, v5
    v_sub_u32 v6, v4, v6
    v_cmp_eq_u32 vcc, 0, v6
    v_cmp_eq_u32 s[64:65], 1, v6
    s_nop 0
    v_cndmask_b32 v232, 0, v244, vcc
    v_cndmask_b32 v232, v232, v245, s[64:65]
    v_cmp_eq_u32 vcc, 2, v6
    v_cmp_eq_u32 s[64:65], 3, v6
    s_nop 0
    v_cndmask_b32 v233, 0, v244, vcc
    v_cndmask_b32 v233, v233, v245, s[64:65]
    v_cmp_eq_u32 vcc, 4, v6
    v_cmp_eq_u32 s[64:65], 5, v6
    s_nop 0
    v_cndmask_b32 v234, 0, v244, vcc
    v_cndmask_b32 v234, v234, v245, s[64:65]
    v_cmp_eq_u32 vcc, 6, v6
    v_cmp_eq_u32 s[64:65], 7, v6
    s_nop 0
    v_cndmask_b32 v235, 0, v244, vcc
    v_cndmask_b32 v235, v235, v245, s[64:65]
    v_cmp_eq_u32 vcc, 16, v6
    v_cmp_eq_u32 s[64:65], 17, v6
    s_nop 0
    v_cndmask_b32 v236, 0, v244, vcc
    v_cndmask_b32 v236, v236, v245, s[64:65]
    v_cmp_eq_u32 vcc, 18, v6
    v_cmp_eq_u32 s[64:65], 19, v6
    s_nop 0
    v_cndmask_b32 v237, 0, v244, vcc
    v_cndmask_b32 v237, v237, v245, s[64:65]
    v_cmp_eq_u32 vcc, 20, v6
    v_cmp_eq_u32 s[64:65], 21, v6
    s_nop 0
    v_cndmask_b32 v238, 0, v244, vcc
    v_cndmask_b32 v238, v238, v245, s[64:65]
    v_cmp_eq_u32 vcc, 22, v6
    v_cmp_eq_u32 s[64:65], 23, v6
    s_nop 0
    v_cndmask_b32 v239, 0, v244, vcc
    v_cndmask_b32 v239, v239, v245, s[64:65]
    v_and_b32 v4, 31, v1
    v_lshrrev_b32 v5, 5, v1
    v_mul_u32_u24 v13, 896, v4
    v_lshl_add_u32 v13, v5, 4, v13
    s_lshl_b32 s67, s1, 11
    s_add_u32 s67, s67, 0
    v_add_u32 v10, s67, v2
    v_add_u32 v11, 0x20000, v10
    s_and_b32 s63, s0, 7
    s_lshl_b32 s101, s63, 18
    s_lshl_b32 s63, s63, 1
    v_add_u32 v12, s63, v1
    v_and_b32 v12, 15, v12
    v_lshlrev_b32 v12, 17, v12
    s_add_u32 s63, s67, 2044
    v_add_u32 v12, s63, v12
    v_lshrrev_b32 v4, 3, v1
    v_bfe_u32 v6, v1, 4, 1
    v_lshlrev_b32 v6, 2, v6
    v_and_b32 v246, 7, v1
    v_xor_b32 v6, v246, v6
    v_lshlrev_b32 v6, 4, v6
    v_lshl_add_u32 v4, v4, 12, v6
    s_mul_i32 s63, s48, 1835008
    s_lshl_b32 s64, s54, 7
    s_add_u32 s63, s63, s64
    v_add_u32 v246, s63, v4
    v_add_u32 v247, 31744, v246
    s_bfe_u32 s96, s2, 0x20001
    s_mul_i32 s96, s96, 7
    s_sub_u32 s96, s52, s96
    s_add_u32 s96, s96, s53
    s_add_u32 s96, s96, s53
    s_and_b32 s57, s2, 1
    s_mul_i32 s57, s57, 3
    s_add_u32 s96, s96, s57
    s_and_b32 s96, s96, 7
    s_lshl_b32 s96, s96, 2
    s_lshl_b32 s96, s96, 10
    s_and_b32 s57, s2, 1
    s_lshl_b32 s57, s57, 1
    s_lshl_b32 s97, s55, 1
    s_add_u32 s97, s97, s57
    s_and_b32 s57, s54, 7
    s_add_u32 s97, s97, s57
    s_mul_i32 s57, s97, 37
    s_lshr_b32 s57, s57, 8
    s_mul_i32 s57, s57, 7
    s_sub_u32 s97, s97, s57
    s_lshl_b32 s97, s97, 2
    s_lshl_b32 s97, s97, 10
    s_lshl_b32 s63, s48, 15
    s_add_u32 s63, s63, 0
    s_lshl_b32 s67, s53, 18
    s_add_u32 s67, s67, s63
    v_add_u32 v14, s67, v2
    s_add_u32 s63, s96, 0
    v_lshl_add_u32 v3, v1, 11, s63
    v_and_b32 v3, 0x7fff, v3
    s_add_u32 s63, s67, 2044
    v_add_u32 v3, s63, v3
    s_mul_i32 s63, s48, 28672
    s_add_u32 s63, s63, 2097152
    s_mul_i32 s67, s55, 229376
    s_add_u32 s67, s67, s63
    s_and_b32 s63, s48, 1
    s_lshl_b32 s63, s63, 8
    v_xor_b32 v253, s63, v2
    v_add_u32 v253, s67, v253
    s_add_u32 s63, s97, 0
    v_min_u32 v4, 5, v1
    v_lshl_add_u32 v242, v4, 11, s63
    v_subrev_u32 v4, 28672, v242
    v_min_u32 v242, v242, v4
    s_add_u32 s63, s67, 2044
    v_add_u32 v242, s63, v242
    s_lshl_b32 s100, s52, 2
    s_add_u32 s100, s100, s48
    s_mul_i32 s63, s53, 229376
    s_lshl_b32 s64, s100, 10
    s_add_u32 s63, s63, s64
    s_add_u32 s98, s63, 2097152
    s_lshr_b32 s65, s48, 1
    s_lshl_b32 s63, s54, 1
    s_add_u32 s65, s65, s63
    s_mul_i32 s65, s65, 7
    s_add_u32 s65, s65, s55
    s_lshl_b32 s65, s65, 12
    s_and_b32 s63, s48, 1
    s_lshl_b32 s63, s63, 10
    s_add_u32 s65, s65, s63
    s_add_u32 s99, s65, 8388608
    s_xor_b32 s63, s48, 3
    s_mul_i32 s63, s63, 28672
    s_add_u32 s63, s63, 26624
    v_add_u32 v15, s63, v2
    s_getreg_b32 s65, hwreg(HW_REG_XCC_ID, 0, 4)
    s_cmp_lg_u32 s48, 1
    s_cbranch_scc1 H_NOX
    s_lshr_b32 s63, s1, 2
    s_lshl_b32 s63, s63, 4
    s_add_u32 s63, s63, s0
    s_lshl_b32 s63, s63, 4
    s_add_u32 s63, s63, 15466496
    v_mov_b32 v4, s65
    v_mov_b32 v5, s58
    v_mov_b32 v6, s65
    v_mov_b32 v7, s59
    v_mov_b32 v8, 0
    s_mov_b64 exec, 1
    buffer_store_dwordx4 v[4:7], v8, s[44:47], s63 offen sc1
    s_mov_b64 exec, -1
H_NOX:
    s_branch P2_START
H_CS:
    s_lshl_b32 s67, s48, 6
    s_add_u32 s67, s67, s66
    s_cmp_ge_u32 s67, 84
    s_cbranch_scc1 H_PF
    v_mul_u32_u24 v6, 2688, v4
    v_add_u32 v6, v6, v5
    s_and_b32 s68, s67, 3
    s_lshr_b32 s69, s67, 2
    s_mul_i32 s63, s68, 301056
    s_lshl_b32 s64, s69, 7
    s_add_u32 s63, s63, s64
    s_waitcnt lgkmcnt(0)
    buffer_load_dwordx4 v[16:19], v6, s[12:15], s63 offen
    s_add_u32 s63, s63, 21504
    buffer_load_dwordx4 v[20:23], v6, s[12:15], s63 offen
    s_add_u32 s63, s63, 21504
    buffer_load_dwordx4 v[24:27], v6, s[12:15], s63 offen
    s_add_u32 s63, s63, 21504
    buffer_load_dwordx4 v[28:31], v6, s[12:15], s63 offen
    s_add_u32 s63, s63, 21504
    buffer_load_dwordx4 v[32:35], v6, s[12:15], s63 offen
    s_add_u32 s63, s63, 21504
    buffer_load_dwordx4 v[36:39], v6, s[12:15], s63 offen
    s_add_u32 s63, s63, 21504
    buffer_load_dwordx4 v[40:43], v6, s[12:15], s63 offen
    s_add_u32 s63, s63, 21504
    buffer_load_dwordx4 v[44:47], v6, s[12:15], s63 offen
    s_add_u32 s63, s63, 21504
    buffer_load_dwordx4 v[48:51], v6, s[12:15], s63 offen
    s_add_u32 s63, s63, 21504
    buffer_load_dwordx4 v[52:55], v6, s[12:15], s63 offen
    s_add_u32 s63, s63, 21504
    buffer_load_dwordx4 v[56:59], v6, s[12:15], s63 offen
    s_add_u32 s63, s63, 21504
    buffer_load_dwordx4 v[60:63], v6, s[12:15], s63 offen
    s_add_u32 s63, s63, 21504
    buffer_load_dwordx4 v[64:67], v6, s[12:15], s63 offen
    s_add_u32 s63, s63, 21504
    buffer_load_dwordx4 v[68:71], v6, s[12:15], s63 offen
    s_add_u32 s63, s63, 21504
    s_mov_b32 s63, 0x3f80
    s_mov_b32 s64, 0x3f800000
    v_mov_b32 v80, 0
    v_mov_b32 v81, 0
    v_mov_b32 v82, 0
    v_mov_b32 v83, 0
    v_mov_b32 v84, 0
    v_mov_b32 v85, 0
    v_mov_b32 v86, 0
    v_mov_b32 v87, 0
    s_waitcnt vmcnt(10)
    v_dot2c_f32_bf16 v80, s63, v16
    v_dot2c_f32_bf16 v81, s64, v16
    v_dot2c_f32_bf16 v82, s63, v17
    v_dot2c_f32_bf16 v83, s64, v17
    v_dot2c_f32_bf16 v84, s63, v18
    v_dot2c_f32_bf16 v85, s64, v18
    v_dot2c_f32_bf16 v86, s63, v19
    v_dot2c_f32_bf16 v87, s64, v19
    v_dot2c_f32_bf16 v80, s63, v20
    v_dot2c_f32_bf16 v81, s64, v20
    v_dot2c_f32_bf16 v82, s63, v21
    v_dot2c_f32_bf16 v83, s64, v21
    v_dot2c_f32_bf16 v84, s63, v22
    v_dot2c_f32_bf16 v85, s64, v22
    v_dot2c_f32_bf16 v86, s63, v23
    v_dot2c_f32_bf16 v87, s64, v23
    v_dot2c_f32_bf16 v80, s63, v24
    v_dot2c_f32_bf16 v81, s64, v24
    v_dot2c_f32_bf16 v82, s63, v25
    v_dot2c_f32_bf16 v83, s64, v25
    v_dot2c_f32_bf16 v84, s63, v26
    v_dot2c_f32_bf16 v85, s64, v26
    v_dot2c_f32_bf16 v86, s63, v27
    v_dot2c_f32_bf16 v87, s64, v27
    v_dot2c_f32_bf16 v80, s63, v28
    v_dot2c_f32_bf16 v81, s64, v28
    v_dot2c_f32_bf16 v82, s63, v29
    v_dot2c_f32_bf16 v83, s64, v29
    v_dot2c_f32_bf16 v84, s63, v30
    v_dot2c_f32_bf16 v85, s64, v30
    v_dot2c_f32_bf16 v86, s63, v31
    v_dot2c_f32_bf16 v87, s64, v31
    s_waitcnt vmcnt(6)
    v_dot2c_f32_bf16 v80, s63, v32
    v_dot2c_f32_bf16 v81, s64, v32
    v_dot2c_f32_bf16 v82, s63, v33
    v_dot2c_f32_bf16 v83, s64, v33
    v_dot2c_f32_bf16 v84, s63, v34
    v_dot2c_f32_bf16 v85, s64, v34
    v_dot2c_f32_bf16 v86, s63, v35
    v_dot2c_f32_bf16 v87, s64, v35
    v_dot2c_f32_bf16 v80, s63, v36
    v_dot2c_f32_bf16 v81, s64, v36
    v_dot2c_f32_bf16 v82, s63, v37
    v_dot2c_f32_bf16 v83, s64, v37
    v_dot2c_f32_bf16 v84, s63, v38
    v_dot2c_f32_bf16 v85, s64, v38
    v_dot2c_f32_bf16 v86, s63, v39
    v_dot2c_f32_bf16 v87, s64, v39
    v_dot2c_f32_bf16 v80, s63, v40
    v_dot2c_f32_bf16 v81, s64, v40
    v_dot2c_f32_bf16 v82, s63, v41
    v_dot2c_f32_bf16 v83, s64, v41
    v_dot2c_f32_bf16 v84, s63, v42
    v_dot2c_f32_bf16 v85, s64, v42
    v_dot2c_f32_bf16 v86, s63, v43
    v_dot2c_f32_bf16 v87, s64, v43
    v_dot2c_f32_bf16 v80, s63, v44
    v_dot2c_f32_bf16 v81, s64, v44
    v_dot2c_f32_bf16 v82, s63, v45
    v_dot2c_f32_bf16 v83, s64, v45
    v_dot2c_f32_bf16 v84, s63, v46
    v_dot2c_f32_bf16 v85, s64, v46
    v_dot2c_f32_bf16 v86, s63, v47
    v_dot2c_f32_bf16 v87, s64, v47
    s_waitcnt vmcnt(2)
    v_dot2c_f32_bf16 v80, s63, v48
    v_dot2c_f32_bf16 v81, s64, v48
    v_dot2c_f32_bf16 v82, s63, v49
    v_dot2c_f32_bf16 v83, s64, v49
    v_dot2c_f32_bf16 v84, s63, v50
    v_dot2c_f32_bf16 v85, s64, v50
    v_dot2c_f32_bf16 v86, s63, v51
    v_dot2c_f32_bf16 v87, s64, v51
    v_dot2c_f32_bf16 v80, s63, v52
    v_dot2c_f32_bf16 v81, s64, v52
    v_dot2c_f32_bf16 v82, s63, v53
    v_dot2c_f32_bf16 v83, s64, v53
    v_dot2c_f32_bf16 v84, s63, v54
    v_dot2c_f32_bf16 v85, s64, v54
    v_dot2c_f32_bf16 v86, s63, v55
    v_dot2c_f32_bf16 v87, s64, v55
    v_dot2c_f32_bf16 v80, s63, v56
    v_dot2c_f32_bf16 v81, s64, v56
    v_dot2c_f32_bf16 v82, s63, v57
    v_dot2c_f32_bf16 v83, s64, v57
    v_dot2c_f32_bf16 v84, s63, v58
    v_dot2c_f32_bf16 v85, s64, v58
    v_dot2c_f32_bf16 v86, s63, v59
    v_dot2c_f32_bf16 v87, s64, v59
    v_dot2c_f32_bf16 v80, s63, v60
    v_dot2c_f32_bf16 v81, s64, v60
    v_dot2c_f32_bf16 v82, s63, v61
    v_dot2c_f32_bf16 v83, s64, v61
    v_dot2c_f32_bf16 v84, s63, v62
    v_dot2c_f32_bf16 v85, s64, v62
    v_dot2c_f32_bf16 v86, s63, v63
    v_dot2c_f32_bf16 v87, s64, v63
    s_waitcnt vmcnt(0)
    buffer_load_dwordx2 v[14:15], v7, s[40:43], 0 offen sc1
    v_dot2c_f32_bf16 v80, s63, v64
    v_dot2c_f32_bf16 v81, s64, v64
    v_dot2c_f32_bf16 v82, s63, v65
    v_dot2c_f32_bf16 v83, s64, v65
    v_dot2c_f32_bf16 v84, s63, v66
    v_dot2c_f32_bf16 v85, s64, v66
    v_dot2c_f32_bf16 v86, s63, v67
    v_dot2c_f32_bf16 v87, s64, v67
    v_dot2c_f32_bf16 v80, s63, v68
    v_dot2c_f32_bf16 v81, s64, v68
    v_dot2c_f32_bf16 v82, s63, v69
    v_dot2c_f32_bf16 v83, s64, v69
    v_dot2c_f32_bf16 v84, s63, v70
    v_dot2c_f32_bf16 v85, s64, v70
    v_dot2c_f32_bf16 v86, s63, v71
    v_dot2c_f32_bf16 v87, s64, v71
    v_add_f32_dpp v80, v80, v80 row_ror:8 row_mask:0xf bank_mask:0xf
    v_add_f32_dpp v81, v81, v81 row_ror:8 row_mask:0xf bank_mask:0xf
    v_add_f32_dpp v82, v82, v82 row_ror:8 row_mask:0xf bank_mask:0xf
    v_add_f32_dpp v83, v83, v83 row_ror:8 row_mask:0xf bank_mask:0xf
    v_add_f32_dpp v84, v84, v84 row_ror:8 row_mask:0xf bank_mask:0xf
    v_add_f32_dpp v85, v85, v85 row_ror:8 row_mask:0xf bank_mask:0xf
    v_add_f32_dpp v86, v86, v86 row_ror:8 row_mask:0xf bank_mask:0xf
    v_add_f32_dpp v87, v87, v87 row_ror:8 row_mask:0xf bank_mask:0xf
    v_mov_b32 v88, v80
    v_mov_b32 v89, v81
    v_mov_b32 v90, v82
    v_mov_b32 v91, v83
    v_mov_b32 v92, v84
    v_mov_b32 v93, v85
    v_mov_b32 v94, v86
    v_mov_b32 v95, v87
    v_permlane16_swap_b32 v80, v88
    v_permlane16_swap_b32 v81, v89
    v_permlane16_swap_b32 v82, v90
    v_permlane16_swap_b32 v83, v91
    v_permlane16_swap_b32 v84, v92
    v_permlane16_swap_b32 v85, v93
    v_permlane16_swap_b32 v86, v94
    v_permlane16_swap_b32 v87, v95
    v_add_f32 v80, v80, v88
    v_add_f32 v81, v81, v89
    v_add_f32 v82, v82, v90
    v_add_f32 v83, v83, v91
    v_add_f32 v84, v84, v92
    v_add_f32 v85, v85, v93
    v_add_f32 v86, v86, v94
    v_add_f32 v87, v87, v95
    v_mov_b32 v88, v80
    v_mov_b32 v89, v81
    v_mov_b32 v90, v82
    v_mov_b32 v91, v83
    v_mov_b32 v92, v84
    v_mov_b32 v93, v85
    v_mov_b32 v94, v86
    v_mov_b32 v95, v87
    v_permlane32_swap_b32 v80, v88
    v_permlane32_swap_b32 v81, v89
    v_permlane32_swap_b32 v82, v90
    v_permlane32_swap_b32 v83, v91
    v_permlane32_swap_b32 v84, v92
    v_permlane32_swap_b32 v85, v93
    v_permlane32_swap_b32 v86, v94
    v_permlane32_swap_b32 v87, v95
    v_add_f32 v80, v80, v88
    v_add_f32 v81, v81, v89
    v_add_f32 v82, v82, v90
    v_add_f32 v83, v83, v91
    v_add_f32 v84, v84, v92
    v_add_f32 v85, v85, v93
    v_add_f32 v86, v86, v94
    v_add_f32 v87, v87, v95
    v_mov_b32 v88, v80
    v_mov_b32 v90, v81
    v_cmp_eq_u32 vcc, 1, v4
    s_nop 1
    v_cndmask_b32 v88, v88, v82, vcc
    v_cndmask_b32 v90, v90, v83, vcc
    v_cmp_eq_u32 vcc, 2, v4
    s_nop 1
    v_cndmask_b32 v88, v88, v84, vcc
    v_cndmask_b32 v90, v90, v85, vcc
    v_cmp_eq_u32 vcc, 3, v4
    s_nop 1
    v_cndmask_b32 v88, v88, v86, vcc
    v_cndmask_b32 v90, v90, v87, vcc
    v_lshlrev_b32 v6, 2, v5
    v_lshl_add_u32 v6, v4, 4, v6
    s_waitcnt vmcnt(0)
    v_readfirstlane_b32 s58, v14
    v_readfirstlane_b32 s59, v15
    s_nop 0
    s_or_b32 s57, s58, s59
    s_cbranch_scc1 H_T2_ok
    s_mov_b32 s57, 0x40000
    v_mov_b32 v4, 0
H_T2_l:
    buffer_load_dwordx2 v[14:15], v4, s[40:43], 0 offen sc1
    s_sub_u32 s57, s57, 1
    s_waitcnt vmcnt(0)
    s_cbranch_scc1 H_T2_ok
    v_readfirstlane_b32 s58, v14
    v_readfirstlane_b32 s59, v15
    s_nop 0
    s_cmp_eq_u64 s[58:59], 0
    s_cbranch_scc1 H_T2_l
H_T2_ok:
    v_mov_b32 v89, s58
    v_mov_b32 v91, s59
    s_mul_i32 s63, s68, 10752
    s_lshl_b32 s64, s69, 9
    s_add_u32 s63, s63, s64
    s_add_u32 s63, s63, 14483456
    s_mov_b32 exec_lo, 0xffffffff
    s_mov_b32 exec_hi, 0x00000000
    buffer_store_dwordx4 v[88:91], v6, s[44:47], s63 offen sc1
    s_mov_b64 exec, -1
    s_barrier
    s_branch B_P2
H_PF:
    s_cmp_lt_u32 s48, 2
    s_cbranch_scc1 H_W
    s_sub_u32 s67, s51, 24
    s_lshl_b32 s67, s67, 1
    s_add_u32 s67, s67, s48
    s_sub_u32 s67, s67, 2
    s_getpc_b64 s[68:69]
CODE_REF:
    s_lshl_b32 s63, s67, 12
    v_lshl_add_u32 v6, v1, 7, s63
    v_min_u32 v6, CODE_END-CODE_REF-4, v6
    v_mov_b32 v9, s69
    v_add_co_u32 v8, vcc, s68, v6
    s_nop 1
    v_addc_co_u32 v9, vcc, 0, v9, vcc
    s_mov_b32 exec_lo, 0xffffffff
    s_mov_b32 exec_hi, 0x00000000
    global_load_dword v25, v[8:9], off
    s_mov_b64 exec, -1
    s_waitcnt lgkmcnt(0)
    s_barrier
    v_lshlrev_b32 v6, 7, v1
    s_and_b32 s63, s2, 7
    s_lshl_b32 s63, s63, 4
    s_add_u32 s63, s63, s67
    s_mul_i32 s63, s63, 57344
    s_branch B_P2
H_W:
    s_waitcnt lgkmcnt(0)
    s_barrier
    s_branch B_P2
A_P1:
    s_load_dwordx2 s[44:45], s[0:1], 80
    s_load_dwordx2 s[40:41], s[0:1], 72
    s_load_dwordx2 s[16:17], s[0:1], 16
    s_load_dwordx2 s[20:21], s[0:1], 32
    s_load_dwordx2 s[24:25], s[0:1], 40
    s_load_dwordx2 s[28:29], s[0:1], 48
    s_load_dwordx2 s[32:33], s[0:1], 56
    s_load_dwordx2 s[36:37], s[0:1], 64
    s_memrealtime s[58:59]
    s_mov_b32 s46, 16777216
    s_mov_b32 s47, 0x20000
    s_mov_b32 s42, 256
    s_mov_b32 s43, 0x20000
    s_mov_b32 s18, 401408
    s_mov_b32 s19, 0x20000
    s_mov_b32 s22, 7340032
    s_mov_b32 s23, 0x20000
    s_mov_b32 s26, 3584
    s_mov_b32 s27, 0x20000
    s_mov_b32 s30, 7340032
    s_mov_b32 s31, 0x20000
    s_mov_b32 s34, 4096
    s_mov_b32 s35, 0x20000
    s_mov_b32 s38, 1835008
    s_mov_b32 s39, 0x20000
    s_mov_b32 s60, 0
    s_mov_b32 s61, -1
    s_mov_b32 s62, 0x3f803f80
    s_mov_b32 s71, 0
    s_mul_i32 s94, s48, 12288
    s_add_u32 s94, s94, 114688
    s_mul_i32 s95, s48, 28672
    s_and_b32 s7, s48, 1
    s_lshl_b32 s68, s7, 15
    s_add_u32 s68, s68, 98304
    s_lshl_b32 s7, s7, 1
    s_lshl_b32 s63, s50, 2
    s_add_u32 s7, s7, s63
    v_and_b32 v4, 31, v1
    v_lshrrev_b32 v5, 5, v1
    v_bfe_u32 v6, v1, 1, 3
    v_xor_b32 v6, v6, v5
    v_lshlrev_b32 v6, 4, v6
    v_lshl_add_u32 v6, v4, 7, v6
    v_add_u32 v6, s68, v6
    v_xor_b32 v88, 0, v6
    v_xor_b32 v89, 32, v6
    v_xor_b32 v90, 64, v6
    v_xor_b32 v91, 96, v6
    v_lshrrev_b32 v92, 5, v1
    v_mul_u32_u24 v92, 1792, v92
    v_bfe_u32 v4, v1, 2, 2
    v_mul_u32_u24 v4, 448, v4
    v_add_u32 v92, v92, v4
    v_bfe_u32 v4, v1, 4, 1
    v_lshl_add_u32 v92, v4, 5, v92
    v_and_b32 v4, 3, v1
    v_lshl_add_u32 v92, v4, 3, v92
    s_lshr_b32 s63, s48, 1
    s_mul_i32 s63, s63, 112
    v_add_u32 v92, s63, v92
    v_add_u32 v93, 50176, v92
    s_waitcnt lgkmcnt(0)
    s_or_b32 s63, s2, s48
    s_cbranch_scc1 P1_NOTAG
    s_bitset1_b32 s59, 31
    v_mov_b32 v8, s58
    v_mov_b32 v9, s59
    v_mov_b32 v10, 0
    v_mov_b32 v11, 0
    s_mov_b64 exec, 1
    buffer_atomic_cmpswap_x2 v[8:11], v10, s[40:43], 0 offen sc1
    s_mov_b64 exec, -1
P1_NOTAG:
    s_bfe_u32 s63, s2, 0x20001
    s_and_b32 s64, s2, 1
    s_sub_u32 s65, 25, s64
    s_cmp_lt_u32 s51, s65
    s_cselect_b32 s56, 1, 0
    s_cselect_b32 s65, s51, 0
    s_mul_i32 s52, s64, 25
    s_add_u32 s65, s65, s52
    s_mul_i32 s53, s65, 9363
    s_lshr_b32 s53, s53, 16
    s_mul_i32 s52, s53, 7
    s_sub_u32 s65, s65, s52
    s_mul_i32 s52, s63, 7
    s_add_u32 s52, s65, s52
    s_cmp_lt_u32 s51, 28
    s_cselect_b32 s65, s51, 0
    s_mul_i32 s54, s64, 28
    s_add_u32 s65, s65, s54
    s_lshr_b32 s55, s65, 3
    s_and_b32 s65, s65, 7
    s_lshl_b32 s54, s63, 3
    s_add_u32 s54, s54, s65
    s_lshl_b32 s63, s92, 2
    s_add_u32 s63, s63, s3
    s_lshl_b32 s63, s63, 4
    s_add_u32 s63, s63, s50
    s_lshl_b32 s63, s63, 7
    s_add_u32 s4, s63, 15204352
    s_and_b32 s63, s2, 7
    s_lshl_b32 s63, s63, 1
    s_and_b32 s49, s51, 1
    s_add_u32 s49, s49, s63
    s_lshr_b32 s50, s51, 1
    s_lshr_b32 s1, s51, 4
    s_add_u32 s1, s1, s63
    s_lshl_b32 s1, s1, 2
    s_add_u32 s1, s1, s48
    s_and_b32 s0, s51, 15
    s_lshl_b32 s63, s2, 3
    s_add_u32 s5, s63, 15335424
    s_lshl_b32 s65, s1, 4
    s_add_u32 s65, s65, s0
    s_lshl_b32 s65, s65, 9
    s_add_u32 s65, s65, 14680064
    v_lshl_add_u32 v4, v1, 7, s65
    v_writelane_b32 v4, s4, 4
    v_writelane_b32 v4, s5, 5
    s_mov_b64 exec, 63
    buffer_load_dword v126, v4, s[44:47], 0 offen sc1
    s_mov_b64 exec, -1
    v_lshrrev_b32 v4, 5, v1
    v_mul_u32_u24 v4, 512, v4
    v_bfe_u32 v5, v1, 2, 2
    v_mul_u32_u24 v5, 128, v5
    v_add_u32 v4, v4, v5
    v_bfe_u32 v5, v1, 4, 1
    v_lshl_add_u32 v4, v5, 5, v4
    v_and_b32 v5, 3, v1
    v_lshl_add_u32 v4, v5, 3, v4
    s_and_b32 s63, s48, 1
    s_lshl_b32 s63, s63, 5
    v_xor_b32 v4, s63, v4
    v_bfe_u32 v5, v1, 3, 1
    s_lshr_b32 s63, s48, 1
    v_xor_b32 v5, s63, v5
    v_lshl_add_u32 v6, v5, 6, v4
    v_xor_b32 v5, 1, v5
    v_lshl_add_u32 v7, v5, 6, v4
    v_add_u32 v240, s95, v6
    v_add_u32 v241, s95, v7
    v_mov_b32 v244, 0x3f80
    v_mov_b32 v245, 1.0
    s_lshl_b32 s63, s49, 2
    s_add_u32 s63, s63, s48
    s_lshl_b32 s63, s63, 16
    s_add_u32 s63, s63, 2097152
    v_add_u32 v243, s63, v2
    v_lshrrev_b32 v248, 5, v1
    v_mul_u32_u24 v248, 256, v248
    v_bfe_u32 v4, v1, 2, 2
    v_mul_u32_u24 v4, 64, v4
    v_add_u32 v248, v248, v4
    v_bfe_u32 v4, v1, 4, 1
    v_lshl_add_u32 v248, v4, 5, v248
    v_and_b32 v4, 3, v1
    v_lshl_add_u32 v248, v4, 3, v248
    v_add_u32 v248, 114688, v248
    v_add_u32 v249, s94, v2
    s_add_u32 s63, s48, 1
    s_and_b32 s63, s63, 3
    s_mul_i32 s63, s63, 12288
    s_add_u32 s63, s63, 114688
    v_add_u32 v250, s63, v2
    s_add_u32 s63, s48, 2
    s_and_b32 s63, s63, 3
    s_mul_i32 s63, s63, 12288
    s_add_u32 s63, s63, 114688
    v_add_u32 v251, s63, v2
    s_add_u32 s63, s48, 3
    s_and_b32 s63, s63, 3
    s_mul_i32 s63, s63, 12288
    s_add_u32 s63, s63, 114688
    v_add_u32 v252, s63, v2
    v_and_b32 v4, 31, v1
    v_lshrrev_b32 v5, 5, v1
    v_lshlrev_b32 v6, 3, v5
    v_sub_u32 v6, v4, v6
    v_cmp_eq_u32 vcc, 0, v6
    v_cmp_eq_u32 s[64:65], 1, v6
    s_nop 0
    v_cndmask_b32 v232, 0, v244, vcc
    v_cndmask_b32 v232, v232, v245, s[64:65]
    v_cmp_eq_u32 vcc, 2, v6
    v_cmp_eq_u32 s[64:65], 3, v6
    s_nop 0
    v_cndmask_b32 v233, 0, v244, vcc
    v_cndmask_b32 v233, v233, v245, s[64:65]
    v_cmp_eq_u32 vcc, 4, v6
    v_cmp_eq_u32 s[64:65], 5, v6
    s_nop 0
    v_cndmask_b32 v234, 0, v244, vcc
    v_cndmask_b32 v234, v234, v245, s[64:65]
    v_cmp_eq_u32 vcc, 6, v6
    v_cmp_eq_u32 s[64:65], 7, v6
    s_nop 0
    v_cndmask_b32 v235, 0, v244, vcc
    v_cndmask_b32 v235, v235, v245, s[64:65]
    v_cmp_eq_u32 vcc, 16, v6
    v_cmp_eq_u32 s[64:65], 17, v6
    s_nop 0
    v_cndmask_b32 v236, 0, v244, vcc
    v_cndmask_b32 v236, v236, v245, s[64:65]
    v_cmp_eq_u32 vcc, 18, v6
    v_cmp_eq_u32 s[64:65], 19, v6
    s_nop 0
    v_cndmask_b32 v237, 0, v244, vcc
    v_cndmask_b32 v237, v237, v245, s[64:65]
    v_cmp_eq_u32 vcc, 20, v6
    v_cmp_eq_u32 s[64:65], 21, v6
    s_nop 0
    v_cndmask_b32 v238, 0, v244, vcc
    v_cndmask_b32 v238, v238, v245, s[64:65]
    v_cmp_eq_u32 vcc, 22, v6
    v_cmp_eq_u32 s[64:65], 23, v6
    s_nop 0
    v_cndmask_b32 v239, 0, v244, vcc
    v_cndmask_b32 v239, v239, v245, s[64:65]
    v_and_b32 v4, 31, v1
    v_lshrrev_b32 v5, 5, v1
    v_mul_u32_u24 v13, 896, v4
    v_lshl_add_u32 v13, v5, 4, v13
    s_lshl_b32 s67, s1, 11
    s_add_u32 s67, s67, 0
    v_add_u32 v10, s67, v2
    v_add_u32 v11, 0x20000, v10
    s_and_b32 s63, s0, 7
    s_lshl_b32 s101, s63, 18
    s_lshl_b32 s63, s63, 1
    v_add_u32 v12, s63, v1
    v_and_b32 v12, 15, v12
    v_lshlrev_b32 v12, 17, v12
    s_add_u32 s63, s67, 2044
    v_add_u32 v12, s63, v12
    v_lshrrev_b32 v4, 3, v1
    v_bfe_u32 v6, v1, 4, 1
    v_lshlrev_b32 v6, 2, v6
    v_and_b32 v246, 7, v1
    v_xor_b32 v6, v246, v6
    v_lshlrev_b32 v6, 4, v6
    v_lshl_add_u32 v4, v4, 12, v6
    s_mul_i32 s63, s48, 1835008
    s_lshl_b32 s64, s54, 7
    s_add_u32 s63, s63, s64
    v_add_u32 v246, s63, v4
    v_add_u32 v247, 31744, v246
    s_bfe_u32 s96, s2, 0x20001
    s_mul_i32 s96, s96, 7
    s_sub_u32 s96, s52, s96
    s_add_u32 s96, s96, s53
    s_add_u32 s96, s96, s53
    s_and_b32 s57, s2, 1
    s_mul_i32 s57, s57, 3
    s_add_u32 s96, s96, s57
    s_and_b32 s96, s96, 7
    s_lshl_b32 s96, s96, 2
    s_lshl_b32 s96, s96, 10
    s_and_b32 s57, s2, 1
    s_lshl_b32 s57, s57, 1
    s_lshl_b32 s97, s55, 1
    s_add_u32 s97, s97, s57
    s_and_b32 s57, s54, 7
    s_add_u32 s97, s97, s57
    s_mul_i32 s57, s97, 37
    s_lshr_b32 s57, s57, 8
    s_mul_i32 s57, s57, 7
    s_sub_u32 s97, s97, s57
    s_lshl_b32 s97, s97, 2
    s_lshl_b32 s97, s97, 10
    s_lshl_b32 s63, s48, 15
    s_add_u32 s63, s63, 0
    s_lshl_b32 s67, s53, 18
    s_add_u32 s67, s67, s63
    v_add_u32 v14, s67, v2
    s_add_u32 s63, s96, 0
    v_lshl_add_u32 v3, v1, 11, s63
    v_and_b32 v3, 0x7fff, v3
    s_add_u32 s63, s67, 2044
    v_add_u32 v3, s63, v3
    s_mul_i32 s63, s48, 28672
    s_add_u32 s63, s63, 2097152
    s_mul_i32 s67, s55, 229376
    s_add_u32 s67, s67, s63
    s_and_b32 s63, s48, 1
    s_lshl_b32 s63, s63, 8
    v_xor_b32 v253, s63, v2
    v_add_u32 v253, s67, v253
    s_add_u32 s63, s97, 0
    v_min_u32 v4, 5, v1
    v_lshl_add_u32 v242, v4, 11, s63
    v_subrev_u32 v4, 28672, v242
    v_min_u32 v242, v242, v4
    s_add_u32 s63, s67, 2044
    v_add_u32 v242, s63, v242
    s_lshl_b32 s100, s52, 2
    s_add_u32 s100, s100, s48
    s_mul_i32 s63, s53, 229376
    s_lshl_b32 s64, s100, 10
    s_add_u32 s63, s63, s64
    s_add_u32 s98, s63, 2097152
    s_lshr_b32 s65, s48, 1
    s_lshl_b32 s63, s54, 1
    s_add_u32 s65, s65, s63
    s_mul_i32 s65, s65, 7
    s_add_u32 s65, s65, s55
    s_lshl_b32 s65, s65, 12
    s_and_b32 s63, s48, 1
    s_lshl_b32 s63, s63, 10
    s_add_u32 s65, s65, s63
    s_add_u32 s99, s65, 8388608
    s_xor_b32 s63, s48, 3
    s_mul_i32 s63, s63, 28672
    s_add_u32 s63, s63, 26624
    v_add_u32 v15, s63, v2
    s_and_b32 s63, s48, 1
    s_lshl_b32 s63, s63, 11
    s_lshr_b32 s65, s48, 1
    s_mul_i32 s70, s65, 224
    v_lshrrev_b32 v5, 5, v1
    v_lshlrev_b32 v5, 4, v5
    v_and_b32 v6, 31, v1
    v_lshlrev_b32 v4, 2, v6
    v_mov_b32 v9, 0
    s_lshl_b32 s64, s92, 1
    s_add_u32 s64, s64, s65
    s_lshl_b32 s64, s64, 7
    s_add_u32 s64, s64, s7
    s_cmp_eq_u32 s3, 2
    s_cbranch_scc1 P1_V
    v_add_u32 v4, s63, v4
    v_add_u32 v5, s70, v5
    s_cmp_eq_u32 s3, 0
    s_cselect_b32 s66, 0, s62
    s_cselect_b32 s67, 0, 0x3f80
    s_cselect_b32 s68, 0, 2097152
    s_add_u32 s69, s3, 11
    s_lshl_b32 s64, s64, s69
    s_add_u32 s64, s64, s68
    s_lshl_b32 s65, 63, s69
    s_lshl_b32 s69, 1, s69
    v_mov_b32 v7, s66
    v_mov_b32 v8, s67
    s_barrier
    ds_read_b128 v[192:195], v88 offset:4096
    ds_read_b64_tr_b16 v[208:209], v92 offset:0
    ds_read_b64_tr_b16 v[210:211], v92 offset:224
    ds_read_b64_tr_b16 v[212:213], v92 offset:56
    ds_read_b64_tr_b16 v[214:215], v92 offset:280
    ds_read_b128 v[196:199], v88 offset:20480
    s_waitcnt lgkmcnt(0)
    v_mfma_f32_32x32x16_bf16 v[128:143], v[208:211], v[192:195], 0
    ds_read_b128 v[200:203], v89 offset:4096
    ds_read_b64_tr_b16 v[216:217], v92 offset:3584
    v_mfma_f32_32x32x16_bf16 v[160:175], v[212:215], v[192:195], 0
    ds_read_b64_tr_b16 v[218:219], v92 offset:3808
    ds_read_b64_tr_b16 v[220:221], v92 offset:3640
    v_mfma_f32_32x32x16_bf16 v[176:191], v[212:215], v[196:199], 0
    ds_read_b64_tr_b16 v[222:223], v92 offset:3864
    ds_read_b128 v[204:207], v89 offset:20480
    v_mfma_f32_32x32x16_bf16 v[144:159], v[208:211], v[196:199], 0
    s_waitcnt lgkmcnt(0)
    v_mfma_f32_32x32x16_bf16 v[128:143], v[216:219], v[200:203], v[128:143]
    ds_read_b128 v[192:195], v90 offset:4096
    ds_read_b64_tr_b16 v[208:209], v92 offset:7168
    v_mfma_f32_32x32x16_bf16 v[160:175], v[220:223], v[200:203], v[160:175]
    ds_read_b64_tr_b16 v[210:211], v92 offset:7392
    ds_read_b64_tr_b16 v[212:213], v92 offset:7224
    v_mfma_f32_32x32x16_bf16 v[176:191], v[220:223], v[204:207], v[176:191]
    ds_read_b64_tr_b16 v[214:215], v92 offset:7448
    ds_read_b128 v[196:199], v90 offset:20480
    v_mfma_f32_32x32x16_bf16 v[144:159], v[216:219], v[204:207], v[144:159]
    s_waitcnt lgkmcnt(0)
    v_mfma_f32_32x32x16_bf16 v[128:143], v[208:211], v[192:195], v[128:143]
    ds_read_b128 v[200:203], v91 offset:4096
    ds_read_b64_tr_b16 v[216:217], v92 offset:10752
    v_mfma_f32_32x32x16_bf16 v[160:175], v[212:215], v[192:195], v[160:175]
    ds_read_b64_tr_b16 v[218:219], v92 offset:10976
    ds_read_b64_tr_b16 v[220:221], v92 offset:10808
    v_mfma_f32_32x32x16_bf16 v[176:191], v[212:215], v[196:199], v[176:191]
    ds_read_b64_tr_b16 v[222:223], v92 offset:11032
    ds_read_b128 v[204:207], v91 offset:20480
    v_mfma_f32_32x32x16_bf16 v[144:159], v[208:211], v[196:199], v[144:159]
    s_waitcnt lgkmcnt(0)
    s_barrier
    v_mfma_f32_32x32x16_bf16 v[128:143], v[216:219], v[200:203], v[128:143]
    ds_read_b128 v[192:195], v88 offset:8192
    ds_read_b64_tr_b16 v[208:209], v92 offset:14336
    v_mfma_f32_32x32x16_bf16 v[160:175], v[220:223], v[200:203], v[160:175]
    ds_read_b64_tr_b16 v[210:211], v92 offset:14560
    ds_read_b64_tr_b16 v[212:213], v92 offset:14392
    v_mfma_f32_32x32x16_bf16 v[176:191], v[220:223], v[204:207], v[176:191]
    ds_read_b64_tr_b16 v[214:215], v92 offset:14616
    ds_read_b128 v[196:199], v88 offset:24576
    v_mfma_f32_32x32x16_bf16 v[144:159], v[216:219], v[204:207], v[144:159]
    s_waitcnt lgkmcnt(0)
    v_mfma_f32_32x32x16_bf16 v[128:143], v[208:211], v[192:195], v[128:143]
    ds_read_b128 v[200:203], v89 offset:8192
    ds_read_b64_tr_b16 v[216:217], v92 offset:17920
    v_mfma_f32_32x32x16_bf16 v[160:175], v[212:215], v[192:195], v[160:175]
    ds_read_b64_tr_b16 v[218:219], v92 offset:18144
    ds_read_b64_tr_b16 v[220:221], v92 offset:17976
    v_mfma_f32_32x32x16_bf16 v[176:191], v[212:215], v[196:199], v[176:191]
    ds_read_b64_tr_b16 v[222:223], v92 offset:18200
    ds_read_b128 v[204:207], v89 offset:24576
    v_mfma_f32_32x32x16_bf16 v[144:159], v[208:211], v[196:199], v[144:159]
    s_waitcnt lgkmcnt(0)
    v_mfma_f32_32x32x16_bf16 v[128:143], v[216:219], v[200:203], v[128:143]
    ds_read_b128 v[192:195], v90 offset:8192
    ds_read_b64_tr_b16 v[208:209], v92 offset:21504
    v_mfma_f32_32x32x16_bf16 v[160:175], v[220:223], v[200:203], v[160:175]
    ds_read_b64_tr_b16 v[210:211], v92 offset:21728
    ds_read_b64_tr_b16 v[212:213], v92 offset:21560
    v_mfma_f32_32x32x16_bf16 v[176:191], v[220:223], v[204:207], v[176:191]
    ds_read_b64_tr_b16 v[214:215], v92 offset:21784
    ds_read_b128 v[196:199], v90 offset:24576
    v_mfma_f32_32x32x16_bf16 v[144:159], v[216:219], v[204:207], v[144:159]
    s_waitcnt lgkmcnt(0)
    v_mfma_f32_32x32x16_bf16 v[128:143], v[208:211], v[192:195], v[128:143]
    ds_read_b128 v[200:203], v91 offset:8192
    ds_read_b64_tr_b16 v[216:217], v92 offset:25088
    v_mfma_f32_32x32x16_bf16 v[160:175], v[212:215], v[192:195], v[160:175]
    ds_read_b64_tr_b16 v[218:219], v92 offset:25312
    ds_read_b64_tr_b16 v[220:221], v92 offset:25144
    v_mfma_f32_32x32x16_bf16 v[176:191], v[212:215], v[196:199], v[176:191]
    ds_read_b64_tr_b16 v[222:223], v92 offset:25368
    ds_read_b128 v[204:207], v91 offset:24576
    v_mfma_f32_32x32x16_bf16 v[144:159], v[208:211], v[196:199], v[144:159]
    s_waitcnt lgkmcnt(0)
    s_barrier
    v_mfma_f32_32x32x16_bf16 v[128:143], v[216:219], v[200:203], v[128:143]
    ds_read_b128 v[192:195], v88 offset:12288
    ds_read_b64_tr_b16 v[208:209], v92 offset:28672
    v_mfma_f32_32x32x16_bf16 v[160:175], v[220:223], v[200:203], v[160:175]
    ds_read_b64_tr_b16 v[210:211], v92 offset:28896
    ds_read_b64_tr_b16 v[212:213], v92 offset:28728
    v_mfma_f32_32x32x16_bf16 v[176:191], v[220:223], v[204:207], v[176:191]
    ds_read_b64_tr_b16 v[214:215], v92 offset:28952
    ds_read_b128 v[196:199], v88 offset:28672
    v_mfma_f32_32x32x16_bf16 v[144:159], v[216:219], v[204:207], v[144:159]
    s_waitcnt lgkmcnt(0)
    v_mfma_f32_32x32x16_bf16 v[128:143], v[208:211], v[192:195], v[128:143]
    ds_read_b128 v[200:203], v89 offset:12288
    ds_read_b64_tr_b16 v[216:217], v92 offset:32256
    v_mfma_f32_32x32x16_bf16 v[160:175], v[212:215], v[192:195], v[160:175]
    ds_read_b64_tr_b16 v[218:219], v92 offset:32480
    ds_read_b64_tr_b16 v[220:221], v92 offset:32312
    v_mfma_f32_32x32x16_bf16 v[176:191], v[212:215], v[196:199], v[176:191]
    ds_read_b64_tr_b16 v[222:223], v92 offset:32536
    ds_read_b128 v[204:207], v89 offset:28672
    v_mfma_f32_32x32x16_bf16 v[144:159], v[208:211], v[196:199], v[144:159]
    s_waitcnt lgkmcnt(0)
    v_mfma_f32_32x32x16_bf16 v[128:143], v[216:219], v[200:203], v[128:143]
    ds_read_b128 v[192:195], v90 offset:12288
    ds_read_b64_tr_b16 v[208:209], v92 offset:35840
    v_mfma_f32_32x32x16_bf16 v[160:175], v[220:223], v[200:203], v[160:175]
    ds_read_b64_tr_b16 v[210:211], v92 offset:36064
    ds_read_b64_tr_b16 v[212:213], v92 offset:35896
    v_mfma_f32_32x32x16_bf16 v[176:191], v[220:223], v[204:207], v[176:191]
    ds_read_b64_tr_b16 v[214:215], v92 offset:36120
    ds_read_b128 v[196:199], v90 offset:28672
    v_mfma_f32_32x32x16_bf16 v[144:159], v[216:219], v[204:207], v[144:159]
    s_waitcnt lgkmcnt(0)
    v_mfma_f32_32x32x16_bf16 v[128:143], v[208:211], v[192:195], v[128:143]
    ds_read_b128 v[200:203], v91 offset:12288
    ds_read_b64_tr_b16 v[216:217], v92 offset:39424
    v_mfma_f32_32x32x16_bf16 v[160:175], v[212:215], v[192:195], v[160:175]
    ds_read_b64_tr_b16 v[218:219], v92 offset:39648
    ds_read_b64_tr_b16 v[220:221], v92 offset:39480
    v_mfma_f32_32x32x16_bf16 v[176:191], v[212:215], v[196:199], v[176:191]
    ds_read_b64_tr_b16 v[222:223], v92 offset:39704
    ds_read_b128 v[204:207], v91 offset:28672
    v_mfma_f32_32x32x16_bf16 v[144:159], v[208:211], v[196:199], v[144:159]
    s_waitcnt lgkmcnt(0)
    s_barrier
    v_mfma_f32_32x32x16_bf16 v[128:143], v[216:219], v[200:203], v[128:143]
    ds_read_b128 v[192:195], v88 offset:0
    ds_read_b64_tr_b16 v[208:209], v92 offset:43008
    v_mfma_f32_32x32x16_bf16 v[160:175], v[220:223], v[200:203], v[160:175]
    ds_read_b64_tr_b16 v[210:211], v92 offset:43232
    ds_read_b64_tr_b16 v[212:213], v92 offset:43064
    v_mfma_f32_32x32x16_bf16 v[176:191], v[220:223], v[204:207], v[176:191]
    ds_read_b64_tr_b16 v[214:215], v92 offset:43288
    ds_read_b128 v[196:199], v88 offset:16384
    v_mfma_f32_32x32x16_bf16 v[144:159], v[216:219], v[204:207], v[144:159]
    s_waitcnt lgkmcnt(0)
    v_mfma_f32_32x32x16_bf16 v[128:143], v[208:211], v[192:195], v[128:143]
    ds_read_b128 v[200:203], v89 offset:0
    ds_read_b64_tr_b16 v[216:217], v92 offset:46592
    v_mfma_f32_32x32x16_bf16 v[160:175], v[212:215], v[192:195], v[160:175]
    ds_read_b64_tr_b16 v[218:219], v92 offset:46816
    ds_read_b64_tr_b16 v[220:221], v92 offset:46648
    v_mfma_f32_32x32x16_bf16 v[176:191], v[212:215], v[196:199], v[176:191]
    ds_read_b64_tr_b16 v[222:223], v92 offset:46872
    ds_read_b128 v[204:207], v89 offset:16384
    v_mfma_f32_32x32x16_bf16 v[144:159], v[208:211], v[196:199], v[144:159]
    s_waitcnt lgkmcnt(0)
    v_mfma_f32_32x32x16_bf16 v[128:143], v[216:219], v[200:203], v[128:143]
    ds_read_b128 v[192:195], v90 offset:0
    ds_read_b64_tr_b16 v[208:209], v93 offset:0
    v_mfma_f32_32x32x16_bf16 v[160:175], v[220:223], v[200:203], v[160:175]
    ds_read_b64_tr_b16 v[210:211], v93 offset:224
    ds_read_b64_tr_b16 v[212:213], v93 offset:56
    v_mfma_f32_32x32x16_bf16 v[176:191], v[220:223], v[204:207], v[176:191]
    ds_read_b64_tr_b16 v[214:215], v93 offset:280
    ds_read_b128 v[196:199], v90 offset:16384
    v_mfma_f32_32x32x16_bf16 v[144:159], v[216:219], v[204:207], v[144:159]
    s_waitcnt lgkmcnt(0)
    v_mfma_f32_32x32x16_bf16 v[128:143], v[208:211], v[192:195], v[128:143]
    ds_read_b128 v[200:203], v91 offset:0
    ds_read_b64_tr_b16 v[216:217], v93 offset:3584
    v_mfma_f32_32x32x16_bf16 v[160:175], v[212:215], v[192:195], v[160:175]
    ds_read_b64_tr_b16 v[218:219], v93 offset:3808
    ds_read_b64_tr_b16 v[220:221], v93 offset:3640
    v_mfma_f32_32x32x16_bf16 v[176:191], v[212:215], v[196:199], v[176:191]
    ds_read_b64_tr_b16 v[222:223], v93 offset:3864
    ds_read_b128 v[204:207], v91 offset:16384
    v_mfma_f32_32x32x16_bf16 v[144:159], v[208:211], v[196:199], v[144:159]
    s_waitcnt lgkmcnt(0)
    s_barrier
    v_mfma_f32_32x32x16_bf16 v[128:143], v[216:219], v[200:203], v[128:143]
    ds_read_b128 v[192:195], v88 offset:4096
    ds_read_b64_tr_b16 v[208:209], v93 offset:7168
    v_mfma_f32_32x32x16_bf16 v[160:175], v[220:223], v[200:203], v[160:175]
    ds_read_b64_tr_b16 v[210:211], v93 offset:7392
    ds_read_b64_tr_b16 v[212:213], v93 offset:7224
    v_mfma_f32_32x32x16_bf16 v[176:191], v[220:223], v[204:207], v[176:191]
    ds_read_b64_tr_b16 v[214:215], v93 offset:7448
    ds_read_b128 v[196:199], v88 offset:20480
    v_mfma_f32_32x32x16_bf16 v[144:159], v[216:219], v[204:207], v[144:159]
    s_waitcnt lgkmcnt(0)
    buffer_load_dwordx2 v[94:95], v9, s[40:43], 0 offen sc1
    v_mfma_f32_32x32x16_bf16 v[128:143], v[208:211], v[192:195], v[128:143]
    ds_read_b128 v[200:203], v89 offset:4096
    ds_read_b64_tr_b16 v[216:217], v93 offset:10752
    v_mfma_f32_32x32x16_bf16 v[160:175], v[212:215], v[192:195], v[160:175]
    ds_read_b64_tr_b16 v[218:219], v93 offset:10976
    ds_read_b64_tr_b16 v[220:221], v93 offset:10808
    v_mfma_f32_32x32x16_bf16 v[176:191], v[212:215], v[196:199], v[176:191]
    ds_read_b64_tr_b16 v[222:223], v93 offset:11032
    ds_read_b128 v[204:207], v89 offset:20480
    v_mfma_f32_32x32x16_bf16 v[144:159], v[208:211], v[196:199], v[144:159]
    s_waitcnt lgkmcnt(0)
    v_mfma_f32_32x32x16_bf16 v[128:143], v[216:219], v[200:203], v[128:143]
    ds_read_b128 v[192:195], v90 offset:4096
    ds_read_b64_tr_b16 v[208:209], v93 offset:14336
    v_mfma_f32_32x32x16_bf16 v[160:175], v[220:223], v[200:203], v[160:175]
    ds_read_b64_tr_b16 v[210:211], v93 offset:14560
    ds_read_b64_tr_b16 v[212:213], v93 offset:14392
    v_mfma_f32_32x32x16_bf16 v[176:191], v[220:223], v[204:207], v[176:191]
    ds_read_b64_tr_b16 v[214:215], v93 offset:14616
    ds_read_b128 v[196:199], v90 offset:20480
    v_mfma_f32_32x32x16_bf16 v[144:159], v[216:219], v[204:207], v[144:159]
    s_waitcnt lgkmcnt(0)
    v_mfma_f32_32x32x16_bf16 v[128:143], v[208:211], v[192:195], v[128:143]
    ds_read_b128 v[200:203], v91 offset:4096
    ds_read_b64_tr_b16 v[216:217], v93 offset:17920
    v_mfma_f32_32x32x16_bf16 v[160:175], v[212:215], v[192:195], v[160:175]
    ds_read_b64_tr_b16 v[218:219], v93 offset:18144
    ds_read_b64_tr_b16 v[220:221], v93 offset:17976
    v_mfma_f32_32x32x16_bf16 v[176:191], v[212:215], v[196:199], v[176:191]
    ds_read_b64_tr_b16 v[222:223], v93 offset:18200
    ds_read_b128 v[204:207], v91 offset:20480
    v_mfma_f32_32x32x16_bf16 v[144:159], v[208:211], v[196:199], v[144:159]
    s_waitcnt lgkmcnt(0)
    s_barrier
    v_mfma_f32_32x32x16_bf16 v[128:143], v[216:219], v[200:203], v[128:143]
    ds_read_b128 v[192:195], v88 offset:8192
    ds_read_b64_tr_b16 v[208:209], v93 offset:21504
    v_mfma_f32_32x32x16_bf16 v[160:175], v[220:223], v[200:203], v[160:175]
    ds_read_b64_tr_b16 v[210:211], v93 offset:21728
    ds_read_b64_tr_b16 v[212:213], v93 offset:21560
    v_mfma_f32_32x32x16_bf16 v[176:191], v[220:223], v[204:207], v[176:191]
    ds_read_b64_tr_b16 v[214:215], v93 offset:21784
    ds_read_b128 v[196:199], v88 offset:24576
    v_mfma_f32_32x32x16_bf16 v[144:159], v[216:219], v[204:207], v[144:159]
    s_waitcnt lgkmcnt(0)
    v_mfma_f32_32x32x16_bf16 v[128:143], v[208:211], v[192:195], v[128:143]
    ds_read_b128 v[200:203], v89 offset:8192
    ds_read_b64_tr_b16 v[216:217], v93 offset:25088
    v_mfma_f32_32x32x16_bf16 v[160:175], v[212:215], v[192:195], v[160:175]
    ds_read_b64_tr_b16 v[218:219], v93 offset:25312
    ds_read_b64_tr_b16 v[220:221], v93 offset:25144
    v_mfma_f32_32x32x16_bf16 v[176:191], v[212:215], v[196:199], v[176:191]
    ds_read_b64_tr_b16 v[222:223], v93 offset:25368
    ds_read_b128 v[204:207], v89 offset:24576
    v_mfma_f32_32x32x16_bf16 v[144:159], v[208:211], v[196:199], v[144:159]
    s_waitcnt lgkmcnt(0)
    v_mfma_f32_32x32x16_bf16 v[128:143], v[216:219], v[200:203], v[128:143]
    ds_read_b128 v[192:195], v90 offset:8192
    ds_read_b64_tr_b16 v[208:209], v93 offset:28672
    v_mfma_f32_32x32x16_bf16 v[160:175], v[220:223], v[200:203], v[160:175]
    ds_read_b64_tr_b16 v[210:211], v93 offset:28896
    ds_read_b64_tr_b16 v[212:213], v93 offset:28728
    v_mfma_f32_32x32x16_bf16 v[176:191], v[220:223], v[204:207], v[176:191]
    ds_read_b64_tr_b16 v[214:215], v93 offset:28952
    ds_read_b128 v[196:199], v90 offset:24576
    v_mfma_f32_32x32x16_bf16 v[144:159], v[216:219], v[204:207], v[144:159]
    s_waitcnt lgkmcnt(0)
    v_mfma_f32_32x32x16_bf16 v[128:143], v[208:211], v[192:195], v[128:143]
    ds_read_b128 v[200:203], v91 offset:8192
    ds_read_b64_tr_b16 v[216:217], v93 offset:32256
    v_mfma_f32_32x32x16_bf16 v[160:175], v[212:215], v[192:195], v[160:175]
    ds_read_b64_tr_b16 v[218:219], v93 offset:32480
    ds_read_b64_tr_b16 v[220:221], v93 offset:32312
    v_mfma_f32_32x32x16_bf16 v[176:191], v[212:215], v[196:199], v[176:191]
    ds_read_b64_tr_b16 v[222:223], v93 offset:32536
    ds_read_b128 v[204:207], v91 offset:24576
    v_mfma_f32_32x32x16_bf16 v[144:159], v[208:211], v[196:199], v[144:159]
    s_waitcnt lgkmcnt(0)
    s_barrier
    v_mfma_f32_32x32x16_bf16 v[128:143], v[216:219], v[200:203], v[128:143]
    ds_read_b128 v[192:195], v88 offset:12288
    ds_read_b64_tr_b16 v[208:209], v93 offset:35840
    v_mfma_f32_32x32x16_bf16 v[160:175], v[220:223], v[200:203], v[160:175]
    ds_read_b64_tr_b16 v[210:211], v93 offset:36064
    ds_read_b64_tr_b16 v[212:213], v93 offset:35896
    v_mfma_f32_32x32x16_bf16 v[176:191], v[220:223], v[204:207], v[176:191]
    ds_read_b64_tr_b16 v[214:215], v93 offset:36120
    ds_read_b128 v[196:199], v88 offset:28672
    v_mfma_f32_32x32x16_bf16 v[144:159], v[216:219], v[204:207], v[144:159]
    ds_read_b32 v112, v4 offset:512
    ds_read_b32 v114, v4 offset:640
    s_waitcnt lgkmcnt(2)
    v_mfma_f32_32x32x16_bf16 v[128:143], v[208:211], v[192:195], v[128:143]
    ds_read_b128 v[200:203], v89 offset:12288
    ds_read_b64_tr_b16 v[216:217], v93 offset:39424
    v_mfma_f32_32x32x16_bf16 v[160:175], v[212:215], v[192:195], v[160:175]
    ds_read_b64_tr_b16 v[218:219], v93 offset:39648
    ds_read_b64_tr_b16 v[220:221], v93 offset:39480
    v_mfma_f32_32x32x16_bf16 v[176:191], v[212:215], v[196:199], v[176:191]
    ds_read_b64_tr_b16 v[222:223], v93 offset:39704
    ds_read_b128 v[204:207], v89 offset:28672
    v_mfma_f32_32x32x16_bf16 v[144:159], v[208:211], v[196:199], v[144:159]
    ds_read_b32 v116, v4 offset:1536
    ds_read_b32 v118, v4 offset:1664
    s_waitcnt lgkmcnt(2)
    v_mfma_f32_32x32x16_bf16 v[128:143], v[216:219], v[200:203], v[128:143]
    ds_read_b128 v[192:195], v90 offset:12288
    ds_read_b64_tr_b16 v[208:209], v93 offset:43008
    v_mfma_f32_32x32x16_bf16 v[160:175], v[220:223], v[200:203], v[160:175]
    ds_read_b64_tr_b16 v[210:211], v93 offset:43232
    ds_read_b64_tr_b16 v[212:213], v93 offset:43064
    v_mfma_f32_32x32x16_bf16 v[176:191], v[220:223], v[204:207], v[176:191]
    ds_read_b64_tr_b16 v[214:215], v93 offset:43288
    ds_read_b128 v[196:199], v90 offset:28672
    v_mfma_f32_32x32x16_bf16 v[144:159], v[216:219], v[204:207], v[144:159]
    ds_read_b128 v[16:19], v5 offset:0
    ds_read_b128 v[20:23], v5 offset:32
    s_waitcnt lgkmcnt(2)
    v_mfma_f32_32x32x16_bf16 v[128:143], v[208:211], v[192:195], v[128:143]
    ds_read_b128 v[200:203], v91 offset:12288
    ds_read_b64_tr_b16 v[216:217], v93 offset:46592
    v_mfma_f32_32x32x16_bf16 v[160:175], v[212:215], v[192:195], v[160:175]
    ds_read_b64_tr_b16 v[218:219], v93 offset:46816
    ds_read_b64_tr_b16 v[220:221], v93 offset:46648
    v_mfma_f32_32x32x16_bf16 v[176:191], v[212:215], v[196:199], v[176:191]
    ds_read_b64_tr_b16 v[222:223], v93 offset:46872
    ds_read_b128 v[204:207], v91 offset:28672
    v_mfma_f32_32x32x16_bf16 v[144:159], v[208:211], v[196:199], v[144:159]
    ds_read_b128 v[24:27], v5 offset:64
    ds_read_b128 v[28:31], v5 offset:96
    s_waitcnt lgkmcnt(2)
    v_mfma_f32_32x32x16_bf16 v[128:143], v[216:219], v[200:203], v[128:143]
    ds_read_b128 v[32:35], v5 offset:112
    ds_read_b128 v[36:39], v5 offset:144
    ds_read_b128 v[40:43], v5 offset:176
    v_mfma_f32_32x32x16_bf16 v[160:175], v[220:223], v[200:203], v[160:175]
    ds_read_b128 v[44:47], v5 offset:208
    v_mfma_f32_32x32x16_bf16 v[176:191], v[220:223], v[204:207], v[176:191]
    v_mfma_f32_32x32x16_bf16 v[144:159], v[216:219], v[204:207], v[144:159]
    s_waitcnt lgkmcnt(0)
    v_pk_mul_f32 v[64:65], v[16:17], v[114:115] op_sel_hi:[1,0]
    v_pk_mul_f32 v[66:67], v[18:19], v[114:115] op_sel_hi:[1,0]
    v_pk_mul_f32 v[68:69], v[20:21], v[114:115] op_sel_hi:[1,0]
    v_pk_mul_f32 v[70:71], v[22:23], v[114:115] op_sel_hi:[1,0]
    v_pk_mul_f32 v[72:73], v[24:25], v[114:115] op_sel_hi:[1,0]
    v_pk_mul_f32 v[74:75], v[26:27], v[114:115] op_sel_hi:[1,0]
    v_pk_mul_f32 v[76:77], v[28:29], v[114:115] op_sel_hi:[1,0]
    v_pk_mul_f32 v[78:79], v[30:31], v[114:115] op_sel_hi:[1,0]
    v_pk_fma_f32 v[128:129], v[128:129], v[112:113], v[64:65] op_sel_hi:[1,0,1]
    v_pk_fma_f32 v[130:131], v[130:131], v[112:113], v[66:67] op_sel_hi:[1,0,1]
    v_pk_fma_f32 v[132:133], v[132:133], v[112:113], v[68:69] op_sel_hi:[1,0,1]
    v_pk_fma_f32 v[134:135], v[134:135], v[112:113], v[70:71] op_sel_hi:[1,0,1]
    v_pk_fma_f32 v[136:137], v[136:137], v[112:113], v[72:73] op_sel_hi:[1,0,1]
    v_pk_fma_f32 v[138:139], v[138:139], v[112:113], v[74:75] op_sel_hi:[1,0,1]
    v_pk_fma_f32 v[140:141], v[140:141], v[112:113], v[76:77] op_sel_hi:[1,0,1]
    v_pk_fma_f32 v[142:143], v[142:143], v[112:113], v[78:79] op_sel_hi:[1,0,1]
    v_cvt_pk_bf16_f32 v96, v128, v129
    v_cvt_pk_bf16_f32 v97, v130, v131
    v_cvt_pk_bf16_f32 v98, v132, v133
    v_cvt_pk_bf16_f32 v99, v134, v135
    v_cvt_pk_bf16_f32 v100, v136, v137
    v_cvt_pk_bf16_f32 v101, v138, v139
    v_cvt_pk_bf16_f32 v102, v140, v141
    v_cvt_pk_bf16_f32 v103, v142, v143
    v_cndmask_b32 v102, v102, v7, s[60:61]
    v_cndmask_b32 v103, v103, v8, s[60:61]
    v_and_b32 v99, 0xfffefffe, v99
    v_and_b32 v103, 0xfffefffe, v103
    buffer_store_dwordx4 v[96:99], v2, s[44:47], s64 offen offset:0 sc1
    buffer_store_dwordx4 v[100:103], v2, s[44:47], s64 offen offset:1024 sc1
    s_add_u32 s64, s64, s69
    v_pk_mul_f32 v[64:65], v[16:17], v[118:119] op_sel_hi:[1,0]
    v_pk_mul_f32 v[66:67], v[18:19], v[118:119] op_sel_hi:[1,0]
    v_pk_mul_f32 v[68:69], v[20:21], v[118:119] op_sel_hi:[1,0]
    v_pk_mul_f32 v[70:71], v[22:23], v[118:119] op_sel_hi:[1,0]
    v_pk_mul_f32 v[72:73], v[24:25], v[118:119] op_sel_hi:[1,0]
    v_pk_mul_f32 v[74:75], v[26:27], v[118:119] op_sel_hi:[1,0]
    v_pk_mul_f32 v[76:77], v[28:29], v[118:119] op_sel_hi:[1,0]
    v_pk_mul_f32 v[78:79], v[30:31], v[118:119] op_sel_hi:[1,0]
    v_pk_fma_f32 v[144:145], v[144:145], v[116:117], v[64:65] op_sel_hi:[1,0,1]
    v_pk_fma_f32 v[146:147], v[146:147], v[116:117], v[66:67] op_sel_hi:[1,0,1]
    v_pk_fma_f32 v[148:149], v[148:149], v[116:117], v[68:69] op_sel_hi:[1,0,1]
    v_pk_fma_f32 v[150:151], v[150:151], v[116:117], v[70:71] op_sel_hi:[1,0,1]
    v_pk_fma_f32 v[152:153], v[152:153], v[116:117], v[72:73] op_sel_hi:[1,0,1]
    v_pk_fma_f32 v[154:155], v[154:155], v[116:117], v[74:75] op_sel_hi:[1,0,1]
    v_pk_fma_f32 v[156:157], v[156:157], v[116:117], v[76:77] op_sel_hi:[1,0,1]
    v_pk_fma_f32 v[158:159], v[158:159], v[116:117], v[78:79] op_sel_hi:[1,0,1]
    v_cvt_pk_bf16_f32 v104, v144, v145
    v_cvt_pk_bf16_f32 v105, v146, v147
    v_cvt_pk_bf16_f32 v106, v148, v149
    v_cvt_pk_bf16_f32 v107, v150, v151
    v_cvt_pk_bf16_f32 v108, v152, v153
    v_cvt_pk_bf16_f32 v109, v154, v155
    v_cvt_pk_bf16_f32 v110, v156, v157
    v_cvt_pk_bf16_f32 v111, v158, v159
    v_cndmask_b32 v110, v110, v7, s[60:61]
    v_cndmask_b32 v111, v111, v8, s[60:61]
    v_and_b32 v107, 0xfffefffe, v107
    v_and_b32 v111, 0xfffefffe, v111
    buffer_store_dwordx4 v[104:107], v2, s[44:47], s64 offen offset:0 sc1
    buffer_store_dwordx4 v[108:111], v2, s[44:47], s64 offen offset:1024 sc1
    s_add_u32 s64, s64, s65
    v_pk_mul_f32 v[64:65], v[32:33], v[114:115] op_sel_hi:[1,0]
    v_pk_mul_f32 v[66:67], v[34:35], v[114:115] op_sel_hi:[1,0]
    v_pk_mul_f32 v[68:69], v[36:37], v[114:115] op_sel_hi:[1,0]
    v_pk_mul_f32 v[70:71], v[38:39], v[114:115] op_sel_hi:[1,0]
    v_pk_mul_f32 v[72:73], v[40:41], v[114:115] op_sel_hi:[1,0]
    v_pk_mul_f32 v[74:75], v[42:43], v[114:115] op_sel_hi:[1,0]
    v_pk_mul_f32 v[76:77], v[44:45], v[114:115] op_sel_hi:[1,0]
    v_pk_mul_f32 v[78:79], v[46:47], v[114:115] op_sel_hi:[1,0]
    v_pk_fma_f32 v[160:161], v[160:161], v[112:113], v[64:65] op_sel_hi:[1,0,1]
    v_pk_fma_f32 v[162:163], v[162:163], v[112:113], v[66:67] op_sel_hi:[1,0,1]
    v_pk_fma_f32 v[164:165], v[164:165], v[112:113], v[68:69] op_sel_hi:[1,0,1]
    v_pk_fma_f32 v[166:167], v[166:167], v[112:113], v[70:71] op_sel_hi:[1,0,1]
    v_pk_fma_f32 v[168:169], v[168:169], v[112:113], v[72:73] op_sel_hi:[1,0,1]
    v_pk_fma_f32 v[170:171], v[170:171], v[112:113], v[74:75] op_sel_hi:[1,0,1]
    v_pk_fma_f32 v[172:173], v[172:173], v[112:113], v[76:77] op_sel_hi:[1,0,1]
    v_pk_fma_f32 v[174:175], v[174:175], v[112:113], v[78:79] op_sel_hi:[1,0,1]
    v_cvt_pk_bf16_f32 v96, v160, v161
    v_cvt_pk_bf16_f32 v97, v162, v163
    v_cvt_pk_bf16_f32 v98, v164, v165
    v_cvt_pk_bf16_f32 v99, v166, v167
    v_cvt_pk_bf16_f32 v100, v168, v169
    v_cvt_pk_bf16_f32 v101, v170, v171
    v_cvt_pk_bf16_f32 v102, v172, v173
    v_cvt_pk_bf16_f32 v103, v174, v175
    v_cndmask_b32 v102, v102, v7, s[60:61]
    v_cndmask_b32 v103, v103, v8, s[60:61]
    v_and_b32 v99, 0xfffefffe, v99
    v_and_b32 v103, 0xfffefffe, v103
    buffer_store_dwordx4 v[96:99], v2, s[44:47], s64 offen offset:0 sc1
    buffer_store_dwordx4 v[100:103], v2, s[44:47], s64 offen offset:1024 sc1
    s_add_u32 s64, s64, s69
    v_pk_mul_f32 v[64:65], v[32:33], v[118:119] op_sel_hi:[1,0]
    v_pk_mul_f32 v[66:67], v[34:35], v[118:119] op_sel_hi:[1,0]
    v_pk_mul_f32 v[68:69], v[36:37], v[118:119] op_sel_hi:[1,0]
    v_pk_mul_f32 v[70:71], v[38:39], v[118:119] op_sel_hi:[1,0]
    v_pk_mul_f32 v[72:73], v[40:41], v[118:119] op_sel_hi:[1,0]
    v_pk_mul_f32 v[74:75], v[42:43], v[118:119] op_sel_hi:[1,0]
    v_pk_mul_f32 v[76:77], v[44:45], v[118:119] op_sel_hi:[1,0]
    v_pk_mul_f32 v[78:79], v[46:47], v[118:119] op_sel_hi:[1,0]
    v_pk_fma_f32 v[176:177], v[176:177], v[116:117], v[64:65] op_sel_hi:[1,0,1]
    v_pk_fma_f32 v[178:179], v[178:179], v[116:117], v[66:67] op_sel_hi:[1,0,1]
    v_pk_fma_f32 v[180:181], v[180:181], v[116:117], v[68:69] op_sel_hi:[1,0,1]
    v_pk_fma_f32 v[182:183], v[182:183], v[116:117], v[70:71] op_sel_hi:[1,0,1]
    v_pk_fma_f32 v[184:185], v[184:185], v[116:117], v[72:73] op_sel_hi:[1,0,1]
    v_pk_fma_f32 v[186:187], v[186:187], v[116:117], v[74:75] op_sel_hi:[1,0,1]
    v_pk_fma_f32 v[188:189], v[188:189], v[116:117], v[76:77] op_sel_hi:[1,0,1]
    v_pk_fma_f32 v[190:191], v[190:191], v[116:117], v[78:79] op_sel_hi:[1,0,1]
    v_cvt_pk_bf16_f32 v104, v176, v177
    v_cvt_pk_bf16_f32 v105, v178, v179
    v_cvt_pk_bf16_f32 v106, v180, v181
    v_cvt_pk_bf16_f32 v107, v182, v183
    v_cvt_pk_bf16_f32 v108, v184, v185
    v_cvt_pk_bf16_f32 v109, v186, v187
    v_cvt_pk_bf16_f32 v110, v188, v189
    v_cvt_pk_bf16_f32 v111, v190, v191
    v_cndmask_b32 v110, v110, v7, s[60:61]
    v_cndmask_b32 v111, v111, v8, s[60:61]
    v_and_b32 v107, 0xfffefffe, v107
    v_and_b32 v111, 0xfffefffe, v111
    buffer_store_dwordx4 v[104:107], v2, s[44:47], s64 offen offset:0 sc1
    buffer_store_dwordx4 v[108:111], v2, s[44:47], s64 offen offset:1024 sc1
    s_branch P1_DONE
P1_V:
    v_add_u32 v4, s70, v4
    v_add_u32 v5, s63, v5
    s_lshl_b32 s64, s64, 12
    s_add_u32 s64, s64, 2099200
    s_mov_b32 s69, 4096
    s_mov_b32 s65, 258048
    s_mov_b32 s66, 0x0fffffff
    s_mov_b32 s67, 0x0fffffff
    v_cmp_eq_u32 vcc, 28, v6
    v_mov_b32 v7, s62
    s_nop 0
    v_cndmask_b32 v8, 0, v7, vcc
    v_mov_b32 v96, v8
    v_mov_b32 v97, v8
    v_mov_b32 v98, v8
    v_mov_b32 v99, v8
    v_mov_b32 v100, v8
    v_mov_b32 v101, v8
    v_mov_b32 v102, v8
    v_mov_b32 v103, v8
    v_mov_b32 v104, v8
    v_mov_b32 v105, v8
    v_mov_b32 v106, v8
    v_mov_b32 v107, v8
    v_mov_b32 v108, v8
    v_mov_b32 v109, v8
    v_mov_b32 v110, v8
    v_mov_b32 v111, v8
    s_barrier
    ds_read_b128 v[192:195], v88 offset:4096
    ds_read_b64_tr_b16 v[208:209], v92 offset:0
    ds_read_b64_tr_b16 v[210:211], v92 offset:224
    ds_read_b64_tr_b16 v[212:213], v92 offset:56
    ds_read_b64_tr_b16 v[214:215], v92 offset:280
    ds_read_b128 v[196:199], v88 offset:20480
    s_waitcnt lgkmcnt(0)
    v_mfma_f32_32x32x16_bf16 v[128:143], v[192:195], v[208:211], 0
    ds_read_b128 v[200:203], v89 offset:4096
    ds_read_b64_tr_b16 v[216:217], v92 offset:3584
    v_mfma_f32_32x32x16_bf16 v[160:175], v[192:195], v[212:215], 0
    ds_read_b64_tr_b16 v[218:219], v92 offset:3808
    ds_read_b64_tr_b16 v[220:221], v92 offset:3640
    v_mfma_f32_32x32x16_bf16 v[176:191], v[196:199], v[212:215], 0
    ds_read_b64_tr_b16 v[222:223], v92 offset:3864
    ds_read_b128 v[204:207], v89 offset:20480
    v_mfma_f32_32x32x16_bf16 v[144:159], v[196:199], v[208:211], 0
    s_waitcnt lgkmcnt(0)
    v_mfma_f32_32x32x16_bf16 v[128:143], v[200:203], v[216:219], v[128:143]
    ds_read_b128 v[192:195], v90 offset:4096
    ds_read_b64_tr_b16 v[208:209], v92 offset:7168
    v_mfma_f32_32x32x16_bf16 v[160:175], v[200:203], v[220:223], v[160:175]
    ds_read_b64_tr_b16 v[210:211], v92 offset:7392
    ds_read_b64_tr_b16 v[212:213], v92 offset:7224
    v_mfma_f32_32x32x16_bf16 v[176:191], v[204:207], v[220:223], v[176:191]
    ds_read_b64_tr_b16 v[214:215], v92 offset:7448
    ds_read_b128 v[196:199], v90 offset:20480
    v_mfma_f32_32x32x16_bf16 v[144:159], v[204:207], v[216:219], v[144:159]
    s_waitcnt lgkmcnt(0)
    v_mfma_f32_32x32x16_bf16 v[128:143], v[192:195], v[208:211], v[128:143]
    ds_read_b128 v[200:203], v91 offset:4096
    ds_read_b64_tr_b16 v[216:217], v92 offset:10752
    v_mfma_f32_32x32x16_bf16 v[160:175], v[192:195], v[212:215], v[160:175]
    ds_read_b64_tr_b16 v[218:219], v92 offset:10976
    ds_read_b64_tr_b16 v[220:221], v92 offset:10808
    v_mfma_f32_32x32x16_bf16 v[176:191], v[196:199], v[212:215], v[176:191]
    ds_read_b64_tr_b16 v[222:223], v92 offset:11032
    ds_read_b128 v[204:207], v91 offset:20480
    v_mfma_f32_32x32x16_bf16 v[144:159], v[196:199], v[208:211], v[144:159]
    s_waitcnt lgkmcnt(0)
    s_barrier
    v_mfma_f32_32x32x16_bf16 v[128:143], v[200:203], v[216:219], v[128:143]
    ds_read_b128 v[192:195], v88 offset:8192
    ds_read_b64_tr_b16 v[208:209], v92 offset:14336
    v_mfma_f32_32x32x16_bf16 v[160:175], v[200:203], v[220:223], v[160:175]
    ds_read_b64_tr_b16 v[210:211], v92 offset:14560
    ds_read_b64_tr_b16 v[212:213], v92 offset:14392
    v_mfma_f32_32x32x16_bf16 v[176:191], v[204:207], v[220:223], v[176:191]
    ds_read_b64_tr_b16 v[214:215], v92 offset:14616
    ds_read_b128 v[196:199], v88 offset:24576
    v_mfma_f32_32x32x16_bf16 v[144:159], v[204:207], v[216:219], v[144:159]
    s_waitcnt lgkmcnt(0)
    v_mfma_f32_32x32x16_bf16 v[128:143], v[192:195], v[208:211], v[128:143]
    ds_read_b128 v[200:203], v89 offset:8192
    ds_read_b64_tr_b16 v[216:217], v92 offset:17920
    v_mfma_f32_32x32x16_bf16 v[160:175], v[192:195], v[212:215], v[160:175]
    ds_read_b64_tr_b16 v[218:219], v92 offset:18144
    ds_read_b64_tr_b16 v[220:221], v92 offset:17976
    v_mfma_f32_32x32x16_bf16 v[176:191], v[196:199], v[212:215], v[176:191]
    ds_read_b64_tr_b16 v[222:223], v92 offset:18200
    ds_read_b128 v[204:207], v89 offset:24576
    v_mfma_f32_32x32x16_bf16 v[144:159], v[196:199], v[208:211], v[144:159]
    s_waitcnt lgkmcnt(0)
    v_mfma_f32_32x32x16_bf16 v[128:143], v[200:203], v[216:219], v[128:143]
    ds_read_b128 v[192:195], v90 offset:8192
    ds_read_b64_tr_b16 v[208:209], v92 offset:21504
    v_mfma_f32_32x32x16_bf16 v[160:175], v[200:203], v[220:223], v[160:175]
    ds_read_b64_tr_b16 v[210:211], v92 offset:21728
    ds_read_b64_tr_b16 v[212:213], v92 offset:21560
    v_mfma_f32_32x32x16_bf16 v[176:191], v[204:207], v[220:223], v[176:191]
    ds_read_b64_tr_b16 v[214:215], v92 offset:21784
    ds_read_b128 v[196:199], v90 offset:24576
    v_mfma_f32_32x32x16_bf16 v[144:159], v[204:207], v[216:219], v[144:159]
    s_waitcnt lgkmcnt(0)
    v_mfma_f32_32x32x16_bf16 v[128:143], v[192:195], v[208:211], v[128:143]
    ds_read_b128 v[200:203], v91 offset:8192
    ds_read_b64_tr_b16 v[216:217], v92 offset:25088
    v_mfma_f32_32x32x16_bf16 v[160:175], v[192:195], v[212:215], v[160:175]
    ds_read_b64_tr_b16 v[218:219], v92 offset:25312
    ds_read_b64_tr_b16 v[220:221], v92 offset:25144
    v_mfma_f32_32x32x16_bf16 v[176:191], v[196:199], v[212:215], v[176:191]
    ds_read_b64_tr_b16 v[222:223], v92 offset:25368
    ds_read_b128 v[204:207], v91 offset:24576
    v_mfma_f32_32x32x16_bf16 v[144:159], v[196:199], v[208:211], v[144:159]
    s_waitcnt lgkmcnt(0)
    s_barrier
    v_mfma_f32_32x32x16_bf16 v[128:143], v[200:203], v[216:219], v[128:143]
    ds_read_b128 v[192:195], v88 offset:12288
    ds_read_b64_tr_b16 v[208:209], v92 offset:28672
    v_mfma_f32_32x32x16_bf16 v[160:175], v[200:203], v[220:223], v[160:175]
    ds_read_b64_tr_b16 v[210:211], v92 offset:28896
    ds_read_b64_tr_b16 v[212:213], v92 offset:28728
    v_mfma_f32_32x32x16_bf16 v[176:191], v[204:207], v[220:223], v[176:191]
    ds_read_b64_tr_b16 v[214:215], v92 offset:28952
    ds_read_b128 v[196:199], v88 offset:28672
    v_mfma_f32_32x32x16_bf16 v[144:159], v[204:207], v[216:219], v[144:159]
    s_waitcnt lgkmcnt(0)
    v_mfma_f32_32x32x16_bf16 v[128:143], v[192:195], v[208:211], v[128:143]
    ds_read_b128 v[200:203], v89 offset:12288
    ds_read_b64_tr_b16 v[216:217], v92 offset:32256
    v_mfma_f32_32x32x16_bf16 v[160:175], v[192:195], v[212:215], v[160:175]
    ds_read_b64_tr_b16 v[218:219], v92 offset:32480
    ds_read_b64_tr_b16 v[220:221], v92 offset:32312
    v_mfma_f32_32x32x16_bf16 v[176:191], v[196:199], v[212:215], v[176:191]
    ds_read_b64_tr_b16 v[222:223], v92 offset:32536
    ds_read_b128 v[204:207], v89 offset:28672
    v_mfma_f32_32x32x16_bf16 v[144:159], v[196:199], v[208:211], v[144:159]
    s_waitcnt lgkmcnt(0)
    v_mfma_f32_32x32x16_bf16 v[128:143], v[200:203], v[216:219], v[128:143]
    ds_read_b128 v[192:195], v90 offset:12288
    ds_read_b64_tr_b16 v[208:209], v92 offset:35840
    v_mfma_f32_32x32x16_bf16 v[160:175], v[200:203], v[220:223], v[160:175]
    ds_read_b64_tr_b16 v[210:211], v92 offset:36064
    ds_read_b64_tr_b16 v[212:213], v92 offset:35896
    v_mfma_f32_32x32x16_bf16 v[176:191], v[204:207], v[220:223], v[176:191]
    ds_read_b64_tr_b16 v[214:215], v92 offset:36120
    ds_read_b128 v[196:199], v90 offset:28672
    v_mfma_f32_32x32x16_bf16 v[144:159], v[204:207], v[216:219], v[144:159]
    s_waitcnt lgkmcnt(0)
    v_mfma_f32_32x32x16_bf16 v[128:143], v[192:195], v[208:211], v[128:143]
    ds_read_b128 v[200:203], v91 offset:12288
    ds_read_b64_tr_b16 v[216:217], v92 offset:39424
    v_mfma_f32_32x32x16_bf16 v[160:175], v[192:195], v[212:215], v[160:175]
    ds_read_b64_tr_b16 v[218:219], v92 offset:39648
    ds_read_b64_tr_b16 v[220:221], v92 offset:39480
    v_mfma_f32_32x32x16_bf16 v[176:191], v[196:199], v[212:215], v[176:191]
    ds_read_b64_tr_b16 v[222:223], v92 offset:39704
    ds_read_b128 v[204:207], v91 offset:28672
    v_mfma_f32_32x32x16_bf16 v[144:159], v[196:199], v[208:211], v[144:159]
    s_waitcnt lgkmcnt(0)
    s_barrier
    v_mfma_f32_32x32x16_bf16 v[128:143], v[200:203], v[216:219], v[128:143]
    ds_read_b128 v[192:195], v88 offset:0
    ds_read_b64_tr_b16 v[208:209], v92 offset:43008
    v_mfma_f32_32x32x16_bf16 v[160:175], v[200:203], v[220:223], v[160:175]
    ds_read_b64_tr_b16 v[210:211], v92 offset:43232
    ds_read_b64_tr_b16 v[212:213], v92 offset:43064
    v_mfma_f32_32x32x16_bf16 v[176:191], v[204:207], v[220:223], v[176:191]
    ds_read_b64_tr_b16 v[214:215], v92 offset:43288
    ds_read_b128 v[196:199], v88 offset:16384
    v_mfma_f32_32x32x16_bf16 v[144:159], v[204:207], v[216:219], v[144:159]
    s_waitcnt lgkmcnt(0)
    v_mfma_f32_32x32x16_bf16 v[128:143], v[192:195], v[208:211], v[128:143]
    ds_read_b128 v[200:203], v89 offset:0
    ds_read_b64_tr_b16 v[216:217], v92 offset:46592
    v_mfma_f32_32x32x16_bf16 v[160:175], v[192:195], v[212:215], v[160:175]
    ds_read_b64_tr_b16 v[218:219], v92 offset:46816
    ds_read_b64_tr_b16 v[220:221], v92 offset:46648
    v_mfma_f32_32x32x16_bf16 v[176:191], v[196:199], v[212:215], v[176:191]
    ds_read_b64_tr_b16 v[222:223], v92 offset:46872
    ds_read_b128 v[204:207], v89 offset:16384
    v_mfma_f32_32x32x16_bf16 v[144:159], v[196:199], v[208:211], v[144:159]
    s_waitcnt lgkmcnt(0)
    v_mfma_f32_32x32x16_bf16 v[128:143], v[200:203], v[216:219], v[128:143]
    ds_read_b128 v[192:195], v90 offset:0
    ds_read_b64_tr_b16 v[208:209], v93 offset:0
    v_mfma_f32_32x32x16_bf16 v[160:175], v[200:203], v[220:223], v[160:175]
    ds_read_b64_tr_b16 v[210:211], v93 offset:224
    ds_read_b64_tr_b16 v[212:213], v93 offset:56
    v_mfma_f32_32x32x16_bf16 v[176:191], v[204:207], v[220:223], v[176:191]
    ds_read_b64_tr_b16 v[214:215], v93 offset:280
    ds_read_b128 v[196:199], v90 offset:16384
    v_mfma_f32_32x32x16_bf16 v[144:159], v[204:207], v[216:219], v[144:159]
    s_waitcnt lgkmcnt(0)
    v_mfma_f32_32x32x16_bf16 v[128:143], v[192:195], v[208:211], v[128:143]
    ds_read_b128 v[200:203], v91 offset:0
    ds_read_b64_tr_b16 v[216:217], v93 offset:3584
    v_mfma_f32_32x32x16_bf16 v[160:175], v[192:195], v[212:215], v[160:175]
    ds_read_b64_tr_b16 v[218:219], v93 offset:3808
    ds_read_b64_tr_b16 v[220:221], v93 offset:3640
    v_mfma_f32_32x32x16_bf16 v[176:191], v[196:199], v[212:215], v[176:191]
    ds_read_b64_tr_b16 v[222:223], v93 offset:3864
    ds_read_b128 v[204:207], v91 offset:16384
    v_mfma_f32_32x32x16_bf16 v[144:159], v[196:199], v[208:211], v[144:159]
    s_waitcnt lgkmcnt(0)
    s_barrier
    v_mfma_f32_32x32x16_bf16 v[128:143], v[200:203], v[216:219], v[128:143]
    ds_read_b128 v[192:195], v88 offset:4096
    ds_read_b64_tr_b16 v[208:209], v93 offset:7168
    v_mfma_f32_32x32x16_bf16 v[160:175], v[200:203], v[220:223], v[160:175]
    ds_read_b64_tr_b16 v[210:211], v93 offset:7392
    ds_read_b64_tr_b16 v[212:213], v93 offset:7224
    v_mfma_f32_32x32x16_bf16 v[176:191], v[204:207], v[220:223], v[176:191]
    ds_read_b64_tr_b16 v[214:215], v93 offset:7448
    ds_read_b128 v[196:199], v88 offset:20480
    v_mfma_f32_32x32x16_bf16 v[144:159], v[204:207], v[216:219], v[144:159]
    s_waitcnt lgkmcnt(0)
    buffer_load_dwordx2 v[94:95], v9, s[40:43], 0 offen sc1
    v_mfma_f32_32x32x16_bf16 v[128:143], v[192:195], v[208:211], v[128:143]
    ds_read_b128 v[200:203], v89 offset:4096
    ds_read_b64_tr_b16 v[216:217], v93 offset:10752
    v_mfma_f32_32x32x16_bf16 v[160:175], v[192:195], v[212:215], v[160:175]
    ds_read_b64_tr_b16 v[218:219], v93 offset:10976
    ds_read_b64_tr_b16 v[220:221], v93 offset:10808
    v_mfma_f32_32x32x16_bf16 v[176:191], v[196:199], v[212:215], v[176:191]
    ds_read_b64_tr_b16 v[222:223], v93 offset:11032
    ds_read_b128 v[204:207], v89 offset:20480
    v_mfma_f32_32x32x16_bf16 v[144:159], v[196:199], v[208:211], v[144:159]
    s_waitcnt lgkmcnt(0)
    v_mfma_f32_32x32x16_bf16 v[128:143], v[200:203], v[216:219], v[128:143]
    ds_read_b128 v[192:195], v90 offset:4096
    ds_read_b64_tr_b16 v[208:209], v93 offset:14336
    v_mfma_f32_32x32x16_bf16 v[160:175], v[200:203], v[220:223], v[160:175]
    ds_read_b64_tr_b16 v[210:211], v93 offset:14560
    ds_read_b64_tr_b16 v[212:213], v93 offset:14392
    v_mfma_f32_32x32x16_bf16 v[176:191], v[204:207], v[220:223], v[176:191]
    ds_read_b64_tr_b16 v[214:215], v93 offset:14616
    ds_read_b128 v[196:199], v90 offset:20480
    v_mfma_f32_32x32x16_bf16 v[144:159], v[204:207], v[216:219], v[144:159]
    s_waitcnt lgkmcnt(0)
    v_mfma_f32_32x32x16_bf16 v[128:143], v[192:195], v[208:211], v[128:143]
    ds_read_b128 v[200:203], v91 offset:4096
    ds_read_b64_tr_b16 v[216:217], v93 offset:17920
    v_mfma_f32_32x32x16_bf16 v[160:175], v[192:195], v[212:215], v[160:175]
    ds_read_b64_tr_b16 v[218:219], v93 offset:18144
    ds_read_b64_tr_b16 v[220:221], v93 offset:17976
    v_mfma_f32_32x32x16_bf16 v[176:191], v[196:199], v[212:215], v[176:191]
    ds_read_b64_tr_b16 v[222:223], v93 offset:18200
    ds_read_b128 v[204:207], v91 offset:20480
    v_mfma_f32_32x32x16_bf16 v[144:159], v[196:199], v[208:211], v[144:159]
    s_waitcnt lgkmcnt(0)
    s_barrier
    v_mfma_f32_32x32x16_bf16 v[128:143], v[200:203], v[216:219], v[128:143]
    ds_read_b128 v[192:195], v88 offset:8192
    ds_read_b64_tr_b16 v[208:209], v93 offset:21504
    v_mfma_f32_32x32x16_bf16 v[160:175], v[200:203], v[220:223], v[160:175]
    ds_read_b64_tr_b16 v[210:211], v93 offset:21728
    ds_read_b64_tr_b16 v[212:213], v93 offset:21560
    v_mfma_f32_32x32x16_bf16 v[176:191], v[204:207], v[220:223], v[176:191]
    ds_read_b64_tr_b16 v[214:215], v93 offset:21784
    ds_read_b128 v[196:199], v88 offset:24576
    v_mfma_f32_32x32x16_bf16 v[144:159], v[204:207], v[216:219], v[144:159]
    s_waitcnt lgkmcnt(0)
    v_mfma_f32_32x32x16_bf16 v[128:143], v[192:195], v[208:211], v[128:143]
    ds_read_b128 v[200:203], v89 offset:8192
    ds_read_b64_tr_b16 v[216:217], v93 offset:25088
    v_mfma_f32_32x32x16_bf16 v[160:175], v[192:195], v[212:215], v[160:175]
    ds_read_b64_tr_b16 v[218:219], v93 offset:25312
    ds_read_b64_tr_b16 v[220:221], v93 offset:25144
    v_mfma_f32_32x32x16_bf16 v[176:191], v[196:199], v[212:215], v[176:191]
    ds_read_b64_tr_b16 v[222:223], v93 offset:25368
    ds_read_b128 v[204:207], v89 offset:24576
    v_mfma_f32_32x32x16_bf16 v[144:159], v[196:199], v[208:211], v[144:159]
    s_waitcnt lgkmcnt(0)
    v_mfma_f32_32x32x16_bf16 v[128:143], v[200:203], v[216:219], v[128:143]
    ds_read_b128 v[192:195], v90 offset:8192
    ds_read_b64_tr_b16 v[208:209], v93 offset:28672
    v_mfma_f32_32x32x16_bf16 v[160:175], v[200:203], v[220:223], v[160:175]
    ds_read_b64_tr_b16 v[210:211], v93 offset:28896
    ds_read_b64_tr_b16 v[212:213], v93 offset:28728
    v_mfma_f32_32x32x16_bf16 v[176:191], v[204:207], v[220:223], v[176:191]
    ds_read_b64_tr_b16 v[214:215], v93 offset:28952
    ds_read_b128 v[196:199], v90 offset:24576
    v_mfma_f32_32x32x16_bf16 v[144:159], v[204:207], v[216:219], v[144:159]
    s_waitcnt lgkmcnt(0)
    v_mfma_f32_32x32x16_bf16 v[128:143], v[192:195], v[208:211], v[128:143]
    ds_read_b128 v[200:203], v91 offset:8192
    ds_read_b64_tr_b16 v[216:217], v93 offset:32256
    v_mfma_f32_32x32x16_bf16 v[160:175], v[192:195], v[212:215], v[160:175]
    ds_read_b64_tr_b16 v[218:219], v93 offset:32480
    ds_read_b64_tr_b16 v[220:221], v93 offset:32312
    v_mfma_f32_32x32x16_bf16 v[176:191], v[196:199], v[212:215], v[176:191]
    ds_read_b64_tr_b16 v[222:223], v93 offset:32536
    ds_read_b128 v[204:207], v91 offset:24576
    v_mfma_f32_32x32x16_bf16 v[144:159], v[196:199], v[208:211], v[144:159]
    s_waitcnt lgkmcnt(0)
    s_barrier
    v_mfma_f32_32x32x16_bf16 v[128:143], v[200:203], v[216:219], v[128:143]
    ds_read_b128 v[192:195], v88 offset:12288
    ds_read_b64_tr_b16 v[208:209], v93 offset:35840
    v_mfma_f32_32x32x16_bf16 v[160:175], v[200:203], v[220:223], v[160:175]
    ds_read_b64_tr_b16 v[210:211], v93 offset:36064
    ds_read_b64_tr_b16 v[212:213], v93 offset:35896
    v_mfma_f32_32x32x16_bf16 v[176:191], v[204:207], v[220:223], v[176:191]
    ds_read_b64_tr_b16 v[214:215], v93 offset:36120
    ds_read_b128 v[196:199], v88 offset:28672
    v_mfma_f32_32x32x16_bf16 v[144:159], v[204:207], v[216:219], v[144:159]
    ds_read_b128 v[16:19], v5 offset:512
    ds_read_b128 v[20:23], v5 offset:544
    s_waitcnt lgkmcnt(2)
    v_mfma_f32_32x32x16_bf16 v[128:143], v[192:195], v[208:211], v[128:143]
    ds_read_b128 v[200:203], v89 offset:12288
    ds_read_b64_tr_b16 v[216:217], v93 offset:39424
    v_mfma_f32_32x32x16_bf16 v[160:175], v[192:195], v[212:215], v[160:175]
    ds_read_b64_tr_b16 v[218:219], v93 offset:39648
    ds_read_b64_tr_b16 v[220:221], v93 offset:39480
    v_mfma_f32_32x32x16_bf16 v[176:191], v[196:199], v[212:215], v[176:191]
    ds_read_b64_tr_b16 v[222:223], v93 offset:39704
    ds_read_b128 v[204:207], v89 offset:28672
    v_mfma_f32_32x32x16_bf16 v[144:159], v[196:199], v[208:211], v[144:159]
    ds_read_b128 v[24:27], v5 offset:576
    ds_read_b128 v[28:31], v5 offset:608
    s_waitcnt lgkmcnt(2)
    v_mfma_f32_32x32x16_bf16 v[128:143], v[200:203], v[216:219], v[128:143]
    ds_read_b128 v[192:195], v90 offset:12288
    ds_read_b64_tr_b16 v[208:209], v93 offset:43008
    v_mfma_f32_32x32x16_bf16 v[160:175], v[200:203], v[220:223], v[160:175]
    ds_read_b64_tr_b16 v[210:211], v93 offset:43232
    ds_read_b64_tr_b16 v[212:213], v93 offset:43064
    v_mfma_f32_32x32x16_bf16 v[176:191], v[204:207], v[220:223], v[176:191]
    ds_read_b64_tr_b16 v[214:215], v93 offset:43288
    ds_read_b128 v[196:199], v90 offset:28672
    v_mfma_f32_32x32x16_bf16 v[144:159], v[204:207], v[216:219], v[144:159]
    ds_read_b128 v[32:35], v5 offset:640
    ds_read_b128 v[36:39], v5 offset:672
    s_waitcnt lgkmcnt(2)
    v_mfma_f32_32x32x16_bf16 v[128:143], v[192:195], v[208:211], v[128:143]
    ds_read_b128 v[200:203], v91 offset:12288
    ds_read_b64_tr_b16 v[216:217], v93 offset:46592
    v_mfma_f32_32x32x16_bf16 v[160:175], v[192:195], v[212:215], v[160:175]
    ds_read_b64_tr_b16 v[218:219], v93 offset:46816
    ds_read_b64_tr_b16 v[220:221], v93 offset:46648
    v_mfma_f32_32x32x16_bf16 v[176:191], v[196:199], v[212:215], v[176:191]
    ds_read_b64_tr_b16 v[222:223], v93 offset:46872
    ds_read_b128 v[204:207], v91 offset:28672
    v_mfma_f32_32x32x16_bf16 v[144:159], v[196:199], v[208:211], v[144:159]
    ds_read_b128 v[40:43], v5 offset:704
    ds_read_b128 v[44:47], v5 offset:736
    s_waitcnt lgkmcnt(2)
    v_mfma_f32_32x32x16_bf16 v[128:143], v[200:203], v[216:219], v[128:143]
    ds_read_b128 v[48:51], v5 offset:1536
    ds_read_b128 v[52:55], v5 offset:1568
    ds_read_b128 v[56:59], v5 offset:1600
    v_mfma_f32_32x32x16_bf16 v[160:175], v[200:203], v[220:223], v[160:175]
    ds_read_b128 v[60:63], v5 offset:1632
    ds_read_b128 v[64:67], v5 offset:1664
    ds_read_b128 v[68:71], v5 offset:1696
    v_mfma_f32_32x32x16_bf16 v[176:191], v[204:207], v[220:223], v[176:191]
    ds_read_b128 v[72:75], v5 offset:1728
    ds_read_b128 v[76:79], v5 offset:1760
    ds_read_b32 v112, v4 offset:0
    v_mfma_f32_32x32x16_bf16 v[144:159], v[204:207], v[216:219], v[144:159]
    ds_read_b32 v114, v4 offset:112
    s_waitcnt lgkmcnt(0)
    v_pk_mul_f32 v[192:193], v[32:33], v[112:113] op_sel_hi:[1,0]
    v_pk_mul_f32 v[194:195], v[34:35], v[112:113] op_sel_hi:[1,0]
    v_pk_mul_f32 v[196:197], v[36:37], v[112:113] op_sel_hi:[1,0]
    v_pk_mul_f32 v[198:199], v[38:39], v[112:113] op_sel_hi:[1,0]
    v_pk_mul_f32 v[200:201], v[40:41], v[112:113] op_sel_hi:[1,0]
    v_pk_mul_f32 v[202:203], v[42:43], v[112:113] op_sel_hi:[1,0]
    v_pk_mul_f32 v[204:205], v[44:45], v[112:113] op_sel_hi:[1,0]
    v_pk_mul_f32 v[206:207], v[46:47], v[112:113] op_sel_hi:[1,0]
    v_pk_fma_f32 v[128:129], v[128:129], v[16:17], v[192:193]
    v_pk_fma_f32 v[130:131], v[130:131], v[18:19], v[194:195]
    v_pk_fma_f32 v[132:133], v[132:133], v[20:21], v[196:197]
    v_pk_fma_f32 v[134:135], v[134:135], v[22:23], v[198:199]
    v_pk_fma_f32 v[136:137], v[136:137], v[24:25], v[200:201]
    v_pk_fma_f32 v[138:139], v[138:139], v[26:27], v[202:203]
    v_pk_fma_f32 v[140:141], v[140:141], v[28:29], v[204:205]
    v_pk_fma_f32 v[142:143], v[142:143], v[30:31], v[206:207]
    s_mov_b64 exec, s[66:67]
    v_cvt_pk_bf16_f32 v96, v128, v129
    v_cvt_pk_bf16_f32 v97, v130, v131
    v_cvt_pk_bf16_f32 v98, v132, v133
    v_cvt_pk_bf16_f32 v99, v134, v135
    v_cvt_pk_bf16_f32 v100, v136, v137
    v_cvt_pk_bf16_f32 v101, v138, v139
    v_cvt_pk_bf16_f32 v102, v140, v141
    v_cvt_pk_bf16_f32 v103, v142, v143
    v_and_b32 v99, -2, v99
    v_and_b32 v103, -2, v103
    s_mov_b64 exec, -1
    buffer_store_dwordx4 v[96:99], v2, s[44:47], s64 offen offset:0 sc1
    buffer_store_dwordx4 v[100:103], v2, s[44:47], s64 offen offset:1024 sc1
    s_add_u32 s64, s64, s69
    v_pk_mul_f32 v[192:193], v[64:65], v[112:113] op_sel_hi:[1,0]
    v_pk_mul_f32 v[194:195], v[66:67], v[112:113] op_sel_hi:[1,0]
    v_pk_mul_f32 v[196:197], v[68:69], v[112:113] op_sel_hi:[1,0]
    v_pk_mul_f32 v[198:199], v[70:71], v[112:113] op_sel_hi:[1,0]
    v_pk_mul_f32 v[200:201], v[72:73], v[112:113] op_sel_hi:[1,0]
    v_pk_mul_f32 v[202:203], v[74:75], v[112:113] op_sel_hi:[1,0]
    v_pk_mul_f32 v[204:205], v[76:77], v[112:113] op_sel_hi:[1,0]
    v_pk_mul_f32 v[206:207], v[78:79], v[112:113] op_sel_hi:[1,0]
    v_pk_fma_f32 v[144:145], v[144:145], v[48:49], v[192:193]
    v_pk_fma_f32 v[146:147], v[146:147], v[50:51], v[194:195]
    v_pk_fma_f32 v[148:149], v[148:149], v[52:53], v[196:197]
    v_pk_fma_f32 v[150:151], v[150:151], v[54:55], v[198:199]
    v_pk_fma_f32 v[152:153], v[152:153], v[56:57], v[200:201]
    v_pk_fma_f32 v[154:155], v[154:155], v[58:59], v[202:203]
    v_pk_fma_f32 v[156:157], v[156:157], v[60:61], v[204:205]
    v_pk_fma_f32 v[158:159], v[158:159], v[62:63], v[206:207]
    s_mov_b64 exec, s[66:67]
    v_cvt_pk_bf16_f32 v104, v144, v145
    v_cvt_pk_bf16_f32 v105, v146, v147
    v_cvt_pk_bf16_f32 v106, v148, v149
    v_cvt_pk_bf16_f32 v107, v150, v151
    v_cvt_pk_bf16_f32 v108, v152, v153
    v_cvt_pk_bf16_f32 v109, v154, v155
    v_cvt_pk_bf16_f32 v110, v156, v157
    v_cvt_pk_bf16_f32 v111, v158, v159
    v_and_b32 v107, -2, v107
    v_and_b32 v111, -2, v111
    s_mov_b64 exec, -1
    buffer_store_dwordx4 v[104:107], v2, s[44:47], s64 offen offset:0 sc1
    buffer_store_dwordx4 v[108:111], v2, s[44:47], s64 offen offset:1024 sc1
    s_add_u32 s64, s64, s65
    v_pk_mul_f32 v[192:193], v[32:33], v[114:115] op_sel_hi:[1,0]
    v_pk_mul_f32 v[194:195], v[34:35], v[114:115] op_sel_hi:[1,0]
    v_pk_mul_f32 v[196:197], v[36:37], v[114:115] op_sel_hi:[1,0]
    v_pk_mul_f32 v[198:199], v[38:39], v[114:115] op_sel_hi:[1,0]
    v_pk_mul_f32 v[200:201], v[40:41], v[114:115] op_sel_hi:[1,0]
    v_pk_mul_f32 v[202:203], v[42:43], v[114:115] op_sel_hi:[1,0]
    v_pk_mul_f32 v[204:205], v[44:45], v[114:115] op_sel_hi:[1,0]
    v_pk_mul_f32 v[206:207], v[46:47], v[114:115] op_sel_hi:[1,0]
    v_pk_fma_f32 v[160:161], v[160:161], v[16:17], v[192:193]
    v_pk_fma_f32 v[162:163], v[162:163], v[18:19], v[194:195]
    v_pk_fma_f32 v[164:165], v[164:165], v[20:21], v[196:197]
    v_pk_fma_f32 v[166:167], v[166:167], v[22:23], v[198:199]
    v_pk_fma_f32 v[168:169], v[168:169], v[24:25], v[200:201]
    v_pk_fma_f32 v[170:171], v[170:171], v[26:27], v[202:203]
    v_pk_fma_f32 v[172:173], v[172:173], v[28:29], v[204:205]
    v_pk_fma_f32 v[174:175], v[174:175], v[30:31], v[206:207]
    s_mov_b64 exec, s[66:67]
    v_cvt_pk_bf16_f32 v96, v160, v161
    v_cvt_pk_bf16_f32 v97, v162, v163
    v_cvt_pk_bf16_f32 v98, v164, v165
    v_cvt_pk_bf16_f32 v99, v166, v167
    v_cvt_pk_bf16_f32 v100, v168, v169
    v_cvt_pk_bf16_f32 v101, v170, v171
    v_cvt_pk_bf16_f32 v102, v172, v173
    v_cvt_pk_bf16_f32 v103, v174, v175
    v_and_b32 v99, -2, v99
    v_and_b32 v103, -2, v103
    s_mov_b64 exec, -1
    buffer_store_dwordx4 v[96:99], v2, s[44:47], s64 offen offset:0 sc1
    buffer_store_dwordx4 v[100:103], v2, s[44:47], s64 offen offset:1024 sc1
    s_add_u32 s64, s64, s69
    v_pk_mul_f32 v[192:193], v[64:65], v[114:115] op_sel_hi:[1,0]
    v_pk_mul_f32 v[194:195], v[66:67], v[114:115] op_sel_hi:[1,0]
    v_pk_mul_f32 v[196:197], v[68:69], v[114:115] op_sel_hi:[1,0]
    v_pk_mul_f32 v[198:199], v[70:71], v[114:115] op_sel_hi:[1,0]
    v_pk_mul_f32 v[200:201], v[72:73], v[114:115] op_sel_hi:[1,0]
    v_pk_mul_f32 v[202:203], v[74:75], v[114:115] op_sel_hi:[1,0]
    v_pk_mul_f32 v[204:205], v[76:77], v[114:115] op_sel_hi:[1,0]
    v_pk_mul_f32 v[206:207], v[78:79], v[114:115] op_sel_hi:[1,0]
    v_pk_fma_f32 v[176:177], v[176:177], v[48:49], v[192:193]
    v_pk_fma_f32 v[178:179], v[178:179], v[50:51], v[194:195]
    v_pk_fma_f32 v[180:181], v[180:181], v[52:53], v[196:197]
    v_pk_fma_f32 v[182:183], v[182:183], v[54:55], v[198:199]
    v_pk_fma_f32 v[184:185], v[184:185], v[56:57], v[200:201]
    v_pk_fma_f32 v[186:187], v[186:187], v[58:59], v[202:203]
    v_pk_fma_f32 v[188:189], v[188:189], v[60:61], v[204:205]
    v_pk_fma_f32 v[190:191], v[190:191], v[62:63], v[206:207]
    s_mov_b64 exec, s[66:67]
    v_cvt_pk_bf16_f32 v104, v176, v177
    v_cvt_pk_bf16_f32 v105, v178, v179
    v_cvt_pk_bf16_f32 v106, v180, v181
    v_cvt_pk_bf16_f32 v107, v182, v183
    v_cvt_pk_bf16_f32 v108, v184, v185
    v_cvt_pk_bf16_f32 v109, v186, v187
    v_cvt_pk_bf16_f32 v110, v188, v189
    v_cvt_pk_bf16_f32 v111, v190, v191
    v_and_b32 v107, -2, v107
    v_and_b32 v111, -2, v111
    s_mov_b64 exec, -1
    buffer_store_dwordx4 v[104:107], v2, s[44:47], s64 offen offset:0 sc1
    buffer_store_dwordx4 v[108:111], v2, s[44:47], s64 offen offset:1024 sc1
P1_DONE:
    s_waitcnt vmcnt(8)
    v_readfirstlane_b32 s58, v94
    v_readfirstlane_b32 s59, v95
    s_nop 0
    s_or_b32 s57, s58, s59
    s_cbranch_scc1 P1_T_ok
    s_mov_b32 s57, 0x40000
    v_mov_b32 v4, 0
P1_T_l:
    buffer_load_dwordx2 v[94:95], v4, s[40:43], 0 offen sc1
    s_sub_u32 s57, s57, 1
    s_waitcnt vmcnt(0)
    s_cbranch_scc1 P1_T_ok
    v_readfirstlane_b32 s58, v94
    v_readfirstlane_b32 s59, v95
    s_nop 0
    s_cmp_eq_u64 s[58:59], 0
    s_cbranch_scc1 P1_T_l
P1_T_ok:
    v_mov_b32 v4, s58
    v_mov_b32 v5, s59
    v_mov_b32 v6, 0
    s_cmp_lg_u32 s48, 0
    s_waitcnt vmcnt(0)
    s_barrier
    s_cbranch_scc1 P2_NOF
    s_mov_b64 exec, 1
    buffer_store_dwordx2 v[4:5], v6, s[44:47], s4 offen sc1
    s_mov_b64 exec, -1
P2_NOF:
P2_START:
    s_mul_i32 s70, s1, 28672
    s_lshl_b32 s64, s0, 6
    s_add_u32 s70, s70, s64
    buffer_load_dwordx4 v[224:227], v13, s[8:11], s70 offen offset:0
    buffer_load_dwordx4 v[228:231], v13, s[8:11], s70 offen offset:32
    s_lshl_b32 s65, s50, 2
    s_add_u32 s65, s65, s48
    s_lshl_b32 s64, s49, 6
    s_add_u32 s64, s64, s65
    s_lshl_b32 s64, s64, 11
    s_lshr_b32 s63, s49, 2
    s_lshl_b32 s63, s63, 13
    s_add_u32 s63, s63, 15204352
    s_lshl_b32 s66, s48, 9
    s_add_u32 s66, s66, 2048
    s_lshl_b32 s68, s50, 7
    v_and_b32 v7, 3, v1
    v_lshl_add_u32 v7, v7, 7, s66
    v_bfe_u32 v8, v1, 2, 1
    v_lshl_add_u32 v7, v8, 11, v7
    v_writelane_b32 v7, s68, 8
    s_waitcnt vmcnt(0)
    s_mov_b32 exec_lo, 0x000001ff
    s_mov_b32 exec_hi, 0x00000000
    s_mov_b32 s57, 0x40000
POLL_1:
    buffer_load_dwordx2 v[8:9], v7, s[44:47], s63 offen sc1
    s_sub_u32 s57, s57, 1
    s_waitcnt vmcnt(0)
    s_cbranch_scc1 POLL_1_x
    v_cmp_ne_u64 vcc, s[58:59], v[8:9]
    s_nop 0
    s_and_b64 exec, exec, vcc
    s_cbranch_scc1 POLL_1
POLL_1_x:
    s_mov_b64 exec, -1
    buffer_load_dwordx4 v[16:19], v2, s[44:47], s64 offen offset:0 sc1
    buffer_load_dwordx4 v[20:23], v2, s[44:47], s64 offen offset:1024 sc1
    s_add_u32 s66, s44, 4096
    s_addc_u32 s67, s45, 0
    global_load_dwordx4 v[160:163], v243, s[66:67] offset:-4096 sc1
    global_load_dwordx4 v[164:167], v243, s[66:67] offset:-3072 sc1
    global_load_dwordx4 v[168:171], v243, s[66:67] offset:-2048 sc1
    global_load_dwordx4 v[172:175], v243, s[66:67] offset:-1024 sc1
    s_waitcnt vmcnt(2)
    v_mfma_f32_32x32x16_bf16 v[48:63], v[160:163], v[16:19], 0
    v_mfma_f32_32x32x16_bf16 v[48:63], v[164:167], v[20:23], v[48:63]
    global_load_dwordx4 v[176:179], v243, s[66:67] offset:0 sc1
    global_load_dwordx4 v[180:183], v243, s[66:67] offset:1024 sc1
    global_load_dwordx4 v[184:187], v243, s[66:67] offset:2048 sc1
    global_load_dwordx4 v[188:191], v243, s[66:67] offset:3072 sc1
    ds_write_b128 v249, v[16:19]
    s_nop 6
    v_max3_f32 v4, v48, v49, v50
    v_max3_f32 v5, v51, v52, v53
    v_max3_f32 v4, v4, v54, v55
    v_max3_f32 v5, v5, v56, v57
    v_max3_f32 v4, v4, v58, v59
    v_max3_f32 v5, v5, v60, v61
    v_max3_f32 v4, v4, v62, v63
    v_max_f32 v4, v4, v5
    v_mov_b32 v5, v4
    s_nop 1
    v_permlane32_swap_b32 v4, v5
    v_max_f32 v4, v4, v5
    v_sub_f32 v5, 0, v4
    v_and_b32 v6, 0xffff0000, v5
    v_sub_f32 v5, v5, v6
    v_and_b32 v7, 0xffff0000, v5
    v_sub_f32 v5, v5, v7
    v_lshrrev_b32 v5, 16, v5
    v_lshrrev_b32 v6, 16, v6
    v_or_b32 v6, v6, v7
    v_cndmask_b32 v22, v22, v6, s[60:61]
    v_cndmask_b32 v23, v23, v5, s[60:61]
    ds_write_b128 v249, v[20:23] offset:1024
    v_mfma_f32_32x32x16_bf16 v[112:127], v[160:163], v[16:19], 0
    v_mfma_f32_32x32x16_bf16 v[112:127], v[164:167], v[20:23], v[112:127]
    s_add_u32 s66, s66, 8192
    s_addc_u32 s67, s67, 0
    global_load_dwordx4 v[192:195], v243, s[66:67] offset:-4096 sc1
    global_load_dwordx4 v[196:199], v243, s[66:67] offset:-3072 sc1
    global_load_dwordx4 v[200:203], v243, s[66:67] offset:-2048 sc1
    global_load_dwordx4 v[204:207], v243, s[66:67] offset:-1024 sc1
    s_waitcnt lgkmcnt(0)
    s_barrier
    ds_read_b128 v[24:27], v250
    ds_read_b128 v[28:31], v250 offset:1024
    ds_read_b128 v[32:35], v251
    ds_read_b128 v[36:39], v251 offset:1024
    ds_read_b128 v[40:43], v252
    ds_read_b128 v[44:47], v252 offset:1024
    global_load_dwordx4 v[208:211], v243, s[66:67] offset:0 sc1
    global_load_dwordx4 v[212:215], v243, s[66:67] offset:1024 sc1
    global_load_dwordx4 v[216:219], v243, s[66:67] offset:2048 sc1
    global_load_dwordx4 v[220:223], v243, s[66:67] offset:3072 sc1
P2_MAIN:
    s_nop 10
    v_exp_f32 v112, v112
    v_exp_f32 v113, v113
    v_exp_f32 v114, v114
    v_exp_f32 v115, v115
    s_waitcnt lgkmcnt(0)
    v_mfma_f32_32x32x16_bf16 v[128:143], v[160:163], v[24:27], 0
    v_exp_f32 v116, v116
    v_exp_f32 v117, v117
    v_exp_f32 v118, v118
    v_exp_f32 v119, v119
    v_cvt_pk_bf16_f32 v144, v112, v113
    v_cvt_pk_bf16_f32 v145, v114, v115
    v_mfma_f32_32x32x16_bf16 v[128:143], v[164:167], v[28:31], v[128:143]
    s_waitcnt vmcnt(12)
    v_exp_f32 v120, v120
    v_exp_f32 v121, v121
    v_exp_f32 v122, v122
    v_exp_f32 v123, v123
    v_cvt_pk_bf16_f32 v146, v116, v117
    v_cvt_pk_bf16_f32 v147, v118, v119
    v_exp_f32 v124, v124
    v_exp_f32 v125, v125
    v_exp_f32 v126, v126
    v_exp_f32 v127, v127
    v_cvt_pk_bf16_f32 v148, v120, v121
    v_cvt_pk_bf16_f32 v149, v122, v123
    v_cvt_pk_bf16_f32 v150, v124, v125
    v_cvt_pk_bf16_f32 v151, v126, v127
    v_mfma_f32_32x32x16_bf16 v[112:127], v[160:163], v[32:35], 0
    v_exp_f32 v128, v128
    v_exp_f32 v129, v129
    v_exp_f32 v130, v130
    v_exp_f32 v131, v131
    v_mfma_f32_32x32x16_bf16 v[48:63], v[168:171], v[144:147], 0
    v_exp_f32 v132, v132
    v_exp_f32 v133, v133
    v_exp_f32 v134, v134
    v_exp_f32 v135, v135
    v_cvt_pk_bf16_f32 v152, v128, v129
    v_cvt_pk_bf16_f32 v153, v130, v131
    v_mfma_f32_32x32x16_bf16 v[112:127], v[164:167], v[36:39], v[112:127]
    v_exp_f32 v136, v136
    v_exp_f32 v137, v137
    v_exp_f32 v138, v138
    v_exp_f32 v139, v139
    v_cvt_pk_bf16_f32 v154, v132, v133
    v_cvt_pk_bf16_f32 v155, v134, v135
    v_mfma_f32_32x32x16_bf16 v[48:63], v[172:175], v[148:151], v[48:63]
    v_exp_f32 v140, v140
    v_exp_f32 v141, v141
    v_exp_f32 v142, v142
    v_exp_f32 v143, v143
    v_cvt_pk_bf16_f32 v156, v136, v137
    v_cvt_pk_bf16_f32 v157, v138, v139
    v_cvt_pk_bf16_f32 v158, v140, v141
    v_cvt_pk_bf16_f32 v159, v142, v143
    v_mfma_f32_32x32x16_bf16 v[128:143], v[160:163], v[40:43], 0
    v_exp_f32 v112, v112
    v_exp_f32 v113, v113
    v_exp_f32 v114, v114
    v_exp_f32 v115, v115
    v_mfma_f32_32x32x16_bf16 v[64:79], v[168:171], v[152:155], 0
    v_exp_f32 v116, v116
    v_exp_f32 v117, v117
    v_exp_f32 v118, v118
    v_exp_f32 v119, v119
    v_cvt_pk_bf16_f32 v144, v112, v113
    v_cvt_pk_bf16_f32 v145, v114, v115
    v_mfma_f32_32x32x16_bf16 v[128:143], v[164:167], v[44:47], v[128:143]
    v_exp_f32 v120, v120
    v_exp_f32 v121, v121
    v_exp_f32 v122, v122
    v_exp_f32 v123, v123
    v_cvt_pk_bf16_f32 v146, v116, v117
    v_cvt_pk_bf16_f32 v147, v118, v119
    v_mfma_f32_32x32x16_bf16 v[64:79], v[172:175], v[156:159], v[64:79]
    s_waitcnt vmcnt(8)
    v_exp_f32 v124, v124
    v_exp_f32 v125, v125
    v_exp_f32 v126, v126
    v_exp_f32 v127, v127
    v_cvt_pk_bf16_f32 v148, v120, v121
    v_cvt_pk_bf16_f32 v149, v122, v123
    v_cvt_pk_bf16_f32 v150, v124, v125
    v_cvt_pk_bf16_f32 v151, v126, v127
    v_mfma_f32_32x32x16_bf16 v[112:127], v[176:179], v[16:19], 0
    v_exp_f32 v128, v128
    v_exp_f32 v129, v129
    v_exp_f32 v130, v130
    v_exp_f32 v131, v131
    v_mfma_f32_32x32x16_bf16 v[80:95], v[168:171], v[144:147], 0
    v_exp_f32 v132, v132
    v_exp_f32 v133, v133
    v_exp_f32 v134, v134
    v_exp_f32 v135, v135
    v_cvt_pk_bf16_f32 v152, v128, v129
    v_cvt_pk_bf16_f32 v153, v130, v131
    v_mfma_f32_32x32x16_bf16 v[112:127], v[180:183], v[20:23], v[112:127]
    v_exp_f32 v136, v136
    v_exp_f32 v137, v137
    v_exp_f32 v138, v138
    v_exp_f32 v139, v139
    v_cvt_pk_bf16_f32 v154, v132, v133
    v_cvt_pk_bf16_f32 v155, v134, v135
    v_mfma_f32_32x32x16_bf16 v[80:95], v[172:175], v[148:151], v[80:95]
    v_exp_f32 v140, v140
    v_exp_f32 v141, v141
    v_exp_f32 v142, v142
    v_exp_f32 v143, v143
    v_cvt_pk_bf16_f32 v156, v136, v137
    v_cvt_pk_bf16_f32 v157, v138, v139
    v_cvt_pk_bf16_f32 v158, v140, v141
    v_cvt_pk_bf16_f32 v159, v142, v143
    v_mfma_f32_32x32x16_bf16 v[128:143], v[176:179], v[24:27], 0
    v_exp_f32 v112, v112
    v_exp_f32 v113, v113
    v_exp_f32 v114, v114
    v_exp_f32 v115, v115
    v_mfma_f32_32x32x16_bf16 v[96:111], v[168:171], v[152:155], 0
    v_exp_f32 v116, v116
    v_exp_f32 v117, v117
    v_exp_f32 v118, v118
    v_exp_f32 v119, v119
    v_cvt_pk_bf16_f32 v144, v112, v113
    v_cvt_pk_bf16_f32 v145, v114, v115
    v_mfma_f32_32x32x16_bf16 v[128:143], v[180:183], v[28:31], v[128:143]
    v_exp_f32 v120, v120
    v_exp_f32 v121, v121
    v_exp_f32 v122, v122
    v_exp_f32 v123, v123
    v_cvt_pk_bf16_f32 v146, v116, v117
    v_cvt_pk_bf16_f32 v147, v118, v119
    v_mfma_f32_32x32x16_bf16 v[96:111], v[172:175], v[156:159], v[96:111]
    v_exp_f32 v124, v124
    v_exp_f32 v125, v125
    v_exp_f32 v126, v126
    v_exp_f32 v127, v127
    v_cvt_pk_bf16_f32 v148, v120, v121
    v_cvt_pk_bf16_f32 v149, v122, v123
    v_cvt_pk_bf16_f32 v150, v124, v125
    v_cvt_pk_bf16_f32 v151, v126, v127
    v_mfma_f32_32x32x16_bf16 v[112:127], v[176:179], v[32:35], 0
    s_add_u32 s66, s66, 8192
    v_exp_f32 v128, v128
    v_exp_f32 v129, v129
    v_exp_f32 v130, v130
    v_exp_f32 v131, v131
    v_mfma_f32_32x32x16_bf16 v[48:63], v[184:187], v[144:147], v[48:63]
    s_addc_u32 s67, s67, 0
    v_exp_f32 v132, v132
    v_exp_f32 v133, v133
    v_exp_f32 v134, v134
    v_exp_f32 v135, v135
    v_cvt_pk_bf16_f32 v152, v128, v129
    v_cvt_pk_bf16_f32 v153, v130, v131
    v_mfma_f32_32x32x16_bf16 v[112:127], v[180:183], v[36:39], v[112:127]
    global_load_dwordx4 v[160:163], v243, s[66:67] offset:-4096 sc1
    v_exp_f32 v136, v136
    v_exp_f32 v137, v137
    v_exp_f32 v138, v138
    v_exp_f32 v139, v139
    v_cvt_pk_bf16_f32 v154, v132, v133
    v_cvt_pk_bf16_f32 v155, v134, v135
    v_mfma_f32_32x32x16_bf16 v[48:63], v[188:191], v[148:151], v[48:63]
    global_load_dwordx4 v[164:167], v243, s[66:67] offset:-3072 sc1
    v_exp_f32 v140, v140
    v_exp_f32 v141, v141
    v_exp_f32 v142, v142
    v_exp_f32 v143, v143
    v_cvt_pk_bf16_f32 v156, v136, v137
    v_cvt_pk_bf16_f32 v157, v138, v139
    v_cvt_pk_bf16_f32 v158, v140, v141
    v_cvt_pk_bf16_f32 v159, v142, v143
    v_mfma_f32_32x32x16_bf16 v[128:143], v[176:179], v[40:43], 0
    global_load_dwordx4 v[168:171], v243, s[66:67] offset:-2048 sc1
    v_exp_f32 v112, v112
    v_exp_f32 v113, v113
    v_exp_f32 v114, v114
    v_exp_f32 v115, v115
    v_mfma_f32_32x32x16_bf16 v[64:79], v[184:187], v[152:155], v[64:79]
    global_load_dwordx4 v[172:175], v243, s[66:67] offset:-1024 sc1
    v_exp_f32 v116, v116
    v_exp_f32 v117, v117
    v_exp_f32 v118, v118
    v_exp_f32 v119, v119
    v_cvt_pk_bf16_f32 v144, v112, v113
    v_cvt_pk_bf16_f32 v145, v114, v115
    v_mfma_f32_32x32x16_bf16 v[128:143], v[180:183], v[44:47], v[128:143]
    v_exp_f32 v120, v120
    v_exp_f32 v121, v121
    v_exp_f32 v122, v122
    v_exp_f32 v123, v123
    v_cvt_pk_bf16_f32 v146, v116, v117
    v_cvt_pk_bf16_f32 v147, v118, v119
    v_mfma_f32_32x32x16_bf16 v[64:79], v[188:191], v[156:159], v[64:79]
    s_waitcnt vmcnt(8)
    v_exp_f32 v124, v124
    v_exp_f32 v125, v125
    v_exp_f32 v126, v126
    v_exp_f32 v127, v127
    v_cvt_pk_bf16_f32 v148, v120, v121
    v_cvt_pk_bf16_f32 v149, v122, v123
    v_cvt_pk_bf16_f32 v150, v124, v125
    v_cvt_pk_bf16_f32 v151, v126, v127
    v_mfma_f32_32x32x16_bf16 v[112:127], v[192:195], v[16:19], 0
    v_exp_f32 v128, v128
    v_exp_f32 v129, v129
    v_exp_f32 v130, v130
    v_exp_f32 v131, v131
    v_mfma_f32_32x32x16_bf16 v[80:95], v[184:187], v[144:147], v[80:95]
    v_exp_f32 v132, v132
    v_exp_f32 v133, v133
    v_exp_f32 v134, v134
    v_exp_f32 v135, v135
    v_cvt_pk_bf16_f32 v152, v128, v129
    v_cvt_pk_bf16_f32 v153, v130, v131
    v_mfma_f32_32x32x16_bf16 v[112:127], v[196:199], v[20:23], v[112:127]
    v_exp_f32 v136, v136
    v_exp_f32 v137, v137
    v_exp_f32 v138, v138
    v_exp_f32 v139, v139
    v_cvt_pk_bf16_f32 v154, v132, v133
    v_cvt_pk_bf16_f32 v155, v134, v135
    v_mfma_f32_32x32x16_bf16 v[80:95], v[188:191], v[148:151], v[80:95]
    v_exp_f32 v140, v140
    v_exp_f32 v141, v141
    v_exp_f32 v142, v142
    v_exp_f32 v143, v143
    v_cvt_pk_bf16_f32 v156, v136, v137
    v_cvt_pk_bf16_f32 v157, v138, v139
    v_cvt_pk_bf16_f32 v158, v140, v141
    v_cvt_pk_bf16_f32 v159, v142, v143
    v_mfma_f32_32x32x16_bf16 v[128:143], v[192:195], v[24:27], 0
    v_exp_f32 v112, v112
    v_exp_f32 v113, v113
    v_exp_f32 v114, v114
    v_exp_f32 v115, v115
    v_mfma_f32_32x32x16_bf16 v[96:111], v[184:187], v[152:155], v[96:111]
    v_exp_f32 v116, v116
    v_exp_f32 v117, v117
    v_exp_f32 v118, v118
    v_exp_f32 v119, v119
    v_cvt_pk_bf16_f32 v144, v112, v113
    v_cvt_pk_bf16_f32 v145, v114, v115
    v_mfma_f32_32x32x16_bf16 v[128:143], v[196:199], v[28:31], v[128:143]
    v_exp_f32 v120, v120
    v_exp_f32 v121, v121
    v_exp_f32 v122, v122
    v_exp_f32 v123, v123
    v_cvt_pk_bf16_f32 v146, v116, v117
    v_cvt_pk_bf16_f32 v147, v118, v119
    v_mfma_f32_32x32x16_bf16 v[96:111], v[188:191], v[156:159], v[96:111]
    v_exp_f32 v124, v124
    v_exp_f32 v125, v125
    v_exp_f32 v126, v126
    v_exp_f32 v127, v127
    v_cvt_pk_bf16_f32 v148, v120, v121
    v_cvt_pk_bf16_f32 v149, v122, v123
    v_cvt_pk_bf16_f32 v150, v124, v125
    v_cvt_pk_bf16_f32 v151, v126, v127
    v_mfma_f32_32x32x16_bf16 v[112:127], v[192:195], v[32:35], 0
    v_exp_f32 v128, v128
    v_exp_f32 v129, v129
    v_exp_f32 v130, v130
    v_exp_f32 v131, v131
    v_mfma_f32_32x32x16_bf16 v[48:63], v[200:203], v[144:147], v[48:63]
    v_exp_f32 v132, v132
    v_exp_f32 v133, v133
    v_exp_f32 v134, v134
    v_exp_f32 v135, v135
    v_cvt_pk_bf16_f32 v152, v128, v129
    v_cvt_pk_bf16_f32 v153, v130, v131
    v_mfma_f32_32x32x16_bf16 v[112:127], v[196:199], v[36:39], v[112:127]
    global_load_dwordx4 v[176:179], v243, s[66:67] offset:0 sc1
    v_exp_f32 v136, v136
    v_exp_f32 v137, v137
    v_exp_f32 v138, v138
    v_exp_f32 v139, v139
    v_cvt_pk_bf16_f32 v154, v132, v133
    v_cvt_pk_bf16_f32 v155, v134, v135
    v_mfma_f32_32x32x16_bf16 v[48:63], v[204:207], v[148:151], v[48:63]
    global_load_dwordx4 v[180:183], v243, s[66:67] offset:1024 sc1
    v_exp_f32 v140, v140
    v_exp_f32 v141, v141
    v_exp_f32 v142, v142
    v_exp_f32 v143, v143
    v_cvt_pk_bf16_f32 v156, v136, v137
    v_cvt_pk_bf16_f32 v157, v138, v139
    v_cvt_pk_bf16_f32 v158, v140, v141
    v_cvt_pk_bf16_f32 v159, v142, v143
    v_mfma_f32_32x32x16_bf16 v[128:143], v[192:195], v[40:43], 0
    global_load_dwordx4 v[184:187], v243, s[66:67] offset:2048 sc1
    v_exp_f32 v112, v112
    v_exp_f32 v113, v113
    v_exp_f32 v114, v114
    v_exp_f32 v115, v115
    v_mfma_f32_32x32x16_bf16 v[64:79], v[200:203], v[152:155], v[64:79]
    global_load_dwordx4 v[188:191], v243, s[66:67] offset:3072 sc1
    v_exp_f32 v116, v116
    v_exp_f32 v117, v117
    v_exp_f32 v118, v118
    v_exp_f32 v119, v119
    v_cvt_pk_bf16_f32 v144, v112, v113
    v_cvt_pk_bf16_f32 v145, v114, v115
    v_mfma_f32_32x32x16_bf16 v[128:143], v[196:199], v[44:47], v[128:143]
    v_exp_f32 v120, v120
    v_exp_f32 v121, v121
    v_exp_f32 v122, v122
    v_exp_f32 v123, v123
    v_cvt_pk_bf16_f32 v146, v116, v117
    v_cvt_pk_bf16_f32 v147, v118, v119
    v_mfma_f32_32x32x16_bf16 v[64:79], v[204:207], v[156:159], v[64:79]
    s_waitcnt vmcnt(8)
    v_exp_f32 v124, v124
    v_exp_f32 v125, v125
    v_exp_f32 v126, v126
    v_exp_f32 v127, v127
    v_cvt_pk_bf16_f32 v148, v120, v121
    v_cvt_pk_bf16_f32 v149, v122, v123
    v_cvt_pk_bf16_f32 v150, v124, v125
    v_cvt_pk_bf16_f32 v151, v126, v127
    v_mfma_f32_32x32x16_bf16 v[112:127], v[208:211], v[16:19], 0
    v_exp_f32 v128, v128
    v_exp_f32 v129, v129
    v_exp_f32 v130, v130
    v_exp_f32 v131, v131
    v_mfma_f32_32x32x16_bf16 v[80:95], v[200:203], v[144:147], v[80:95]
    v_exp_f32 v132, v132
    v_exp_f32 v133, v133
    v_exp_f32 v134, v134
    v_exp_f32 v135, v135
    v_cvt_pk_bf16_f32 v152, v128, v129
    v_cvt_pk_bf16_f32 v153, v130, v131
    v_mfma_f32_32x32x16_bf16 v[112:127], v[212:215], v[20:23], v[112:127]
    v_exp_f32 v136, v136
    v_exp_f32 v137, v137
    v_exp_f32 v138, v138
    v_exp_f32 v139, v139
    v_cvt_pk_bf16_f32 v154, v132, v133
    v_cvt_pk_bf16_f32 v155, v134, v135
    v_mfma_f32_32x32x16_bf16 v[80:95], v[204:207], v[148:151], v[80:95]
    v_exp_f32 v140, v140
    v_exp_f32 v141, v141
    v_exp_f32 v142, v142
    v_exp_f32 v143, v143
    v_cvt_pk_bf16_f32 v156, v136, v137
    v_cvt_pk_bf16_f32 v157, v138, v139
    v_cvt_pk_bf16_f32 v158, v140, v141
    v_cvt_pk_bf16_f32 v159, v142, v143
    v_mfma_f32_32x32x16_bf16 v[128:143], v[208:211], v[24:27], 0
    ds_write_b32 v250, v244 offset:3072
    v_exp_f32 v112, v112
    v_exp_f32 v113, v113
    v_exp_f32 v114, v114
    v_exp_f32 v115, v115
    v_mfma_f32_32x32x16_bf16 v[96:111], v[200:203], v[152:155], v[96:111]
    v_exp_f32 v116, v116
    v_exp_f32 v117, v117
    v_exp_f32 v118, v118
    v_exp_f32 v119, v119
    v_cvt_pk_bf16_f32 v144, v112, v113
    v_cvt_pk_bf16_f32 v145, v114, v115
    v_mfma_f32_32x32x16_bf16 v[128:143], v[212:215], v[28:31], v[128:143]
    v_exp_f32 v120, v120
    v_exp_f32 v121, v121
    v_exp_f32 v122, v122
    v_exp_f32 v123, v123
    v_cvt_pk_bf16_f32 v146, v116, v117
    v_cvt_pk_bf16_f32 v147, v118, v119
    v_mfma_f32_32x32x16_bf16 v[96:111], v[204:207], v[156:159], v[96:111]
    v_exp_f32 v124, v124
    v_exp_f32 v125, v125
    v_exp_f32 v126, v126
    v_exp_f32 v127, v127
    v_cvt_pk_bf16_f32 v148, v120, v121
    v_cvt_pk_bf16_f32 v149, v122, v123
    v_cvt_pk_bf16_f32 v150, v124, v125
    v_cvt_pk_bf16_f32 v151, v126, v127
    v_mfma_f32_32x32x16_bf16 v[112:127], v[208:211], v[32:35], 0
    s_add_u32 s66, s66, 8192
    v_exp_f32 v128, v128
    v_exp_f32 v129, v129
    v_exp_f32 v130, v130
    v_exp_f32 v131, v131
    v_mfma_f32_32x32x16_bf16 v[48:63], v[216:219], v[144:147], v[48:63]
    s_addc_u32 s67, s67, 0
    v_exp_f32 v132, v132
    v_exp_f32 v133, v133
    v_exp_f32 v134, v134
    v_exp_f32 v135, v135
    v_cvt_pk_bf16_f32 v152, v128, v129
    v_cvt_pk_bf16_f32 v153, v130, v131
    v_mfma_f32_32x32x16_bf16 v[112:127], v[212:215], v[36:39], v[112:127]
    global_load_dwordx4 v[192:195], v243, s[66:67] offset:-4096 sc1
    v_exp_f32 v136, v136
    v_exp_f32 v137, v137
    v_exp_f32 v138, v138
    v_exp_f32 v139, v139
    v_cvt_pk_bf16_f32 v154, v132, v133
    v_cvt_pk_bf16_f32 v155, v134, v135
    v_mfma_f32_32x32x16_bf16 v[48:63], v[220:223], v[148:151], v[48:63]
    global_load_dwordx4 v[196:199], v243, s[66:67] offset:-3072 sc1
    v_exp_f32 v140, v140
    v_exp_f32 v141, v141
    v_exp_f32 v142, v142
    v_exp_f32 v143, v143
    v_cvt_pk_bf16_f32 v156, v136, v137
    v_cvt_pk_bf16_f32 v157, v138, v139
    v_cvt_pk_bf16_f32 v158, v140, v141
    v_cvt_pk_bf16_f32 v159, v142, v143
    v_mfma_f32_32x32x16_bf16 v[128:143], v[208:211], v[40:43], 0
    global_load_dwordx4 v[200:203], v243, s[66:67] offset:-2048 sc1
    v_exp_f32 v112, v112
    v_exp_f32 v113, v113
    v_exp_f32 v114, v114
    v_exp_f32 v115, v115
    v_mfma_f32_32x32x16_bf16 v[64:79], v[216:219], v[152:155], v[64:79]
    global_load_dwordx4 v[204:207], v243, s[66:67] offset:-1024 sc1
    v_exp_f32 v116, v116
    v_exp_f32 v117, v117
    v_exp_f32 v118, v118
    v_exp_f32 v119, v119
    v_cvt_pk_bf16_f32 v144, v112, v113
    v_cvt_pk_bf16_f32 v145, v114, v115
    v_mfma_f32_32x32x16_bf16 v[128:143], v[212:215], v[44:47], v[128:143]
    v_exp_f32 v120, v120
    v_exp_f32 v121, v121
    v_exp_f32 v122, v122
    v_exp_f32 v123, v123
    v_cvt_pk_bf16_f32 v146, v116, v117
    v_cvt_pk_bf16_f32 v147, v118, v119
    v_mfma_f32_32x32x16_bf16 v[64:79], v[220:223], v[156:159], v[64:79]
    s_waitcnt vmcnt(8)
    v_exp_f32 v124, v124
    v_exp_f32 v125, v125
    v_exp_f32 v126, v126
    v_exp_f32 v127, v127
    v_cvt_pk_bf16_f32 v148, v120, v121
    v_cvt_pk_bf16_f32 v149, v122, v123
    v_cvt_pk_bf16_f32 v150, v124, v125
    v_cvt_pk_bf16_f32 v151, v126, v127
    v_mfma_f32_32x32x16_bf16 v[112:127], v[160:163], v[16:19], 0
    v_exp_f32 v128, v128
    v_exp_f32 v129, v129
    v_exp_f32 v130, v130
    v_exp_f32 v131, v131
    v_mfma_f32_32x32x16_bf16 v[80:95], v[216:219], v[144:147], v[80:95]
    v_exp_f32 v132, v132
    v_exp_f32 v133, v133
    v_exp_f32 v134, v134
    v_exp_f32 v135, v135
    v_cvt_pk_bf16_f32 v152, v128, v129
    v_cvt_pk_bf16_f32 v153, v130, v131
    v_mfma_f32_32x32x16_bf16 v[112:127], v[164:167], v[20:23], v[112:127]
    v_exp_f32 v136, v136
    v_exp_f32 v137, v137
    v_exp_f32 v138, v138
    v_exp_f32 v139, v139
    v_cvt_pk_bf16_f32 v154, v132, v133
    v_cvt_pk_bf16_f32 v155, v134, v135
    v_mfma_f32_32x32x16_bf16 v[80:95], v[220:223], v[148:151], v[80:95]
    v_exp_f32 v140, v140
    v_exp_f32 v141, v141
    v_exp_f32 v142, v142
    v_exp_f32 v143, v143
    v_cvt_pk_bf16_f32 v156, v136, v137
    v_cvt_pk_bf16_f32 v157, v138, v139
    v_cvt_pk_bf16_f32 v158, v140, v141
    v_cvt_pk_bf16_f32 v159, v142, v143
    v_mfma_f32_32x32x16_bf16 v[128:143], v[160:163], v[24:27], 0
    v_exp_f32 v112, v112
    v_exp_f32 v113, v113
    v_exp_f32 v114, v114
    v_exp_f32 v115, v115
    v_mfma_f32_32x32x16_bf16 v[96:111], v[216:219], v[152:155], v[96:111]
    v_exp_f32 v116, v116
    v_exp_f32 v117, v117
    v_exp_f32 v118, v118
    v_exp_f32 v119, v119
    v_cvt_pk_bf16_f32 v144, v112, v113
    v_cvt_pk_bf16_f32 v145, v114, v115
    v_mfma_f32_32x32x16_bf16 v[128:143], v[164:167], v[28:31], v[128:143]
    v_exp_f32 v120, v120
    v_exp_f32 v121, v121
    v_exp_f32 v122, v122
    v_exp_f32 v123, v123
    v_cvt_pk_bf16_f32 v146, v116, v117
    v_cvt_pk_bf16_f32 v147, v118, v119
    v_mfma_f32_32x32x16_bf16 v[96:111], v[220:223], v[156:159], v[96:111]
    v_exp_f32 v124, v124
    v_exp_f32 v125, v125
    v_exp_f32 v126, v126
    v_exp_f32 v127, v127
    v_cvt_pk_bf16_f32 v148, v120, v121
    v_cvt_pk_bf16_f32 v149, v122, v123
    v_cvt_pk_bf16_f32 v150, v124, v125
    v_cvt_pk_bf16_f32 v151, v126, v127
    v_mfma_f32_32x32x16_bf16 v[112:127], v[160:163], v[32:35], 0
    v_exp_f32 v128, v128
    v_exp_f32 v129, v129
    v_exp_f32 v130, v130
    v_exp_f32 v131, v131
    v_mfma_f32_32x32x16_bf16 v[48:63], v[168:171], v[144:147], v[48:63]
    v_exp_f32 v132, v132
    v_exp_f32 v133, v133
    v_exp_f32 v134, v134
    v_exp_f32 v135, v135
    v_cvt_pk_bf16_f32 v152, v128, v129
    v_cvt_pk_bf16_f32 v153, v130, v131
    v_mfma_f32_32x32x16_bf16 v[112:127], v[164:167], v[36:39], v[112:127]
    global_load_dwordx4 v[208:211], v243, s[66:67] offset:0 sc1
    v_exp_f32 v136, v136
    v_exp_f32 v137, v137
    v_exp_f32 v138, v138
    v_exp_f32 v139, v139
    v_cvt_pk_bf16_f32 v154, v132, v133
    v_cvt_pk_bf16_f32 v155, v134, v135
    v_mfma_f32_32x32x16_bf16 v[48:63], v[172:175], v[148:151], v[48:63]
    global_load_dwordx4 v[212:215], v243, s[66:67] offset:1024 sc1
    v_exp_f32 v140, v140
    v_exp_f32 v141, v141
    v_exp_f32 v142, v142
    v_exp_f32 v143, v143
    v_cvt_pk_bf16_f32 v156, v136, v137
    v_cvt_pk_bf16_f32 v157, v138, v139
    v_cvt_pk_bf16_f32 v158, v140, v141
    v_cvt_pk_bf16_f32 v159, v142, v143
    v_mfma_f32_32x32x16_bf16 v[128:143], v[160:163], v[40:43], 0
    global_load_dwordx4 v[216:219], v243, s[66:67] offset:2048 sc1
    v_exp_f32 v112, v112
    v_exp_f32 v113, v113
    v_exp_f32 v114, v114
    v_exp_f32 v115, v115
    v_mfma_f32_32x32x16_bf16 v[64:79], v[168:171], v[152:155], v[64:79]
    global_load_dwordx4 v[220:223], v243, s[66:67] offset:3072 sc1
    v_exp_f32 v116, v116
    v_exp_f32 v117, v117
    v_exp_f32 v118, v118
    v_exp_f32 v119, v119
    v_cvt_pk_bf16_f32 v144, v112, v113
    v_cvt_pk_bf16_f32 v145, v114, v115
    v_mfma_f32_32x32x16_bf16 v[128:143], v[164:167], v[44:47], v[128:143]
    v_exp_f32 v120, v120
    v_exp_f32 v121, v121
    v_exp_f32 v122, v122
    v_exp_f32 v123, v123
    v_cvt_pk_bf16_f32 v146, v116, v117
    v_cvt_pk_bf16_f32 v147, v118, v119
    v_mfma_f32_32x32x16_bf16 v[64:79], v[172:175], v[156:159], v[64:79]
    s_waitcnt vmcnt(8)
    v_exp_f32 v124, v124
    v_exp_f32 v125, v125
    v_exp_f32 v126, v126
    v_exp_f32 v127, v127
    v_cvt_pk_bf16_f32 v148, v120, v121
    v_cvt_pk_bf16_f32 v149, v122, v123
    v_cvt_pk_bf16_f32 v150, v124, v125
    v_cvt_pk_bf16_f32 v151, v126, v127
    v_mfma_f32_32x32x16_bf16 v[112:127], v[176:179], v[16:19], 0
    v_exp_f32 v128, v128
    v_exp_f32 v129, v129
    v_exp_f32 v130, v130
    v_exp_f32 v131, v131
    v_mfma_f32_32x32x16_bf16 v[80:95], v[168:171], v[144:147], v[80:95]
    v_exp_f32 v132, v132
    v_exp_f32 v133, v133
    v_exp_f32 v134, v134
    v_exp_f32 v135, v135
    v_cvt_pk_bf16_f32 v152, v128, v129
    v_cvt_pk_bf16_f32 v153, v130, v131
    v_mfma_f32_32x32x16_bf16 v[112:127], v[180:183], v[20:23], v[112:127]
    v_exp_f32 v136, v136
    v_exp_f32 v137, v137
    v_exp_f32 v138, v138
    v_exp_f32 v139, v139
    v_cvt_pk_bf16_f32 v154, v132, v133
    v_cvt_pk_bf16_f32 v155, v134, v135
    v_mfma_f32_32x32x16_bf16 v[80:95], v[172:175], v[148:151], v[80:95]
    v_exp_f32 v140, v140
    v_exp_f32 v141, v141
    v_exp_f32 v142, v142
    v_exp_f32 v143, v143
    v_cvt_pk_bf16_f32 v156, v136, v137
    v_cvt_pk_bf16_f32 v157, v138, v139
    v_cvt_pk_bf16_f32 v158, v140, v141
    v_cvt_pk_bf16_f32 v159, v142, v143
    v_mfma_f32_32x32x16_bf16 v[128:143], v[176:179], v[24:27], 0
    v_exp_f32 v112, v112
    v_exp_f32 v113, v113
    v_exp_f32 v114, v114
    v_exp_f32 v115, v115
    v_mfma_f32_32x32x16_bf16 v[96:111], v[168:171], v[152:155], v[96:111]
    v_exp_f32 v116, v116
    v_exp_f32 v117, v117
    v_exp_f32 v118, v118
    v_exp_f32 v119, v119
    v_cvt_pk_bf16_f32 v144, v112, v113
    v_cvt_pk_bf16_f32 v145, v114, v115
    v_mfma_f32_32x32x16_bf16 v[128:143], v[180:183], v[28:31], v[128:143]
    v_exp_f32 v120, v120
    v_exp_f32 v121, v121
    v_exp_f32 v122, v122
    v_exp_f32 v123, v123
    v_cvt_pk_bf16_f32 v146, v116, v117
    v_cvt_pk_bf16_f32 v147, v118, v119
    v_mfma_f32_32x32x16_bf16 v[96:111], v[172:175], v[156:159], v[96:111]
    v_exp_f32 v124, v124
    v_exp_f32 v125, v125
    v_exp_f32 v126, v126
    v_exp_f32 v127, v127
    v_cvt_pk_bf16_f32 v148, v120, v121
    v_cvt_pk_bf16_f32 v149, v122, v123
    v_cvt_pk_bf16_f32 v150, v124, v125
    v_cvt_pk_bf16_f32 v151, v126, v127
    v_mfma_f32_32x32x16_bf16 v[112:127], v[176:179], v[32:35], 0
    s_add_u32 s66, s66, 8192
    v_exp_f32 v128, v128
    v_exp_f32 v129, v129
    v_exp_f32 v130, v130
    v_exp_f32 v131, v131
    v_mfma_f32_32x32x16_bf16 v[48:63], v[184:187], v[144:147], v[48:63]
    s_addc_u32 s67, s67, 0
    v_exp_f32 v132, v132
    v_exp_f32 v133, v133
    v_exp_f32 v134, v134
    v_exp_f32 v135, v135
    v_cvt_pk_bf16_f32 v152, v128, v129
    v_cvt_pk_bf16_f32 v153, v130, v131
    v_mfma_f32_32x32x16_bf16 v[112:127], v[180:183], v[36:39], v[112:127]
    global_load_dwordx4 v[160:163], v243, s[66:67] offset:-4096 sc1
    v_exp_f32 v136, v136
    v_exp_f32 v137, v137
    v_exp_f32 v138, v138
    v_exp_f32 v139, v139
    v_cvt_pk_bf16_f32 v154, v132, v133
    v_cvt_pk_bf16_f32 v155, v134, v135
    v_mfma_f32_32x32x16_bf16 v[48:63], v[188:191], v[148:151], v[48:63]
    global_load_dwordx4 v[164:167], v243, s[66:67] offset:-3072 sc1
    v_exp_f32 v140, v140
    v_exp_f32 v141, v141
    v_exp_f32 v142, v142
    v_exp_f32 v143, v143
    v_cvt_pk_bf16_f32 v156, v136, v137
    v_cvt_pk_bf16_f32 v157, v138, v139
    v_cvt_pk_bf16_f32 v158, v140, v141
    v_cvt_pk_bf16_f32 v159, v142, v143
    v_mfma_f32_32x32x16_bf16 v[128:143], v[176:179], v[40:43], 0
    global_load_dwordx4 v[168:171], v243, s[66:67] offset:-2048 sc1
    v_exp_f32 v112, v112
    v_exp_f32 v113, v113
    v_exp_f32 v114, v114
    v_exp_f32 v115, v115
    v_mfma_f32_32x32x16_bf16 v[64:79], v[184:187], v[152:155], v[64:79]
    global_load_dwordx4 v[172:175], v243, s[66:67] offset:-1024 sc1
    v_exp_f32 v116, v116
    v_exp_f32 v117, v117
    v_exp_f32 v118, v118
    v_exp_f32 v119, v119
    v_cvt_pk_bf16_f32 v144, v112, v113
    v_cvt_pk_bf16_f32 v145, v114, v115
    v_mfma_f32_32x32x16_bf16 v[128:143], v[180:183], v[44:47], v[128:143]
    v_exp_f32 v120, v120
    v_exp_f32 v121, v121
    v_exp_f32 v122, v122
    v_exp_f32 v123, v123
    v_cvt_pk_bf16_f32 v146, v116, v117
    v_cvt_pk_bf16_f32 v147, v118, v119
    v_mfma_f32_32x32x16_bf16 v[64:79], v[188:191], v[156:159], v[64:79]
    s_waitcnt vmcnt(8)
    v_exp_f32 v124, v124
    v_exp_f32 v125, v125
    v_exp_f32 v126, v126
    v_exp_f32 v127, v127
    v_cvt_pk_bf16_f32 v148, v120, v121
    v_cvt_pk_bf16_f32 v149, v122, v123
    v_cvt_pk_bf16_f32 v150, v124, v125
    v_cvt_pk_bf16_f32 v151, v126, v127
    v_mfma_f32_32x32x16_bf16 v[112:127], v[192:195], v[16:19], 0
    v_exp_f32 v128, v128
    v_exp_f32 v129, v129
    v_exp_f32 v130, v130
    v_exp_f32 v131, v131
    v_mfma_f32_32x32x16_bf16 v[80:95], v[184:187], v[144:147], v[80:95]
    v_exp_f32 v132, v132
    v_exp_f32 v133, v133
    v_exp_f32 v134, v134
    v_exp_f32 v135, v135
    v_cvt_pk_bf16_f32 v152, v128, v129
    v_cvt_pk_bf16_f32 v153, v130, v131
    v_mfma_f32_32x32x16_bf16 v[112:127], v[196:199], v[20:23], v[112:127]
    v_exp_f32 v136, v136
    v_exp_f32 v137, v137
    v_exp_f32 v138, v138
    v_exp_f32 v139, v139
    v_cvt_pk_bf16_f32 v154, v132, v133
    v_cvt_pk_bf16_f32 v155, v134, v135
    v_mfma_f32_32x32x16_bf16 v[80:95], v[188:191], v[148:151], v[80:95]
    v_exp_f32 v140, v140
    v_exp_f32 v141, v141
    v_exp_f32 v142, v142
    v_exp_f32 v143, v143
    v_cvt_pk_bf16_f32 v156, v136, v137
    v_cvt_pk_bf16_f32 v157, v138, v139
    v_cvt_pk_bf16_f32 v158, v140, v141
    v_cvt_pk_bf16_f32 v159, v142, v143
    v_mfma_f32_32x32x16_bf16 v[128:143], v[192:195], v[24:27], 0
    v_exp_f32 v112, v112
    v_exp_f32 v113, v113
    v_exp_f32 v114, v114
    v_exp_f32 v115, v115
    v_mfma_f32_32x32x16_bf16 v[96:111], v[184:187], v[152:155], v[96:111]
    v_exp_f32 v116, v116
    v_exp_f32 v117, v117
    v_exp_f32 v118, v118
    v_exp_f32 v119, v119
    v_cvt_pk_bf16_f32 v144, v112, v113
    v_cvt_pk_bf16_f32 v145, v114, v115
    v_mfma_f32_32x32x16_bf16 v[128:143], v[196:199], v[28:31], v[128:143]
    v_exp_f32 v120, v120
    v_exp_f32 v121, v121
    v_exp_f32 v122, v122
    v_exp_f32 v123, v123
    v_cvt_pk_bf16_f32 v146, v116, v117
    v_cvt_pk_bf16_f32 v147, v118, v119
    v_mfma_f32_32x32x16_bf16 v[96:111], v[188:191], v[156:159], v[96:111]
    v_exp_f32 v124, v124
    v_exp_f32 v125, v125
    v_exp_f32 v126, v126
    v_exp_f32 v127, v127
    v_cvt_pk_bf16_f32 v148, v120, v121
    v_cvt_pk_bf16_f32 v149, v122, v123
    v_cvt_pk_bf16_f32 v150, v124, v125
    v_cvt_pk_bf16_f32 v151, v126, v127
    v_mfma_f32_32x32x16_bf16 v[112:127], v[192:195], v[32:35], 0
    v_exp_f32 v128, v128
    v_exp_f32 v129, v129
    v_exp_f32 v130, v130
    v_exp_f32 v131, v131
    v_mfma_f32_32x32x16_bf16 v[48:63], v[200:203], v[144:147], v[48:63]
    v_exp_f32 v132, v132
    v_exp_f32 v133, v133
    v_exp_f32 v134, v134
    v_exp_f32 v135, v135
    v_cvt_pk_bf16_f32 v152, v128, v129
    v_cvt_pk_bf16_f32 v153, v130, v131
    v_mfma_f32_32x32x16_bf16 v[112:127], v[196:199], v[36:39], v[112:127]
    global_load_dwordx4 v[176:179], v243, s[66:67] offset:0 sc1
    v_exp_f32 v136, v136
    v_exp_f32 v137, v137
    v_exp_f32 v138, v138
    v_exp_f32 v139, v139
    v_cvt_pk_bf16_f32 v154, v132, v133
    v_cvt_pk_bf16_f32 v155, v134, v135
    v_mfma_f32_32x32x16_bf16 v[48:63], v[204:207], v[148:151], v[48:63]
    global_load_dwordx4 v[180:183], v243, s[66:67] offset:1024 sc1
    v_exp_f32 v140, v140
    v_exp_f32 v141, v141
    v_exp_f32 v142, v142
    v_exp_f32 v143, v143
    v_cvt_pk_bf16_f32 v156, v136, v137
    v_cvt_pk_bf16_f32 v157, v138, v139
    v_cvt_pk_bf16_f32 v158, v140, v141
    v_cvt_pk_bf16_f32 v159, v142, v143
    v_mfma_f32_32x32x16_bf16 v[128:143], v[192:195], v[40:43], 0
    global_load_dwordx4 v[184:187], v243, s[66:67] offset:2048 sc1
    v_exp_f32 v112, v112
    v_exp_f32 v113, v113
    v_exp_f32 v114, v114
    v_exp_f32 v115, v115
    v_mfma_f32_32x32x16_bf16 v[64:79], v[200:203], v[152:155], v[64:79]
    global_load_dwordx4 v[188:191], v243, s[66:67] offset:3072 sc1
    v_exp_f32 v116, v116
    v_exp_f32 v117, v117
    v_exp_f32 v118, v118
    v_exp_f32 v119, v119
    v_cvt_pk_bf16_f32 v144, v112, v113
    v_cvt_pk_bf16_f32 v145, v114, v115
    v_mfma_f32_32x32x16_bf16 v[128:143], v[196:199], v[44:47], v[128:143]
    v_exp_f32 v120, v120
    v_exp_f32 v121, v121
    v_exp_f32 v122, v122
    v_exp_f32 v123, v123
    v_cvt_pk_bf16_f32 v146, v116, v117
    v_cvt_pk_bf16_f32 v147, v118, v119
    v_mfma_f32_32x32x16_bf16 v[64:79], v[204:207], v[156:159], v[64:79]
    s_waitcnt vmcnt(8)
    v_exp_f32 v124, v124
    v_exp_f32 v125, v125
    v_exp_f32 v126, v126
    v_exp_f32 v127, v127
    v_cvt_pk_bf16_f32 v148, v120, v121
    v_cvt_pk_bf16_f32 v149, v122, v123
    v_cvt_pk_bf16_f32 v150, v124, v125
    v_cvt_pk_bf16_f32 v151, v126, v127
    v_mfma_f32_32x32x16_bf16 v[112:127], v[208:211], v[16:19], 0
    v_exp_f32 v128, v128
    v_exp_f32 v129, v129
    v_exp_f32 v130, v130
    v_exp_f32 v131, v131
    v_mfma_f32_32x32x16_bf16 v[80:95], v[200:203], v[144:147], v[80:95]
    v_exp_f32 v132, v132
    v_exp_f32 v133, v133
    v_exp_f32 v134, v134
    v_exp_f32 v135, v135
    v_cvt_pk_bf16_f32 v152, v128, v129
    v_cvt_pk_bf16_f32 v153, v130, v131
    v_mfma_f32_32x32x16_bf16 v[112:127], v[212:215], v[20:23], v[112:127]
    v_exp_f32 v136, v136
    v_exp_f32 v137, v137
    v_exp_f32 v138, v138
    v_exp_f32 v139, v139
    v_cvt_pk_bf16_f32 v154, v132, v133
    v_cvt_pk_bf16_f32 v155, v134, v135
    v_mfma_f32_32x32x16_bf16 v[80:95], v[204:207], v[148:151], v[80:95]
    v_exp_f32 v140, v140
    v_exp_f32 v141, v141
    v_exp_f32 v142, v142
    v_exp_f32 v143, v143
    v_cvt_pk_bf16_f32 v156, v136, v137
    v_cvt_pk_bf16_f32 v157, v138, v139
    v_cvt_pk_bf16_f32 v158, v140, v141
    v_cvt_pk_bf16_f32 v159, v142, v143
    v_mfma_f32_32x32x16_bf16 v[128:143], v[208:211], v[24:27], 0
    v_exp_f32 v112, v112
    v_exp_f32 v113, v113
    v_exp_f32 v114, v114
    v_exp_f32 v115, v115
    v_mfma_f32_32x32x16_bf16 v[96:111], v[200:203], v[152:155], v[96:111]
    v_exp_f32 v116, v116
    v_exp_f32 v117, v117
    v_exp_f32 v118, v118
    v_exp_f32 v119, v119
    v_cvt_pk_bf16_f32 v144, v112, v113
    v_cvt_pk_bf16_f32 v145, v114, v115
    v_mfma_f32_32x32x16_bf16 v[128:143], v[212:215], v[28:31], v[128:143]
    v_exp_f32 v120, v120
    v_exp_f32 v121, v121
    v_exp_f32 v122, v122
    v_exp_f32 v123, v123
    v_cvt_pk_bf16_f32 v146, v116, v117
    v_cvt_pk_bf16_f32 v147, v118, v119
    v_mfma_f32_32x32x16_bf16 v[96:111], v[204:207], v[156:159], v[96:111]
    v_exp_f32 v124, v124
    v_exp_f32 v125, v125
    v_exp_f32 v126, v126
    v_exp_f32 v127, v127
    v_cvt_pk_bf16_f32 v148, v120, v121
    v_cvt_pk_bf16_f32 v149, v122, v123
    v_cvt_pk_bf16_f32 v150, v124, v125
    v_cvt_pk_bf16_f32 v151, v126, v127
    v_mfma_f32_32x32x16_bf16 v[112:127], v[208:211], v[32:35], 0
    s_add_u32 s66, s66, 8192
    v_exp_f32 v128, v128
    v_exp_f32 v129, v129
    v_exp_f32 v130, v130
    v_exp_f32 v131, v131
    v_mfma_f32_32x32x16_bf16 v[48:63], v[216:219], v[144:147], v[48:63]
    s_addc_u32 s67, s67, 0
    v_exp_f32 v132, v132
    v_exp_f32 v133, v133
    v_exp_f32 v134, v134
    v_exp_f32 v135, v135
    v_cvt_pk_bf16_f32 v152, v128, v129
    v_cvt_pk_bf16_f32 v153, v130, v131
    v_mfma_f32_32x32x16_bf16 v[112:127], v[212:215], v[36:39], v[112:127]
    global_load_dwordx4 v[192:195], v243, s[66:67] offset:-4096 sc1
    v_exp_f32 v136, v136
    v_exp_f32 v137, v137
    v_exp_f32 v138, v138
    v_exp_f32 v139, v139
    v_cvt_pk_bf16_f32 v154, v132, v133
    v_cvt_pk_bf16_f32 v155, v134, v135
    v_mfma_f32_32x32x16_bf16 v[48:63], v[220:223], v[148:151], v[48:63]
    global_load_dwordx4 v[196:199], v243, s[66:67] offset:-3072 sc1
    v_exp_f32 v140, v140
    v_exp_f32 v141, v141
    v_exp_f32 v142, v142
    v_exp_f32 v143, v143
    v_cvt_pk_bf16_f32 v156, v136, v137
    v_cvt_pk_bf16_f32 v157, v138, v139
    v_cvt_pk_bf16_f32 v158, v140, v141
    v_cvt_pk_bf16_f32 v159, v142, v143
    v_mfma_f32_32x32x16_bf16 v[128:143], v[208:211], v[40:43], 0
    global_load_dwordx4 v[200:203], v243, s[66:67] offset:-2048 sc1
    v_exp_f32 v112, v112
    v_exp_f32 v113, v113
    v_exp_f32 v114, v114
    v_exp_f32 v115, v115
    v_mfma_f32_32x32x16_bf16 v[64:79], v[216:219], v[152:155], v[64:79]
    global_load_dwordx4 v[204:207], v243, s[66:67] offset:-1024 sc1
    v_exp_f32 v116, v116
    v_exp_f32 v117, v117
    v_exp_f32 v118, v118
    v_exp_f32 v119, v119
    v_cvt_pk_bf16_f32 v144, v112, v113
    v_cvt_pk_bf16_f32 v145, v114, v115
    v_mfma_f32_32x32x16_bf16 v[128:143], v[212:215], v[44:47], v[128:143]
    v_exp_f32 v120, v120
    v_exp_f32 v121, v121
    v_exp_f32 v122, v122
    v_exp_f32 v123, v123
    v_cvt_pk_bf16_f32 v146, v116, v117
    v_cvt_pk_bf16_f32 v147, v118, v119
    v_mfma_f32_32x32x16_bf16 v[64:79], v[220:223], v[156:159], v[64:79]
    s_waitcnt vmcnt(8)
    v_exp_f32 v124, v124
    v_exp_f32 v125, v125
    v_exp_f32 v126, v126
    v_exp_f32 v127, v127
    v_cvt_pk_bf16_f32 v148, v120, v121
    v_cvt_pk_bf16_f32 v149, v122, v123
    v_cvt_pk_bf16_f32 v150, v124, v125
    v_cvt_pk_bf16_f32 v151, v126, v127
    v_mfma_f32_32x32x16_bf16 v[112:127], v[160:163], v[16:19], 0
    v_exp_f32 v128, v128
    v_exp_f32 v129, v129
    v_exp_f32 v130, v130
    v_exp_f32 v131, v131
    v_mfma_f32_32x32x16_bf16 v[80:95], v[216:219], v[144:147], v[80:95]
    v_exp_f32 v132, v132
    v_exp_f32 v133, v133
    v_exp_f32 v134, v134
    v_exp_f32 v135, v135
    v_cvt_pk_bf16_f32 v152, v128, v129
    v_cvt_pk_bf16_f32 v153, v130, v131
    v_mfma_f32_32x32x16_bf16 v[112:127], v[164:167], v[20:23], v[112:127]
    v_exp_f32 v136, v136
    v_exp_f32 v137, v137
    v_exp_f32 v138, v138
    v_exp_f32 v139, v139
    v_cvt_pk_bf16_f32 v154, v132, v133
    v_cvt_pk_bf16_f32 v155, v134, v135
    v_mfma_f32_32x32x16_bf16 v[80:95], v[220:223], v[148:151], v[80:95]
    v_exp_f32 v140, v140
    v_exp_f32 v141, v141
    v_exp_f32 v142, v142
    v_exp_f32 v143, v143
    v_cvt_pk_bf16_f32 v156, v136, v137
    v_cvt_pk_bf16_f32 v157, v138, v139
    v_cvt_pk_bf16_f32 v158, v140, v141
    v_cvt_pk_bf16_f32 v159, v142, v143
    v_mfma_f32_32x32x16_bf16 v[128:143], v[160:163], v[24:27], 0
    v_exp_f32 v112, v112
    v_exp_f32 v113, v113
    v_exp_f32 v114, v114
    v_exp_f32 v115, v115
    v_mfma_f32_32x32x16_bf16 v[96:111], v[216:219], v[152:155], v[96:111]
    v_exp_f32 v116, v116
    v_exp_f32 v117, v117
    v_exp_f32 v118, v118
    v_exp_f32 v119, v119
    v_cvt_pk_bf16_f32 v144, v112, v113
    v_cvt_pk_bf16_f32 v145, v114, v115
    v_mfma_f32_32x32x16_bf16 v[128:143], v[164:167], v[28:31], v[128:143]
    v_exp_f32 v120, v120
    v_exp_f32 v121, v121
    v_exp_f32 v122, v122
    v_exp_f32 v123, v123
    v_cvt_pk_bf16_f32 v146, v116, v117
    v_cvt_pk_bf16_f32 v147, v118, v119
    v_mfma_f32_32x32x16_bf16 v[96:111], v[220:223], v[156:159], v[96:111]
    v_exp_f32 v124, v124
    v_exp_f32 v125, v125
    v_exp_f32 v126, v126
    v_exp_f32 v127, v127
    v_cvt_pk_bf16_f32 v148, v120, v121
    v_cvt_pk_bf16_f32 v149, v122, v123
    v_cvt_pk_bf16_f32 v150, v124, v125
    v_cvt_pk_bf16_f32 v151, v126, v127
    v_mfma_f32_32x32x16_bf16 v[112:127], v[160:163], v[32:35], 0
    v_exp_f32 v128, v128
    v_exp_f32 v129, v129
    v_exp_f32 v130, v130
    v_exp_f32 v131, v131
    v_mfma_f32_32x32x16_bf16 v[48:63], v[168:171], v[144:147], v[48:63]
    v_exp_f32 v132, v132
    v_exp_f32 v133, v133
    v_exp_f32 v134, v134
    v_exp_f32 v135, v135
    v_cvt_pk_bf16_f32 v152, v128, v129
    v_cvt_pk_bf16_f32 v153, v130, v131
    v_mfma_f32_32x32x16_bf16 v[112:127], v[164:167], v[36:39], v[112:127]
    global_load_dwordx4 v[208:211], v243, s[66:67] offset:0 sc1
    v_exp_f32 v136, v136
    v_exp_f32 v137, v137
    v_exp_f32 v138, v138
    v_exp_f32 v139, v139
    v_cvt_pk_bf16_f32 v154, v132, v133
    v_cvt_pk_bf16_f32 v155, v134, v135
    v_mfma_f32_32x32x16_bf16 v[48:63], v[172:175], v[148:151], v[48:63]
    global_load_dwordx4 v[212:215], v243, s[66:67] offset:1024 sc1
    v_exp_f32 v140, v140
    v_exp_f32 v141, v141
    v_exp_f32 v142, v142
    v_exp_f32 v143, v143
    v_cvt_pk_bf16_f32 v156, v136, v137
    v_cvt_pk_bf16_f32 v157, v138, v139
    v_cvt_pk_bf16_f32 v158, v140, v141
    v_cvt_pk_bf16_f32 v159, v142, v143
    v_mfma_f32_32x32x16_bf16 v[128:143], v[160:163], v[40:43], 0
    global_load_dwordx4 v[216:219], v243, s[66:67] offset:2048 sc1
    v_exp_f32 v112, v112
    v_exp_f32 v113, v113
    v_exp_f32 v114, v114
    v_exp_f32 v115, v115
    v_mfma_f32_32x32x16_bf16 v[64:79], v[168:171], v[152:155], v[64:79]
    global_load_dwordx4 v[220:223], v243, s[66:67] offset:3072 sc1
    v_exp_f32 v116, v116
    v_exp_f32 v117, v117
    v_exp_f32 v118, v118
    v_exp_f32 v119, v119
    v_cvt_pk_bf16_f32 v144, v112, v113
    v_cvt_pk_bf16_f32 v145, v114, v115
    v_mfma_f32_32x32x16_bf16 v[128:143], v[164:167], v[44:47], v[128:143]
    v_exp_f32 v120, v120
    v_exp_f32 v121, v121
    v_exp_f32 v122, v122
    v_exp_f32 v123, v123
    v_cvt_pk_bf16_f32 v146, v116, v117
    v_cvt_pk_bf16_f32 v147, v118, v119
    v_mfma_f32_32x32x16_bf16 v[64:79], v[172:175], v[156:159], v[64:79]
    s_waitcnt vmcnt(8)
    v_exp_f32 v124, v124
    v_exp_f32 v125, v125
    v_exp_f32 v126, v126
    v_exp_f32 v127, v127
    v_cvt_pk_bf16_f32 v148, v120, v121
    v_cvt_pk_bf16_f32 v149, v122, v123
    v_cvt_pk_bf16_f32 v150, v124, v125
    v_cvt_pk_bf16_f32 v151, v126, v127
    v_mfma_f32_32x32x16_bf16 v[112:127], v[176:179], v[16:19], 0
    v_exp_f32 v128, v128
    v_exp_f32 v129, v129
    v_exp_f32 v130, v130
    v_exp_f32 v131, v131
    v_mfma_f32_32x32x16_bf16 v[80:95], v[168:171], v[144:147], v[80:95]
    v_exp_f32 v132, v132
    v_exp_f32 v133, v133
    v_exp_f32 v134, v134
    v_exp_f32 v135, v135
    v_cvt_pk_bf16_f32 v152, v128, v129
    v_cvt_pk_bf16_f32 v153, v130, v131
    v_mfma_f32_32x32x16_bf16 v[112:127], v[180:183], v[20:23], v[112:127]
    v_exp_f32 v136, v136
    v_exp_f32 v137, v137
    v_exp_f32 v138, v138
    v_exp_f32 v139, v139
    v_cvt_pk_bf16_f32 v154, v132, v133
    v_cvt_pk_bf16_f32 v155, v134, v135
    v_mfma_f32_32x32x16_bf16 v[80:95], v[172:175], v[148:151], v[80:95]
    v_exp_f32 v140, v140
    v_exp_f32 v141, v141
    v_exp_f32 v142, v142
    v_exp_f32 v143, v143
    v_cvt_pk_bf16_f32 v156, v136, v137
    v_cvt_pk_bf16_f32 v157, v138, v139
    v_cvt_pk_bf16_f32 v158, v140, v141
    v_cvt_pk_bf16_f32 v159, v142, v143
    v_mfma_f32_32x32x16_bf16 v[128:143], v[176:179], v[24:27], 0
    v_exp_f32 v112, v112
    v_exp_f32 v113, v113
    v_exp_f32 v114, v114
    v_exp_f32 v115, v115
    v_mfma_f32_32x32x16_bf16 v[96:111], v[168:171], v[152:155], v[96:111]
    v_exp_f32 v116, v116
    v_exp_f32 v117, v117
    v_exp_f32 v118, v118
    v_exp_f32 v119, v119
    v_cvt_pk_bf16_f32 v144, v112, v113
    v_cvt_pk_bf16_f32 v145, v114, v115
    v_mfma_f32_32x32x16_bf16 v[128:143], v[180:183], v[28:31], v[128:143]
    v_exp_f32 v120, v120
    v_exp_f32 v121, v121
    v_exp_f32 v122, v122
    v_exp_f32 v123, v123
    v_cvt_pk_bf16_f32 v146, v116, v117
    v_cvt_pk_bf16_f32 v147, v118, v119
    v_mfma_f32_32x32x16_bf16 v[96:111], v[172:175], v[156:159], v[96:111]
    v_exp_f32 v124, v124
    v_exp_f32 v125, v125
    v_exp_f32 v126, v126
    v_exp_f32 v127, v127
    v_cvt_pk_bf16_f32 v148, v120, v121
    v_cvt_pk_bf16_f32 v149, v122, v123
    v_cvt_pk_bf16_f32 v150, v124, v125
    v_cvt_pk_bf16_f32 v151, v126, v127
    v_mfma_f32_32x32x16_bf16 v[112:127], v[176:179], v[32:35], 0
    s_add_u32 s66, s66, 8192
    v_exp_f32 v128, v128
    v_exp_f32 v129, v129
    v_exp_f32 v130, v130
    v_exp_f32 v131, v131
    v_mfma_f32_32x32x16_bf16 v[48:63], v[184:187], v[144:147], v[48:63]
    s_addc_u32 s67, s67, 0
    v_exp_f32 v132, v132
    v_exp_f32 v133, v133
    v_exp_f32 v134, v134
    v_exp_f32 v135, v135
    v_cvt_pk_bf16_f32 v152, v128, v129
    v_cvt_pk_bf16_f32 v153, v130, v131
    v_mfma_f32_32x32x16_bf16 v[112:127], v[180:183], v[36:39], v[112:127]
    global_load_dwordx4 v[160:163], v243, s[66:67] offset:-4096 sc1
    v_exp_f32 v136, v136
    v_exp_f32 v137, v137
    v_exp_f32 v138, v138
    v_exp_f32 v139, v139
    v_cvt_pk_bf16_f32 v154, v132, v133
    v_cvt_pk_bf16_f32 v155, v134, v135
    v_mfma_f32_32x32x16_bf16 v[48:63], v[188:191], v[148:151], v[48:63]
    global_load_dwordx4 v[164:167], v243, s[66:67] offset:-3072 sc1
    v_exp_f32 v140, v140
    v_exp_f32 v141, v141
    v_exp_f32 v142, v142
    v_exp_f32 v143, v143
    v_cvt_pk_bf16_f32 v156, v136, v137
    v_cvt_pk_bf16_f32 v157, v138, v139
    v_cvt_pk_bf16_f32 v158, v140, v141
    v_cvt_pk_bf16_f32 v159, v142, v143
    v_mfma_f32_32x32x16_bf16 v[128:143], v[176:179], v[40:43], 0
    global_load_dwordx4 v[168:171], v243, s[66:67] offset:-2048 sc1
    v_exp_f32 v112, v112
    v_exp_f32 v113, v113
    v_exp_f32 v114, v114
    v_exp_f32 v115, v115
    v_mfma_f32_32x32x16_bf16 v[64:79], v[184:187], v[152:155], v[64:79]
    global_load_dwordx4 v[172:175], v243, s[66:67] offset:-1024 sc1
    v_exp_f32 v116, v116
    v_exp_f32 v117, v117
    v_exp_f32 v118, v118
    v_exp_f32 v119, v119
    v_cvt_pk_bf16_f32 v144, v112, v113
    v_cvt_pk_bf16_f32 v145, v114, v115
    v_mfma_f32_32x32x16_bf16 v[128:143], v[180:183], v[44:47], v[128:143]
    v_exp_f32 v120, v120
    v_exp_f32 v121, v121
    v_exp_f32 v122, v122
    v_exp_f32 v123, v123
    v_cvt_pk_bf16_f32 v146, v116, v117
    v_cvt_pk_bf16_f32 v147, v118, v119
    v_mfma_f32_32x32x16_bf16 v[64:79], v[188:191], v[156:159], v[64:79]
    s_waitcnt vmcnt(8)
    v_exp_f32 v124, v124
    v_exp_f32 v125, v125
    v_exp_f32 v126, v126
    v_exp_f32 v127, v127
    v_cvt_pk_bf16_f32 v148, v120, v121
    v_cvt_pk_bf16_f32 v149, v122, v123
    v_cvt_pk_bf16_f32 v150, v124, v125
    v_cvt_pk_bf16_f32 v151, v126, v127
    v_mfma_f32_32x32x16_bf16 v[112:127], v[192:195], v[16:19], 0
    v_exp_f32 v128, v128
    v_exp_f32 v129, v129
    v_exp_f32 v130, v130
    v_exp_f32 v131, v131
    v_mfma_f32_32x32x16_bf16 v[80:95], v[184:187], v[144:147], v[80:95]
    v_exp_f32 v132, v132
    v_exp_f32 v133, v133
    v_exp_f32 v134, v134
    v_exp_f32 v135, v135
    v_cvt_pk_bf16_f32 v152, v128, v129
    v_cvt_pk_bf16_f32 v153, v130, v131
    v_mfma_f32_32x32x16_bf16 v[112:127], v[196:199], v[20:23], v[112:127]
    v_exp_f32 v136, v136
    v_exp_f32 v137, v137
    v_exp_f32 v138, v138
    v_exp_f32 v139, v139
    v_cvt_pk_bf16_f32 v154, v132, v133
    v_cvt_pk_bf16_f32 v155, v134, v135
    v_mfma_f32_32x32x16_bf16 v[80:95], v[188:191], v[148:151], v[80:95]
    v_exp_f32 v140, v140
    v_exp_f32 v141, v141
    v_exp_f32 v142, v142
    v_exp_f32 v143, v143
    v_cvt_pk_bf16_f32 v156, v136, v137
    v_cvt_pk_bf16_f32 v157, v138, v139
    v_cvt_pk_bf16_f32 v158, v140, v141
    v_cvt_pk_bf16_f32 v159, v142, v143
    v_mfma_f32_32x32x16_bf16 v[128:143], v[192:195], v[24:27], 0
    v_exp_f32 v112, v112
    v_exp_f32 v113, v113
    v_exp_f32 v114, v114
    v_exp_f32 v115, v115
    v_mfma_f32_32x32x16_bf16 v[96:111], v[184:187], v[152:155], v[96:111]
    v_exp_f32 v116, v116
    v_exp_f32 v117, v117
    v_exp_f32 v118, v118
    v_exp_f32 v119, v119
    v_cvt_pk_bf16_f32 v144, v112, v113
    v_cvt_pk_bf16_f32 v145, v114, v115
    v_mfma_f32_32x32x16_bf16 v[128:143], v[196:199], v[28:31], v[128:143]
    v_exp_f32 v120, v120
    v_exp_f32 v121, v121
    v_exp_f32 v122, v122
    v_exp_f32 v123, v123
    v_cvt_pk_bf16_f32 v146, v116, v117
    v_cvt_pk_bf16_f32 v147, v118, v119
    v_mfma_f32_32x32x16_bf16 v[96:111], v[188:191], v[156:159], v[96:111]
    v_exp_f32 v124, v124
    v_exp_f32 v125, v125
    v_exp_f32 v126, v126
    v_exp_f32 v127, v127
    v_cvt_pk_bf16_f32 v148, v120, v121
    v_cvt_pk_bf16_f32 v149, v122, v123
    v_cvt_pk_bf16_f32 v150, v124, v125
    v_cvt_pk_bf16_f32 v151, v126, v127
    v_mfma_f32_32x32x16_bf16 v[112:127], v[192:195], v[32:35], 0
    v_exp_f32 v128, v128
    v_exp_f32 v129, v129
    v_exp_f32 v130, v130
    v_exp_f32 v131, v131
    v_mfma_f32_32x32x16_bf16 v[48:63], v[200:203], v[144:147], v[48:63]
    v_exp_f32 v132, v132
    v_exp_f32 v133, v133
    v_exp_f32 v134, v134
    v_exp_f32 v135, v135
    v_cvt_pk_bf16_f32 v152, v128, v129
    v_cvt_pk_bf16_f32 v153, v130, v131
    v_mfma_f32_32x32x16_bf16 v[112:127], v[196:199], v[36:39], v[112:127]
    global_load_dwordx4 v[176:179], v243, s[66:67] offset:0 sc1
    v_exp_f32 v136, v136
    v_exp_f32 v137, v137
    v_exp_f32 v138, v138
    v_exp_f32 v139, v139
    v_cvt_pk_bf16_f32 v154, v132, v133
    v_cvt_pk_bf16_f32 v155, v134, v135
    v_mfma_f32_32x32x16_bf16 v[48:63], v[204:207], v[148:151], v[48:63]
    global_load_dwordx4 v[180:183], v243, s[66:67] offset:1024 sc1
    v_exp_f32 v140, v140
    v_exp_f32 v141, v141
    v_exp_f32 v142, v142
    v_exp_f32 v143, v143
    v_cvt_pk_bf16_f32 v156, v136, v137
    v_cvt_pk_bf16_f32 v157, v138, v139
    v_cvt_pk_bf16_f32 v158, v140, v141
    v_cvt_pk_bf16_f32 v159, v142, v143
    v_mfma_f32_32x32x16_bf16 v[128:143], v[192:195], v[40:43], 0
    global_load_dwordx4 v[184:187], v243, s[66:67] offset:2048 sc1
    v_exp_f32 v112, v112
    v_exp_f32 v113, v113
    v_exp_f32 v114, v114
    v_exp_f32 v115, v115
    v_mfma_f32_32x32x16_bf16 v[64:79], v[200:203], v[152:155], v[64:79]
    global_load_dwordx4 v[188:191], v243, s[66:67] offset:3072 sc1
    v_exp_f32 v116, v116
    v_exp_f32 v117, v117
    v_exp_f32 v118, v118
    v_exp_f32 v119, v119
    v_cvt_pk_bf16_f32 v144, v112, v113
    v_cvt_pk_bf16_f32 v145, v114, v115
    v_mfma_f32_32x32x16_bf16 v[128:143], v[196:199], v[44:47], v[128:143]
    v_exp_f32 v120, v120
    v_exp_f32 v121, v121
    v_exp_f32 v122, v122
    v_exp_f32 v123, v123
    v_cvt_pk_bf16_f32 v146, v116, v117
    v_cvt_pk_bf16_f32 v147, v118, v119
    v_mfma_f32_32x32x16_bf16 v[64:79], v[204:207], v[156:159], v[64:79]
    s_waitcnt vmcnt(8)
    v_exp_f32 v124, v124
    v_exp_f32 v125, v125
    v_exp_f32 v126, v126
    v_exp_f32 v127, v127
    v_cvt_pk_bf16_f32 v148, v120, v121
    v_cvt_pk_bf16_f32 v149, v122, v123
    v_cvt_pk_bf16_f32 v150, v124, v125
    v_cvt_pk_bf16_f32 v151, v126, v127
    v_mfma_f32_32x32x16_bf16 v[112:127], v[208:211], v[16:19], 0
    v_exp_f32 v128, v128
    v_exp_f32 v129, v129
    v_exp_f32 v130, v130
    v_exp_f32 v131, v131
    v_mfma_f32_32x32x16_bf16 v[80:95], v[200:203], v[144:147], v[80:95]
    v_exp_f32 v132, v132
    v_exp_f32 v133, v133
    v_exp_f32 v134, v134
    v_exp_f32 v135, v135
    v_cvt_pk_bf16_f32 v152, v128, v129
    v_cvt_pk_bf16_f32 v153, v130, v131
    v_mfma_f32_32x32x16_bf16 v[112:127], v[212:215], v[20:23], v[112:127]
    v_exp_f32 v136, v136
    v_exp_f32 v137, v137
    v_exp_f32 v138, v138
    v_exp_f32 v139, v139
    v_cvt_pk_bf16_f32 v154, v132, v133
    v_cvt_pk_bf16_f32 v155, v134, v135
    v_mfma_f32_32x32x16_bf16 v[80:95], v[204:207], v[148:151], v[80:95]
    v_exp_f32 v140, v140
    v_exp_f32 v141, v141
    v_exp_f32 v142, v142
    v_exp_f32 v143, v143
    v_cvt_pk_bf16_f32 v156, v136, v137
    v_cvt_pk_bf16_f32 v157, v138, v139
    v_cvt_pk_bf16_f32 v158, v140, v141
    v_cvt_pk_bf16_f32 v159, v142, v143
    v_mfma_f32_32x32x16_bf16 v[128:143], v[208:211], v[24:27], 0
    v_exp_f32 v112, v112
    v_exp_f32 v113, v113
    v_exp_f32 v114, v114
    v_exp_f32 v115, v115
    v_mfma_f32_32x32x16_bf16 v[96:111], v[200:203], v[152:155], v[96:111]
    v_exp_f32 v116, v116
    v_exp_f32 v117, v117
    v_exp_f32 v118, v118
    v_exp_f32 v119, v119
    v_cvt_pk_bf16_f32 v144, v112, v113
    v_cvt_pk_bf16_f32 v145, v114, v115
    v_mfma_f32_32x32x16_bf16 v[128:143], v[212:215], v[28:31], v[128:143]
    v_exp_f32 v120, v120
    v_exp_f32 v121, v121
    v_exp_f32 v122, v122
    v_exp_f32 v123, v123
    v_cvt_pk_bf16_f32 v146, v116, v117
    v_cvt_pk_bf16_f32 v147, v118, v119
    v_mfma_f32_32x32x16_bf16 v[96:111], v[204:207], v[156:159], v[96:111]
    v_exp_f32 v124, v124
    v_exp_f32 v125, v125
    v_exp_f32 v126, v126
    v_exp_f32 v127, v127
    v_cvt_pk_bf16_f32 v148, v120, v121
    v_cvt_pk_bf16_f32 v149, v122, v123
    v_cvt_pk_bf16_f32 v150, v124, v125
    v_cvt_pk_bf16_f32 v151, v126, v127
    v_mfma_f32_32x32x16_bf16 v[112:127], v[208:211], v[32:35], 0
    s_add_u32 s66, s66, 8192
    v_exp_f32 v128, v128
    v_exp_f32 v129, v129
    v_exp_f32 v130, v130
    v_exp_f32 v131, v131
    v_mfma_f32_32x32x16_bf16 v[48:63], v[216:219], v[144:147], v[48:63]
    s_addc_u32 s67, s67, 0
    v_exp_f32 v132, v132
    v_exp_f32 v133, v133
    v_exp_f32 v134, v134
    v_exp_f32 v135, v135
    v_cvt_pk_bf16_f32 v152, v128, v129
    v_cvt_pk_bf16_f32 v153, v130, v131
    v_mfma_f32_32x32x16_bf16 v[112:127], v[212:215], v[36:39], v[112:127]
    global_load_dwordx4 v[192:195], v243, s[66:67] offset:-4096 sc1
    v_exp_f32 v136, v136
    v_exp_f32 v137, v137
    v_exp_f32 v138, v138
    v_exp_f32 v139, v139
    v_cvt_pk_bf16_f32 v154, v132, v133
    v_cvt_pk_bf16_f32 v155, v134, v135
    v_mfma_f32_32x32x16_bf16 v[48:63], v[220:223], v[148:151], v[48:63]
    global_load_dwordx4 v[196:199], v243, s[66:67] offset:-3072 sc1
    v_exp_f32 v140, v140
    v_exp_f32 v141, v141
    v_exp_f32 v142, v142
    v_exp_f32 v143, v143
    v_cvt_pk_bf16_f32 v156, v136, v137
    v_cvt_pk_bf16_f32 v157, v138, v139
    v_cvt_pk_bf16_f32 v158, v140, v141
    v_cvt_pk_bf16_f32 v159, v142, v143
    v_mfma_f32_32x32x16_bf16 v[128:143], v[208:211], v[40:43], 0
    global_load_dwordx4 v[200:203], v243, s[66:67] offset:-2048 sc1
    v_exp_f32 v112, v112
    v_exp_f32 v113, v113
    v_exp_f32 v114, v114
    v_exp_f32 v115, v115
    v_mfma_f32_32x32x16_bf16 v[64:79], v[216:219], v[152:155], v[64:79]
    global_load_dwordx4 v[204:207], v243, s[66:67] offset:-1024 sc1
    v_exp_f32 v116, v116
    v_exp_f32 v117, v117
    v_exp_f32 v118, v118
    v_exp_f32 v119, v119
    v_cvt_pk_bf16_f32 v144, v112, v113
    v_cvt_pk_bf16_f32 v145, v114, v115
    v_mfma_f32_32x32x16_bf16 v[128:143], v[212:215], v[44:47], v[128:143]
    v_exp_f32 v120, v120
    v_exp_f32 v121, v121
    v_exp_f32 v122, v122
    v_exp_f32 v123, v123
    v_cvt_pk_bf16_f32 v146, v116, v117
    v_cvt_pk_bf16_f32 v147, v118, v119
    v_mfma_f32_32x32x16_bf16 v[64:79], v[220:223], v[156:159], v[64:79]
    s_waitcnt vmcnt(8)
    v_exp_f32 v124, v124
    v_exp_f32 v125, v125
    v_exp_f32 v126, v126
    v_exp_f32 v127, v127
    v_cvt_pk_bf16_f32 v148, v120, v121
    v_cvt_pk_bf16_f32 v149, v122, v123
    v_cvt_pk_bf16_f32 v150, v124, v125
    v_cvt_pk_bf16_f32 v151, v126, v127
    v_mfma_f32_32x32x16_bf16 v[112:127], v[160:163], v[16:19], 0
    v_exp_f32 v128, v128
    v_exp_f32 v129, v129
    v_exp_f32 v130, v130
    v_exp_f32 v131, v131
    v_mfma_f32_32x32x16_bf16 v[80:95], v[216:219], v[144:147], v[80:95]
    v_exp_f32 v132, v132
    v_exp_f32 v133, v133
    v_exp_f32 v134, v134
    v_exp_f32 v135, v135
    v_cvt_pk_bf16_f32 v152, v128, v129
    v_cvt_pk_bf16_f32 v153, v130, v131
    v_mfma_f32_32x32x16_bf16 v[112:127], v[164:167], v[20:23], v[112:127]
    v_exp_f32 v136, v136
    v_exp_f32 v137, v137
    v_exp_f32 v138, v138
    v_exp_f32 v139, v139
    v_cvt_pk_bf16_f32 v154, v132, v133
    v_cvt_pk_bf16_f32 v155, v134, v135
    v_mfma_f32_32x32x16_bf16 v[80:95], v[220:223], v[148:151], v[80:95]
    v_exp_f32 v140, v140
    v_exp_f32 v141, v141
    v_exp_f32 v142, v142
    v_exp_f32 v143, v143
    v_cvt_pk_bf16_f32 v156, v136, v137
    v_cvt_pk_bf16_f32 v157, v138, v139
    v_cvt_pk_bf16_f32 v158, v140, v141
    v_cvt_pk_bf16_f32 v159, v142, v143
    v_mfma_f32_32x32x16_bf16 v[128:143], v[160:163], v[24:27], 0
    v_exp_f32 v112, v112
    v_exp_f32 v113, v113
    v_exp_f32 v114, v114
    v_exp_f32 v115, v115
    v_mfma_f32_32x32x16_bf16 v[96:111], v[216:219], v[152:155], v[96:111]
    v_exp_f32 v116, v116
    v_exp_f32 v117, v117
    v_exp_f32 v118, v118
    v_exp_f32 v119, v119
    v_cvt_pk_bf16_f32 v144, v112, v113
    v_cvt_pk_bf16_f32 v145, v114, v115
    v_mfma_f32_32x32x16_bf16 v[128:143], v[164:167], v[28:31], v[128:143]
    v_exp_f32 v120, v120
    v_exp_f32 v121, v121
    v_exp_f32 v122, v122
    v_exp_f32 v123, v123
    v_cvt_pk_bf16_f32 v146, v116, v117
    v_cvt_pk_bf16_f32 v147, v118, v119
    v_mfma_f32_32x32x16_bf16 v[96:111], v[220:223], v[156:159], v[96:111]
    v_exp_f32 v124, v124
    v_exp_f32 v125, v125
    v_exp_f32 v126, v126
    v_exp_f32 v127, v127
    v_cvt_pk_bf16_f32 v148, v120, v121
    v_cvt_pk_bf16_f32 v149, v122, v123
    v_cvt_pk_bf16_f32 v150, v124, v125
    v_cvt_pk_bf16_f32 v151, v126, v127
    v_mfma_f32_32x32x16_bf16 v[112:127], v[160:163], v[32:35], 0
    v_exp_f32 v128, v128
    v_exp_f32 v129, v129
    v_exp_f32 v130, v130
    v_exp_f32 v131, v131
    v_mfma_f32_32x32x16_bf16 v[48:63], v[168:171], v[144:147], v[48:63]
    v_exp_f32 v132, v132
    v_exp_f32 v133, v133
    v_exp_f32 v134, v134
    v_exp_f32 v135, v135
    v_cvt_pk_bf16_f32 v152, v128, v129
    v_cvt_pk_bf16_f32 v153, v130, v131
    v_mfma_f32_32x32x16_bf16 v[112:127], v[164:167], v[36:39], v[112:127]
    global_load_dwordx4 v[208:211], v243, s[66:67] offset:0 sc1
    v_exp_f32 v136, v136
    v_exp_f32 v137, v137
    v_exp_f32 v138, v138
    v_exp_f32 v139, v139
    v_cvt_pk_bf16_f32 v154, v132, v133
    v_cvt_pk_bf16_f32 v155, v134, v135
    v_mfma_f32_32x32x16_bf16 v[48:63], v[172:175], v[148:151], v[48:63]
    global_load_dwordx4 v[212:215], v243, s[66:67] offset:1024 sc1
    v_exp_f32 v140, v140
    v_exp_f32 v141, v141
    v_exp_f32 v142, v142
    v_exp_f32 v143, v143
    v_cvt_pk_bf16_f32 v156, v136, v137
    v_cvt_pk_bf16_f32 v157, v138, v139
    v_cvt_pk_bf16_f32 v158, v140, v141
    v_cvt_pk_bf16_f32 v159, v142, v143
    v_mfma_f32_32x32x16_bf16 v[128:143], v[160:163], v[40:43], 0
    global_load_dwordx4 v[216:219], v243, s[66:67] offset:2048 sc1
    v_exp_f32 v112, v112
    v_exp_f32 v113, v113
    v_exp_f32 v114, v114
    v_exp_f32 v115, v115
    v_mfma_f32_32x32x16_bf16 v[64:79], v[168:171], v[152:155], v[64:79]
    global_load_dwordx4 v[220:223], v243, s[66:67] offset:3072 sc1
    v_exp_f32 v116, v116
    v_exp_f32 v117, v117
    v_exp_f32 v118, v118
    v_exp_f32 v119, v119
    v_cvt_pk_bf16_f32 v144, v112, v113
    v_cvt_pk_bf16_f32 v145, v114, v115
    v_mfma_f32_32x32x16_bf16 v[128:143], v[164:167], v[44:47], v[128:143]
    v_exp_f32 v120, v120
    v_exp_f32 v121, v121
    v_exp_f32 v122, v122
    v_exp_f32 v123, v123
    v_cvt_pk_bf16_f32 v146, v116, v117
    v_cvt_pk_bf16_f32 v147, v118, v119
    v_mfma_f32_32x32x16_bf16 v[64:79], v[172:175], v[156:159], v[64:79]
    s_waitcnt vmcnt(8)
    v_exp_f32 v124, v124
    v_exp_f32 v125, v125
    v_exp_f32 v126, v126
    v_exp_f32 v127, v127
    v_cvt_pk_bf16_f32 v148, v120, v121
    v_cvt_pk_bf16_f32 v149, v122, v123
    v_cvt_pk_bf16_f32 v150, v124, v125
    v_cvt_pk_bf16_f32 v151, v126, v127
    v_mfma_f32_32x32x16_bf16 v[112:127], v[176:179], v[16:19], 0
    v_exp_f32 v128, v128
    v_exp_f32 v129, v129
    v_exp_f32 v130, v130
    v_exp_f32 v131, v131
    v_mfma_f32_32x32x16_bf16 v[80:95], v[168:171], v[144:147], v[80:95]
    v_exp_f32 v132, v132
    v_exp_f32 v133, v133
    v_exp_f32 v134, v134
    v_exp_f32 v135, v135
    v_cvt_pk_bf16_f32 v152, v128, v129
    v_cvt_pk_bf16_f32 v153, v130, v131
    v_mfma_f32_32x32x16_bf16 v[112:127], v[180:183], v[20:23], v[112:127]
    v_exp_f32 v136, v136
    v_exp_f32 v137, v137
    v_exp_f32 v138, v138
    v_exp_f32 v139, v139
    v_cvt_pk_bf16_f32 v154, v132, v133
    v_cvt_pk_bf16_f32 v155, v134, v135
    v_mfma_f32_32x32x16_bf16 v[80:95], v[172:175], v[148:151], v[80:95]
    v_exp_f32 v140, v140
    v_exp_f32 v141, v141
    v_exp_f32 v142, v142
    v_exp_f32 v143, v143
    v_cvt_pk_bf16_f32 v156, v136, v137
    v_cvt_pk_bf16_f32 v157, v138, v139
    v_cvt_pk_bf16_f32 v158, v140, v141
    v_cvt_pk_bf16_f32 v159, v142, v143
    v_mfma_f32_32x32x16_bf16 v[128:143], v[176:179], v[24:27], 0
    v_exp_f32 v112, v112
    v_exp_f32 v113, v113
    v_exp_f32 v114, v114
    v_exp_f32 v115, v115
    v_mfma_f32_32x32x16_bf16 v[96:111], v[168:171], v[152:155], v[96:111]
    v_exp_f32 v116, v116
    v_exp_f32 v117, v117
    v_exp_f32 v118, v118
    v_exp_f32 v119, v119
    v_cvt_pk_bf16_f32 v144, v112, v113
    v_cvt_pk_bf16_f32 v145, v114, v115
    v_mfma_f32_32x32x16_bf16 v[128:143], v[180:183], v[28:31], v[128:143]
    v_exp_f32 v120, v120
    v_exp_f32 v121, v121
    v_exp_f32 v122, v122
    v_exp_f32 v123, v123
    v_cvt_pk_bf16_f32 v146, v116, v117
    v_cvt_pk_bf16_f32 v147, v118, v119
    v_mfma_f32_32x32x16_bf16 v[96:111], v[172:175], v[156:159], v[96:111]
    v_exp_f32 v124, v124
    v_exp_f32 v125, v125
    v_exp_f32 v126, v126
    v_exp_f32 v127, v127
    v_cvt_pk_bf16_f32 v148, v120, v121
    v_cvt_pk_bf16_f32 v149, v122, v123
    v_cvt_pk_bf16_f32 v150, v124, v125
    v_cvt_pk_bf16_f32 v151, v126, v127
    v_mfma_f32_32x32x16_bf16 v[112:127], v[176:179], v[32:35], 0
    v_exp_f32 v128, v128
    v_exp_f32 v129, v129
    v_exp_f32 v130, v130
    v_exp_f32 v131, v131
    v_mfma_f32_32x32x16_bf16 v[48:63], v[184:187], v[144:147], v[48:63]
    v_exp_f32 v132, v132
    v_exp_f32 v133, v133
    v_exp_f32 v134, v134
    v_exp_f32 v135, v135
    v_cvt_pk_bf16_f32 v152, v128, v129
    v_cvt_pk_bf16_f32 v153, v130, v131
    v_mfma_f32_32x32x16_bf16 v[112:127], v[180:183], v[36:39], v[112:127]
    v_exp_f32 v136, v136
    v_exp_f32 v137, v137
    v_exp_f32 v138, v138
    v_exp_f32 v139, v139
    v_cvt_pk_bf16_f32 v154, v132, v133
    v_cvt_pk_bf16_f32 v155, v134, v135
    v_mfma_f32_32x32x16_bf16 v[48:63], v[188:191], v[148:151], v[48:63]
    v_exp_f32 v140, v140
    v_exp_f32 v141, v141
    v_exp_f32 v142, v142
    v_exp_f32 v143, v143
    v_cvt_pk_bf16_f32 v156, v136, v137
    v_cvt_pk_bf16_f32 v157, v138, v139
    v_cvt_pk_bf16_f32 v158, v140, v141
    v_cvt_pk_bf16_f32 v159, v142, v143
    v_mfma_f32_32x32x16_bf16 v[128:143], v[176:179], v[40:43], 0
    v_exp_f32 v112, v112
    v_exp_f32 v113, v113
    v_exp_f32 v114, v114
    v_exp_f32 v115, v115
    v_mfma_f32_32x32x16_bf16 v[64:79], v[184:187], v[152:155], v[64:79]
    v_exp_f32 v116, v116
    v_exp_f32 v117, v117
    v_exp_f32 v118, v118
    v_exp_f32 v119, v119
    v_cvt_pk_bf16_f32 v144, v112, v113
    v_cvt_pk_bf16_f32 v145, v114, v115
    v_mfma_f32_32x32x16_bf16 v[128:143], v[180:183], v[44:47], v[128:143]
    v_exp_f32 v120, v120
    v_exp_f32 v121, v121
    v_exp_f32 v122, v122
    v_exp_f32 v123, v123
    v_cvt_pk_bf16_f32 v146, v116, v117
    v_cvt_pk_bf16_f32 v147, v118, v119
    v_mfma_f32_32x32x16_bf16 v[64:79], v[188:191], v[156:159], v[64:79]
    s_waitcnt vmcnt(4)
    v_exp_f32 v124, v124
    v_exp_f32 v125, v125
    v_exp_f32 v126, v126
    v_exp_f32 v127, v127
    v_cvt_pk_bf16_f32 v148, v120, v121
    v_cvt_pk_bf16_f32 v149, v122, v123
    v_cvt_pk_bf16_f32 v150, v124, v125
    v_cvt_pk_bf16_f32 v151, v126, v127
    v_mfma_f32_32x32x16_bf16 v[112:127], v[192:195], v[16:19], 0
    v_exp_f32 v128, v128
    v_exp_f32 v129, v129
    v_exp_f32 v130, v130
    v_exp_f32 v131, v131
    v_mfma_f32_32x32x16_bf16 v[80:95], v[184:187], v[144:147], v[80:95]
    v_exp_f32 v132, v132
    v_exp_f32 v133, v133
    v_exp_f32 v134, v134
    v_exp_f32 v135, v135
    v_cvt_pk_bf16_f32 v152, v128, v129
    v_cvt_pk_bf16_f32 v153, v130, v131
    v_mfma_f32_32x32x16_bf16 v[112:127], v[196:199], v[20:23], v[112:127]
    v_exp_f32 v136, v136
    v_exp_f32 v137, v137
    v_exp_f32 v138, v138
    v_exp_f32 v139, v139
    v_cvt_pk_bf16_f32 v154, v132, v133
    v_cvt_pk_bf16_f32 v155, v134, v135
    v_mfma_f32_32x32x16_bf16 v[80:95], v[188:191], v[148:151], v[80:95]
    v_exp_f32 v140, v140
    v_exp_f32 v141, v141
    v_exp_f32 v142, v142
    v_exp_f32 v143, v143
    v_cvt_pk_bf16_f32 v156, v136, v137
    v_cvt_pk_bf16_f32 v157, v138, v139
    v_cvt_pk_bf16_f32 v158, v140, v141
    v_cvt_pk_bf16_f32 v159, v142, v143
    v_mfma_f32_32x32x16_bf16 v[128:143], v[192:195], v[24:27], 0
    v_exp_f32 v112, v112
    v_exp_f32 v113, v113
    v_exp_f32 v114, v114
    v_exp_f32 v115, v115
    v_mfma_f32_32x32x16_bf16 v[96:111], v[184:187], v[152:155], v[96:111]
    v_exp_f32 v116, v116
    v_exp_f32 v117, v117
    v_exp_f32 v118, v118
    v_exp_f32 v119, v119
    v_cvt_pk_bf16_f32 v144, v112, v113
    v_cvt_pk_bf16_f32 v145, v114, v115
    v_mfma_f32_32x32x16_bf16 v[128:143], v[196:199], v[28:31], v[128:143]
    v_exp_f32 v120, v120
    v_exp_f32 v121, v121
    v_exp_f32 v122, v122
    v_exp_f32 v123, v123
    v_cvt_pk_bf16_f32 v146, v116, v117
    v_cvt_pk_bf16_f32 v147, v118, v119
    v_mfma_f32_32x32x16_bf16 v[96:111], v[188:191], v[156:159], v[96:111]
    v_exp_f32 v124, v124
    v_exp_f32 v125, v125
    v_exp_f32 v126, v126
    v_exp_f32 v127, v127
    v_cvt_pk_bf16_f32 v148, v120, v121
    v_cvt_pk_bf16_f32 v149, v122, v123
    v_cvt_pk_bf16_f32 v150, v124, v125
    v_cvt_pk_bf16_f32 v151, v126, v127
    v_mfma_f32_32x32x16_bf16 v[112:127], v[192:195], v[32:35], 0
    v_exp_f32 v128, v128
    v_exp_f32 v129, v129
    v_exp_f32 v130, v130
    v_exp_f32 v131, v131
    v_mfma_f32_32x32x16_bf16 v[48:63], v[200:203], v[144:147], v[48:63]
    v_exp_f32 v132, v132
    v_exp_f32 v133, v133
    v_exp_f32 v134, v134
    v_exp_f32 v135, v135
    v_cvt_pk_bf16_f32 v152, v128, v129
    v_cvt_pk_bf16_f32 v153, v130, v131
    v_mfma_f32_32x32x16_bf16 v[112:127], v[196:199], v[36:39], v[112:127]
    v_exp_f32 v136, v136
    v_exp_f32 v137, v137
    v_exp_f32 v138, v138
    v_exp_f32 v139, v139
    v_cvt_pk_bf16_f32 v154, v132, v133
    v_cvt_pk_bf16_f32 v155, v134, v135
    v_mfma_f32_32x32x16_bf16 v[48:63], v[204:207], v[148:151], v[48:63]
    v_exp_f32 v140, v140
    v_exp_f32 v141, v141
    v_exp_f32 v142, v142
    v_exp_f32 v143, v143
    v_cvt_pk_bf16_f32 v156, v136, v137
    v_cvt_pk_bf16_f32 v157, v138, v139
    v_cvt_pk_bf16_f32 v158, v140, v141
    v_cvt_pk_bf16_f32 v159, v142, v143
    v_mfma_f32_32x32x16_bf16 v[128:143], v[192:195], v[40:43], 0
    v_exp_f32 v112, v112
    v_exp_f32 v113, v113
    v_exp_f32 v114, v114
    v_exp_f32 v115, v115
    v_mfma_f32_32x32x16_bf16 v[64:79], v[200:203], v[152:155], v[64:79]
    v_exp_f32 v116, v116
    v_exp_f32 v117, v117
    v_exp_f32 v118, v118
    v_exp_f32 v119, v119
    v_cvt_pk_bf16_f32 v144, v112, v113
    v_cvt_pk_bf16_f32 v145, v114, v115
    v_mfma_f32_32x32x16_bf16 v[128:143], v[196:199], v[44:47], v[128:143]
    v_exp_f32 v120, v120
    v_exp_f32 v121, v121
    v_exp_f32 v122, v122
    v_exp_f32 v123, v123
    v_cvt_pk_bf16_f32 v146, v116, v117
    v_cvt_pk_bf16_f32 v147, v118, v119
    v_mfma_f32_32x32x16_bf16 v[64:79], v[204:207], v[156:159], v[64:79]
    s_waitcnt vmcnt(0)
    v_exp_f32 v124, v124
    v_exp_f32 v125, v125
    v_exp_f32 v126, v126
    v_exp_f32 v127, v127
    v_cvt_pk_bf16_f32 v148, v120, v121
    v_cvt_pk_bf16_f32 v149, v122, v123
    v_cvt_pk_bf16_f32 v150, v124, v125
    v_cvt_pk_bf16_f32 v151, v126, v127
    v_mfma_f32_32x32x16_bf16 v[112:127], v[208:211], v[24:27], 0
    v_exp_f32 v128, v128
    v_exp_f32 v129, v129
    v_exp_f32 v130, v130
    v_exp_f32 v131, v131
    v_mfma_f32_32x32x16_bf16 v[80:95], v[200:203], v[144:147], v[80:95]
    v_exp_f32 v132, v132
    v_exp_f32 v133, v133
    v_exp_f32 v134, v134
    v_exp_f32 v135, v135
    v_cvt_pk_bf16_f32 v152, v128, v129
    v_cvt_pk_bf16_f32 v153, v130, v131
    v_mfma_f32_32x32x16_bf16 v[112:127], v[212:215], v[28:31], v[112:127]
    v_exp_f32 v136, v136
    v_exp_f32 v137, v137
    v_exp_f32 v138, v138
    v_exp_f32 v139, v139
    v_cvt_pk_bf16_f32 v154, v132, v133
    v_cvt_pk_bf16_f32 v155, v134, v135
    v_mfma_f32_32x32x16_bf16 v[80:95], v[204:207], v[148:151], v[80:95]
    v_exp_f32 v140, v140
    v_exp_f32 v141, v141
    v_exp_f32 v142, v142
    v_exp_f32 v143, v143
    v_cvt_pk_bf16_f32 v156, v136, v137
    v_cvt_pk_bf16_f32 v157, v138, v139
    v_cvt_pk_bf16_f32 v158, v140, v141
    v_cvt_pk_bf16_f32 v159, v142, v143
    v_mfma_f32_32x32x16_bf16 v[128:143], v[208:211], v[32:35], 0
    v_exp_f32 v112, v112
    v_exp_f32 v113, v113
    v_exp_f32 v114, v114
    v_exp_f32 v115, v115
    v_mfma_f32_32x32x16_bf16 v[96:111], v[200:203], v[152:155], v[96:111]
    v_exp_f32 v116, v116
    v_exp_f32 v117, v117
    v_exp_f32 v118, v118
    v_exp_f32 v119, v119
    v_cvt_pk_bf16_f32 v144, v112, v113
    v_cvt_pk_bf16_f32 v145, v114, v115
    v_mfma_f32_32x32x16_bf16 v[128:143], v[212:215], v[36:39], v[128:143]
    v_exp_f32 v120, v120
    v_exp_f32 v121, v121
    v_exp_f32 v122, v122
    v_exp_f32 v123, v123
    v_cvt_pk_bf16_f32 v146, v116, v117
    v_cvt_pk_bf16_f32 v147, v118, v119
    v_mfma_f32_32x32x16_bf16 v[96:111], v[204:207], v[156:159], v[96:111]
    v_exp_f32 v124, v124
    v_exp_f32 v125, v125
    v_exp_f32 v126, v126
    v_exp_f32 v127, v127
    v_cvt_pk_bf16_f32 v148, v120, v121
    v_cvt_pk_bf16_f32 v149, v122, v123
    v_cvt_pk_bf16_f32 v150, v124, v125
    v_cvt_pk_bf16_f32 v151, v126, v127
    v_mfma_f32_32x32x16_bf16 v[112:127], v[208:211], v[40:43], 0
    ds_write_b32 v250, v245 offset:3072
    v_exp_f32 v128, v128
    v_exp_f32 v129, v129
    v_exp_f32 v130, v130
    v_exp_f32 v131, v131
    v_mfma_f32_32x32x16_bf16 v[64:79], v[216:219], v[144:147], v[64:79]
    v_exp_f32 v132, v132
    v_exp_f32 v133, v133
    v_exp_f32 v134, v134
    v_exp_f32 v135, v135
    v_cvt_pk_bf16_f32 v152, v128, v129
    v_cvt_pk_bf16_f32 v153, v130, v131
    v_mfma_f32_32x32x16_bf16 v[112:127], v[212:215], v[44:47], v[112:127]
    v_exp_f32 v136, v136
    v_exp_f32 v137, v137
    v_exp_f32 v138, v138
    v_exp_f32 v139, v139
    v_cvt_pk_bf16_f32 v154, v132, v133
    v_cvt_pk_bf16_f32 v155, v134, v135
    v_mfma_f32_32x32x16_bf16 v[64:79], v[220:223], v[148:151], v[64:79]
    v_exp_f32 v140, v140
    v_exp_f32 v141, v141
    v_exp_f32 v142, v142
    v_exp_f32 v143, v143
    v_cvt_pk_bf16_f32 v156, v136, v137
    v_cvt_pk_bf16_f32 v157, v138, v139
    v_cvt_pk_bf16_f32 v158, v140, v141
    v_cvt_pk_bf16_f32 v159, v142, v143
    v_mfma_f32_32x32x16_bf16 v[128:143], v[208:211], v[16:19], 0
    v_exp_f32 v112, v112
    v_exp_f32 v113, v113
    v_exp_f32 v114, v114
    v_exp_f32 v115, v115
    v_mfma_f32_32x32x16_bf16 v[80:95], v[216:219], v[152:155], v[80:95]
    ds_write_b128 v250, v[64:67] offset:0
    v_exp_f32 v116, v116
    v_exp_f32 v117, v117
    v_exp_f32 v118, v118
    v_exp_f32 v119, v119
    v_cvt_pk_bf16_f32 v144, v112, v113
    v_cvt_pk_bf16_f32 v145, v114, v115
    v_mfma_f32_32x32x16_bf16 v[128:143], v[212:215], v[20:23], v[128:143]
    ds_write_b128 v250, v[68:71] offset:1024
    v_exp_f32 v120, v120
    v_exp_f32 v121, v121
    v_exp_f32 v122, v122
    v_exp_f32 v123, v123
    v_cvt_pk_bf16_f32 v146, v116, v117
    v_cvt_pk_bf16_f32 v147, v118, v119
    v_mfma_f32_32x32x16_bf16 v[80:95], v[220:223], v[156:159], v[80:95]
    ds_write_b128 v250, v[72:75] offset:2048
    v_exp_f32 v124, v124
    v_exp_f32 v125, v125
    v_exp_f32 v126, v126
    v_exp_f32 v127, v127
    v_cvt_pk_bf16_f32 v148, v120, v121
    v_cvt_pk_bf16_f32 v149, v122, v123
    v_cvt_pk_bf16_f32 v150, v124, v125
    v_cvt_pk_bf16_f32 v151, v126, v127
    v_exp_f32 v128, v128
    v_exp_f32 v129, v129
    v_exp_f32 v130, v130
    v_exp_f32 v131, v131
    v_mfma_f32_32x32x16_bf16 v[96:111], v[216:219], v[144:147], v[96:111]
    ds_write_b128 v251, v[80:83] offset:4096
    ds_write_b128 v251, v[84:87] offset:5120
    v_exp_f32 v132, v132
    v_exp_f32 v133, v133
    v_exp_f32 v134, v134
    v_exp_f32 v135, v135
    v_cvt_pk_bf16_f32 v152, v128, v129
    v_cvt_pk_bf16_f32 v153, v130, v131
    v_exp_f32 v136, v136
    v_exp_f32 v137, v137
    v_exp_f32 v138, v138
    v_exp_f32 v139, v139
    v_cvt_pk_bf16_f32 v154, v132, v133
    v_cvt_pk_bf16_f32 v155, v134, v135
    v_mfma_f32_32x32x16_bf16 v[96:111], v[220:223], v[148:151], v[96:111]
    ds_write_b128 v251, v[88:91] offset:6144
    v_exp_f32 v140, v140
    v_exp_f32 v141, v141
    v_exp_f32 v142, v142
    v_exp_f32 v143, v143
    v_cvt_pk_bf16_f32 v156, v136, v137
    v_cvt_pk_bf16_f32 v157, v138, v139
    v_cvt_pk_bf16_f32 v158, v140, v141
    v_cvt_pk_bf16_f32 v159, v142, v143
P2_TAIL:
    v_mfma_f32_32x32x16_bf16 v[48:63], v[216:219], v[152:155], v[48:63]
    s_nop 0
    v_mfma_f32_32x32x16_bf16 v[48:63], v[220:223], v[156:159], v[48:63]
    ds_write_b128 v252, v[96:99] offset:8192
    ds_write_b128 v252, v[100:103] offset:9216
    ds_write_b128 v252, v[104:107] offset:10240
    s_mov_b32 s63, 0x4e800000
    v_cmp_nlt_f32 s[66:67], v108, s63
    v_cmp_nlt_f32 s[68:69], v76, s63
    s_nop 0
    s_or_b32 s64, s67, s69
    v_cmp_nlt_f32 s[66:67], v92, s63
    s_nop 2
    v_cmp_nlt_f32 s[68:69], v60, s63
    s_or_b32 s64, s64, s67
    s_or_b32 s64, s64, s69
    s_cselect_b32 s64, 1.0, 0
    v_mov_b32 v4, s64
    v_cndmask_b32 v61, v61, v4, s[60:61]
    v_cndmask_b32 v77, v77, v4, s[60:61]
    v_cndmask_b32 v93, v93, v4, s[60:61]
    v_cndmask_b32 v109, v109, v4, s[60:61]
    ds_write_b128 v250, v[76:79] offset:3072
    ds_write_b128 v251, v[92:95] offset:7168
    ds_write_b128 v252, v[108:111] offset:11264
    s_lshl_b32 s69, s50, 2
    s_add_u32 s69, s69, s48
    s_lshl_b32 s65, s49, 6
    s_add_u32 s65, s65, s69
    s_lshl_b32 s65, s65, 11
    s_add_u32 s65, s65, 0
    s_waitcnt lgkmcnt(0)
    s_barrier
    ds_read_b128 v[76:79], v249 offset:3072
    ds_read_b128 v[92:95], v249 offset:7168
    ds_read_b128 v[108:111], v249 offset:11264
    ds_read_b128 v[64:67], v249 offset:0
    ds_read_b128 v[80:83], v249 offset:4096
    ds_read_b128 v[96:99], v249 offset:8192
    ds_read_b128 v[68:71], v249 offset:1024
    ds_read_b128 v[84:87], v249 offset:5120
    ds_read_b128 v[100:103], v249 offset:9216
    ds_read_b128 v[72:75], v249 offset:2048
    ds_read_b128 v[88:91], v249 offset:6144
    ds_read_b128 v[104:107], v249 offset:10240
    s_waitcnt lgkmcnt(9)
    v_pk_add_f32 v[60:61], v[60:61], v[76:77]
    v_pk_add_f32 v[92:93], v[92:93], v[108:109]
    v_pk_add_f32 v[62:63], v[62:63], v[78:79]
    v_pk_add_f32 v[94:95], v[94:95], v[110:111]
    v_pk_add_f32 v[60:61], v[60:61], v[92:93]
    v_pk_add_f32 v[62:63], v[62:63], v[94:95]
    v_readlane_b32 s63, v61, 32
    v_mov_b32 v4, v60
    v_mov_b32 v6, v60
    s_nop 1
    v_permlane32_swap_b32 v4, v6
    v_rcp_f32 v6, v6
    s_cmp_lg_u32 s63, s71
    s_cbranch_scc1 P2_FALL
P2_FIN:
    s_waitcnt lgkmcnt(6)
    v_pk_add_f32 v[48:49], v[48:49], v[64:65]
    v_pk_add_f32 v[80:81], v[80:81], v[96:97]
    v_pk_add_f32 v[50:51], v[50:51], v[66:67]
    v_pk_add_f32 v[82:83], v[82:83], v[98:99]
    v_pk_add_f32 v[48:49], v[48:49], v[80:81]
    v_pk_add_f32 v[50:51], v[50:51], v[82:83]
    s_waitcnt lgkmcnt(3)
    v_pk_add_f32 v[52:53], v[52:53], v[68:69]
    v_pk_add_f32 v[84:85], v[84:85], v[100:101]
    v_pk_add_f32 v[54:55], v[54:55], v[70:71]
    v_pk_add_f32 v[86:87], v[86:87], v[102:103]
    v_pk_add_f32 v[52:53], v[52:53], v[84:85]
    v_pk_add_f32 v[54:55], v[54:55], v[86:87]
    s_waitcnt lgkmcnt(0)
    v_pk_add_f32 v[56:57], v[56:57], v[72:73]
    v_pk_add_f32 v[88:89], v[88:89], v[104:105]
    v_pk_add_f32 v[58:59], v[58:59], v[74:75]
    v_pk_add_f32 v[90:91], v[90:91], v[106:107]
    v_pk_add_f32 v[56:57], v[56:57], v[88:89]
    v_pk_add_f32 v[58:59], v[58:59], v[90:91]
    v_pk_mul_f32 v[48:49], v[48:49], v[6:7] op_sel_hi:[1,0]
    v_pk_mul_f32 v[50:51], v[50:51], v[6:7] op_sel_hi:[1,0]
    v_pk_mul_f32 v[52:53], v[52:53], v[6:7] op_sel_hi:[1,0]
    v_pk_mul_f32 v[54:55], v[54:55], v[6:7] op_sel_hi:[1,0]
    v_pk_mul_f32 v[56:57], v[56:57], v[6:7] op_sel_hi:[1,0]
    v_pk_mul_f32 v[58:59], v[58:59], v[6:7] op_sel_hi:[1,0]
    v_pk_mul_f32 v[60:61], v[60:61], v[6:7] op_sel_hi:[1,0]
    v_pk_mul_f32 v[62:63], v[62:63], v[6:7] op_sel_hi:[1,0]
    v_cvt_pk_bf16_f32 v64, v48, v49
    v_cvt_pk_bf16_f32 v65, v50, v51
    v_cvt_pk_bf16_f32 v66, v52, v53
    v_cvt_pk_bf16_f32 v67, v54, v55
    v_cvt_pk_bf16_f32 v68, v56, v57
    v_cvt_pk_bf16_f32 v69, v58, v59
    v_cvt_pk_bf16_f32 v70, v60, v61
    v_cvt_pk_bf16_f32 v71, v62, v63
    v_cndmask_b32 v70, v70, 0, s[60:61]
    v_cndmask_b32 v71, v71, 0, s[60:61]
    s_mov_b32 s63, 0xfffeffff
    v_and_or_b32 v67, v67, s63, 1
    v_and_or_b32 v71, v71, s63, 1
    buffer_store_dwordx4 v[64:67], v2, s[44:47], s65 offen offset:0 sc1
    buffer_store_dwordx4 v[68:71], v2, s[44:47], s65 offen offset:1024 sc1
    s_barrier
    v_mfma_f32_32x32x16_bf16 v[96:111], v[224:227], v[232:235], 0
    v_mfma_f32_32x32x16_bf16 v[112:127], v[232:235], v[224:227], 0
    v_mfma_f32_32x32x16_bf16 v[96:111], v[228:231], v[236:239], v[96:111]
    v_mfma_f32_32x32x16_bf16 v[112:127], v[236:239], v[228:231], v[112:127]
    s_xor_b32 s64, s48, 1
    s_mul_i32 s64, s64, 12288
    s_add_u32 s64, s64, 114688
    v_add_u32 v250, s64, v2
    s_xor_b32 s64, s48, 2
    s_mul_i32 s64, s64, 12288
    s_add_u32 s64, s64, 114688
    v_add_u32 v251, s64, v2
    s_xor_b32 s64, s48, 3
    s_mul_i32 s64, s64, 12288
    s_add_u32 s64, s64, 114688
    v_add_u32 v252, s64, v2
    s_barrier
    s_cmp_lt_u32 s0, 14
    s_cbranch_scc0 P3_END
    s_mov_b32 s6, 0x0000ffff
    s_lshr_b32 s63, s1, 2
    s_lshl_b32 s63, s63, 8
    s_add_u32 s63, s63, 15466496
    v_min_u32 v6, 13, v1
    v_lshlrev_b32 v6, 4, v6
    buffer_load_dwordx4 v[192:195], v6, s[44:47], s63 offen sc1
    s_add_u32 s63, s101, 0
    s_and_b32 s63, s63, 0x1fffff
    buffer_load_dwordx4 v[16:19], v10, s[44:47], s63 offen offset:0 sc1
    buffer_load_dwordx4 v[20:23], v10, s[44:47], s63 offen offset:1024 sc1
    buffer_load_dwordx4 v[24:27], v11, s[44:47], s63 offen offset:0 sc1
    buffer_load_dwordx4 v[28:31], v11, s[44:47], s63 offen offset:1024 sc1
    s_add_u32 s63, s101, 262144
    s_and_b32 s63, s63, 0x1fffff
    buffer_load_dwordx4 v[32:35], v10, s[44:47], s63 offen offset:0 sc1
    buffer_load_dwordx4 v[36:39], v10, s[44:47], s63 offen offset:1024 sc1
    buffer_load_dwordx4 v[40:43], v11, s[44:47], s63 offen offset:0 sc1
    buffer_load_dwordx4 v[44:47], v11, s[44:47], s63 offen offset:1024 sc1
    s_add_u32 s63, s101, 524288
    s_and_b32 s63, s63, 0x1fffff
    buffer_load_dwordx4 v[48:51], v10, s[44:47], s63 offen offset:0 sc1
    buffer_load_dwordx4 v[52:55], v10, s[44:47], s63 offen offset:1024 sc1
    buffer_load_dwordx4 v[56:59], v11, s[44:47], s63 offen offset:0 sc1
    buffer_load_dwordx4 v[60:63], v11, s[44:47], s63 offen offset:1024 sc1
    s_add_u32 s63, s101, 786432
    s_and_b32 s63, s63, 0x1fffff
    buffer_load_dwordx4 v[64:67], v10, s[44:47], s63 offen offset:0 sc1
    buffer_load_dwordx4 v[68:71], v10, s[44:47], s63 offen offset:1024 sc1
    buffer_load_dwordx4 v[72:75], v11, s[44:47], s63 offen offset:0 sc1
    buffer_load_dwordx4 v[76:79], v11, s[44:47], s63 offen offset:1024 sc1
    ds_read_b64_tr_b16 v[176:177], v248 offset:0
    ds_read_b64_tr_b16 v[178:179], v248 offset:512
    ds_read_b64_tr_b16 v[180:181], v248 offset:1024
    ds_read_b64_tr_b16 v[182:183], v248 offset:1536
    v_and_b32 v6, 31, v1
    v_lshlrev_b32 v6, 4, v6
    v_lshrrev_b32 v7, 5, v1
    v_mul_u32_u24 v7, 3584, v7
    v_add_u32 v6, v6, v7
    s_waitcnt vmcnt(12)
    v_bitop3_b32 v8, v19, v23, v27 bitop3:0x80
    v_bitop3_b32 v8, v8, v31, 1 bitop3:0x80
    v_cmp_eq_u32 vcc, 0, v8
    s_cbranch_vccnz SO0_h
SO0_r:
    s_getreg_b32 s65, hwreg(HW_REG_XCC_ID, 0, 4)
    v_xor_b32 v192, s65, v192
    v_xor_b32 v193, s58, v193
    v_xor_b32 v194, s65, v194
    v_xor_b32 v195, s59, v195
    v_or3_b32 v192, v192, v193, v194
    v_or_b32 v192, v192, v195
    v_cmp_ne_u32 vcc, 0, v192
    s_nop 0
    s_or_b32 s70, vcc_lo, vcc_hi
    s_waitcnt lgkmcnt(2)
    v_mfma_f32_32x32x16_bf16 v[112:127], v[176:179], v[16:19], v[112:127]
    ds_read_b64_tr_b16 v[184:185], v248 offset:2048
    ds_read_b64_tr_b16 v[186:187], v248 offset:2560
    v_mfma_f32_32x32x16_bf16 v[96:111], v[16:19], v[176:179], v[96:111]
    s_add_u32 s63, s101, 1048576
    s_and_b32 s63, s63, 0x1fffff
    buffer_load_dwordx4 v[80:83], v10, s[44:47], s63 offen offset:0 sc1
    buffer_load_dwordx4 v[84:87], v10, s[44:47], s63 offen offset:1024 sc1
    s_waitcnt lgkmcnt(2)
    v_mfma_f32_32x32x16_bf16 v[112:127], v[180:183], v[20:23], v[112:127]
    ds_read_b64_tr_b16 v[188:189], v248 offset:3072
    ds_read_b64_tr_b16 v[190:191], v248 offset:3584
    v_mfma_f32_32x32x16_bf16 v[96:111], v[20:23], v[180:183], v[96:111]
    buffer_load_dwordx4 v[88:91], v11, s[44:47], s63 offen offset:0 sc1
    buffer_load_dwordx4 v[92:95], v11, s[44:47], s63 offen offset:1024 sc1
    s_waitcnt lgkmcnt(2)
    v_mfma_f32_32x32x16_bf16 v[112:127], v[184:187], v[24:27], v[112:127]
    ds_read_b64_tr_b16 v[176:177], v248 offset:4096
    ds_read_b64_tr_b16 v[178:179], v248 offset:4608
    v_mfma_f32_32x32x16_bf16 v[96:111], v[24:27], v[184:187], v[96:111]
    s_waitcnt vmcnt(12)
    v_bitop3_b32 v8, v35, v39, v43 bitop3:0x80
    v_bitop3_b32 v8, v8, v47, 1 bitop3:0x80
    s_waitcnt lgkmcnt(2)
    v_mfma_f32_32x32x16_bf16 v[112:127], v[188:191], v[28:31], v[112:127]
    ds_read_b64_tr_b16 v[180:181], v248 offset:5120
    ds_read_b64_tr_b16 v[182:183], v248 offset:5632
    v_mfma_f32_32x32x16_bf16 v[96:111], v[28:31], v[188:191], v[96:111]
    v_cmp_eq_u32 vcc, 0, v8
    s_cbranch_vccnz SO1_h
SO1_r:
    s_waitcnt lgkmcnt(2)
    v_mfma_f32_32x32x16_bf16 v[112:127], v[176:179], v[32:35], v[112:127]
    ds_read_b64_tr_b16 v[184:185], v248 offset:6144
    ds_read_b64_tr_b16 v[186:187], v248 offset:6656
    v_mfma_f32_32x32x16_bf16 v[96:111], v[32:35], v[176:179], v[96:111]
    s_add_u32 s63, s101, 1310720
    s_and_b32 s63, s63, 0x1fffff
    buffer_load_dwordx4 v[128:131], v10, s[44:47], s63 offen offset:0 sc1
    buffer_load_dwordx4 v[132:135], v10, s[44:47], s63 offen offset:1024 sc1
    s_waitcnt lgkmcnt(2)
    v_mfma_f32_32x32x16_bf16 v[112:127], v[180:183], v[36:39], v[112:127]
    ds_read_b64_tr_b16 v[188:189], v248 offset:7168
    ds_read_b64_tr_b16 v[190:191], v248 offset:7680
    v_mfma_f32_32x32x16_bf16 v[96:111], v[36:39], v[180:183], v[96:111]
    buffer_load_dwordx4 v[136:139], v11, s[44:47], s63 offen offset:0 sc1
    buffer_load_dwordx4 v[140:143], v11, s[44:47], s63 offen offset:1024 sc1
    s_waitcnt lgkmcnt(2)
    v_mfma_f32_32x32x16_bf16 v[112:127], v[184:187], v[40:43], v[112:127]
    ds_read_b64_tr_b16 v[176:177], v248 offset:12288
    ds_read_b64_tr_b16 v[178:179], v248 offset:12800
    v_mfma_f32_32x32x16_bf16 v[96:111], v[40:43], v[184:187], v[96:111]
    s_waitcnt vmcnt(12)
    v_bitop3_b32 v8, v51, v55, v59 bitop3:0x80
    v_bitop3_b32 v8, v8, v63, 1 bitop3:0x80
    s_waitcnt lgkmcnt(2)
    v_mfma_f32_32x32x16_bf16 v[112:127], v[188:191], v[44:47], v[112:127]
    ds_read_b64_tr_b16 v[180:181], v248 offset:13312
    ds_read_b64_tr_b16 v[182:183], v248 offset:13824
    v_mfma_f32_32x32x16_bf16 v[96:111], v[44:47], v[188:191], v[96:111]
    v_cmp_eq_u32 vcc, 0, v8
    s_cbranch_vccnz SO2_h
SO2_r:
    s_waitcnt lgkmcnt(2)
    v_mfma_f32_32x32x16_bf16 v[112:127], v[176:179], v[48:51], v[112:127]
    ds_read_b64_tr_b16 v[184:185], v248 offset:14336
    ds_read_b64_tr_b16 v[186:187], v248 offset:14848
    v_mfma_f32_32x32x16_bf16 v[96:111], v[48:51], v[176:179], v[96:111]
    s_add_u32 s63, s101, 1572864
    s_and_b32 s63, s63, 0x1fffff
    buffer_load_dwordx4 v[144:147], v10, s[44:47], s63 offen offset:0 sc1
    buffer_load_dwordx4 v[148:151], v10, s[44:47], s63 offen offset:1024 sc1
    s_waitcnt lgkmcnt(2)
    v_mfma_f32_32x32x16_bf16 v[112:127], v[180:183], v[52:55], v[112:127]
    ds_read_b64_tr_b16 v[188:189], v248 offset:15360
    ds_read_b64_tr_b16 v[190:191], v248 offset:15872
    v_mfma_f32_32x32x16_bf16 v[96:111], v[52:55], v[180:183], v[96:111]
    buffer_load_dwordx4 v[152:155], v11, s[44:47], s63 offen offset:0 sc1
    buffer_load_dwordx4 v[156:159], v11, s[44:47], s63 offen offset:1024 sc1
    s_waitcnt lgkmcnt(2)
    v_mfma_f32_32x32x16_bf16 v[112:127], v[184:187], v[56:59], v[112:127]
    ds_read_b64_tr_b16 v[176:177], v248 offset:16384
    ds_read_b64_tr_b16 v[178:179], v248 offset:16896
    v_mfma_f32_32x32x16_bf16 v[96:111], v[56:59], v[184:187], v[96:111]
    s_waitcnt vmcnt(12)
    v_bitop3_b32 v8, v67, v71, v75 bitop3:0x80
    v_bitop3_b32 v8, v8, v79, 1 bitop3:0x80
    s_waitcnt lgkmcnt(2)
    v_mfma_f32_32x32x16_bf16 v[112:127], v[188:191], v[60:63], v[112:127]
    ds_read_b64_tr_b16 v[180:181], v248 offset:17408
    ds_read_b64_tr_b16 v[182:183], v248 offset:17920
    v_mfma_f32_32x32x16_bf16 v[96:111], v[60:63], v[188:191], v[96:111]
    v_cmp_eq_u32 vcc, 0, v8
    s_cbranch_vccnz SO3_h
SO3_r:
    s_waitcnt lgkmcnt(2)
    v_mfma_f32_32x32x16_bf16 v[112:127], v[176:179], v[64:67], v[112:127]
    ds_read_b64_tr_b16 v[184:185], v248 offset:18432
    ds_read_b64_tr_b16 v[186:187], v248 offset:18944
    v_mfma_f32_32x32x16_bf16 v[96:111], v[64:67], v[176:179], v[96:111]
    s_add_u32 s63, s101, 1835008
    s_and_b32 s63, s63, 0x1fffff
    buffer_load_dwordx4 v[160:163], v10, s[44:47], s63 offen offset:0 sc1
    buffer_load_dwordx4 v[164:167], v10, s[44:47], s63 offen offset:1024 sc1
    s_waitcnt lgkmcnt(2)
    v_mfma_f32_32x32x16_bf16 v[112:127], v[180:183], v[68:71], v[112:127]
    ds_read_b64_tr_b16 v[188:189], v248 offset:19456
    ds_read_b64_tr_b16 v[190:191], v248 offset:19968
    v_mfma_f32_32x32x16_bf16 v[96:111], v[68:71], v[180:183], v[96:111]
    buffer_load_dwordx4 v[168:171], v11, s[44:47], s63 offen offset:0 sc1
    buffer_load_dwordx4 v[172:175], v11, s[44:47], s63 offen offset:1024 sc1
    s_waitcnt lgkmcnt(2)
    v_mfma_f32_32x32x16_bf16 v[112:127], v[184:187], v[72:75], v[112:127]
    ds_read_b64_tr_b16 v[176:177], v248 offset:24576
    ds_read_b64_tr_b16 v[178:179], v248 offset:25088
    ds_read_b64_tr_b16 v[192:193], v248 offset:36864
    ds_read_b64_tr_b16 v[194:195], v248 offset:37376
    v_mfma_f32_32x32x16_bf16 v[96:111], v[72:75], v[184:187], v[96:111]
    s_waitcnt vmcnt(12)
    v_bitop3_b32 v8, v83, v87, v91 bitop3:0x80
    v_bitop3_b32 v8, v8, v95, 1 bitop3:0x80
    s_waitcnt lgkmcnt(4)
    v_mfma_f32_32x32x16_bf16 v[112:127], v[188:191], v[76:79], v[112:127]
    ds_read_b64_tr_b16 v[180:181], v248 offset:25600
    ds_read_b64_tr_b16 v[182:183], v248 offset:26112
    ds_read_b64_tr_b16 v[196:197], v248 offset:37888
    ds_read_b64_tr_b16 v[198:199], v248 offset:38400
    v_mfma_f32_32x32x16_bf16 v[96:111], v[76:79], v[188:191], v[96:111]
    v_cmp_eq_u32 vcc, 0, v8
    s_cbranch_vccnz SO4_h
SO4_r:
    s_waitcnt lgkmcnt(6)
    v_mfma_f32_32x32x16_bf16 v[112:127], v[176:179], v[80:83], v[112:127]
    ds_read_b64_tr_b16 v[184:185], v248 offset:26624
    ds_read_b64_tr_b16 v[186:187], v248 offset:27136
    ds_read_b64_tr_b16 v[200:201], v248 offset:38912
    ds_read_b64_tr_b16 v[202:203], v248 offset:39424
    v_mfma_f32_32x32x16_bf16 v[96:111], v[80:83], v[176:179], v[96:111]
    s_waitcnt lgkmcnt(6)
    v_mfma_f32_32x32x16_bf16 v[112:127], v[180:183], v[84:87], v[112:127]
    ds_read_b64_tr_b16 v[188:189], v248 offset:27648
    ds_read_b64_tr_b16 v[190:191], v248 offset:28160
    ds_read_b64_tr_b16 v[204:205], v248 offset:39936
    ds_read_b64_tr_b16 v[206:207], v248 offset:40448
    v_mfma_f32_32x32x16_bf16 v[96:111], v[84:87], v[180:183], v[96:111]
    s_waitcnt lgkmcnt(6)
    v_mfma_f32_32x32x16_bf16 v[112:127], v[184:187], v[88:91], v[112:127]
    ds_read_b64_tr_b16 v[176:177], v248 offset:28672
    ds_read_b64_tr_b16 v[178:179], v248 offset:29184
    ds_read_b64_tr_b16 v[208:209], v248 offset:40960
    ds_read_b64_tr_b16 v[210:211], v248 offset:41472
    v_mfma_f32_32x32x16_bf16 v[96:111], v[88:91], v[184:187], v[96:111]
    s_waitcnt vmcnt(8)
    v_bitop3_b32 v8, v131, v135, v139 bitop3:0x80
    v_bitop3_b32 v8, v8, v143, 1 bitop3:0x80
    s_waitcnt lgkmcnt(6)
    v_mfma_f32_32x32x16_bf16 v[112:127], v[188:191], v[92:95], v[112:127]
    ds_read_b64_tr_b16 v[180:181], v248 offset:29696
    ds_read_b64_tr_b16 v[182:183], v248 offset:30208
    ds_read_b64_tr_b16 v[212:213], v248 offset:41984
    ds_read_b64_tr_b16 v[214:215], v248 offset:42496
    v_mfma_f32_32x32x16_bf16 v[96:111], v[92:95], v[188:191], v[96:111]
    v_cmp_eq_u32 vcc, 0, v8
    s_cbranch_vccnz SO5_h
SO5_r:
    s_waitcnt lgkmcnt(6)
    v_mfma_f32_32x32x16_bf16 v[112:127], v[176:179], v[128:131], v[112:127]
    ds_read_b64_tr_b16 v[184:185], v248 offset:30720
    ds_read_b64_tr_b16 v[186:187], v248 offset:31232
    ds_read_b64_tr_b16 v[216:217], v248 offset:43008
    ds_read_b64_tr_b16 v[218:219], v248 offset:43520
    v_mfma_f32_32x32x16_bf16 v[96:111], v[128:131], v[176:179], v[96:111]
    s_waitcnt lgkmcnt(6)
    v_mfma_f32_32x32x16_bf16 v[112:127], v[180:183], v[132:135], v[112:127]
    ds_read_b64_tr_b16 v[188:189], v248 offset:31744
    ds_read_b64_tr_b16 v[190:191], v248 offset:32256
    ds_read_b64_tr_b16 v[220:221], v248 offset:44032
    ds_read_b64_tr_b16 v[222:223], v248 offset:44544
    v_mfma_f32_32x32x16_bf16 v[96:111], v[132:135], v[180:183], v[96:111]
    s_waitcnt lgkmcnt(6)
    v_mfma_f32_32x32x16_bf16 v[112:127], v[184:187], v[136:139], v[112:127]
    v_mfma_f32_32x32x16_bf16 v[96:111], v[136:139], v[184:187], v[96:111]
    s_waitcnt vmcnt(4)
    v_bitop3_b32 v8, v147, v151, v155 bitop3:0x80
    v_bitop3_b32 v8, v8, v159, 1 bitop3:0x80
    s_waitcnt lgkmcnt(2)
    v_mfma_f32_32x32x16_bf16 v[112:127], v[188:191], v[140:143], v[112:127]
    v_mfma_f32_32x32x16_bf16 v[96:111], v[140:143], v[188:191], v[96:111]
    v_cmp_eq_u32 vcc, 0, v8
    s_cbranch_vccnz SO6_h
SO6_r:
    v_mfma_f32_32x32x16_bf16 v[112:127], v[192:195], v[144:147], v[112:127]
    v_mfma_f32_32x32x16_bf16 v[112:127], v[196:199], v[148:151], v[112:127]
    v_mfma_f32_32x32x16_bf16 v[112:127], v[200:203], v[152:155], v[112:127]
    s_waitcnt vmcnt(0)
    v_bitop3_b32 v8, v163, v167, v171 bitop3:0x80
    v_bitop3_b32 v8, v8, v175, 1 bitop3:0x80
    v_mfma_f32_32x32x16_bf16 v[112:127], v[204:207], v[156:159], v[112:127]
    v_cmp_eq_u32 vcc, 0, v8
    s_cbranch_vccnz SO7_h
SO7_r:
    v_mfma_f32_32x32x16_bf16 v[112:127], v[208:211], v[160:163], v[112:127]
    v_mfma_f32_32x32x16_bf16 v[112:127], v[212:215], v[164:167], v[112:127]
    v_mfma_f32_32x32x16_bf16 v[112:127], v[216:219], v[168:171], v[112:127]
    s_waitcnt lgkmcnt(0)
    v_mfma_f32_32x32x16_bf16 v[112:127], v[220:223], v[172:175], v[112:127]
    s_lshl_b32 s67, s1, 13
    s_add_u32 s67, s67, 14680064
    s_lshl_b32 s63, s0, 9
    s_add_u32 s63, s63, s67
    v_mov_b32 v17, s58
    v_mov_b32 v19, s59
    s_nop 5
    v_pk_add_f32 v[20:21], v[112:113], v[114:115]
    v_pk_mul_f32 v[22:23], v[112:113], v[112:113]
    v_pk_fma_f32 v[22:23], v[114:115], v[114:115], v[22:23]
    v_pk_add_f32 v[20:21], v[20:21], v[116:117]
    v_pk_fma_f32 v[22:23], v[116:117], v[116:117], v[22:23]
    v_pk_add_f32 v[20:21], v[20:21], v[118:119]
    v_pk_fma_f32 v[22:23], v[118:119], v[118:119], v[22:23]
    v_pk_add_f32 v[20:21], v[20:21], v[120:121]
    v_pk_fma_f32 v[22:23], v[120:121], v[120:121], v[22:23]
    v_pk_add_f32 v[20:21], v[20:21], v[122:123]
    v_pk_fma_f32 v[22:23], v[122:123], v[122:123], v[22:23]
    v_pk_add_f32 v[20:21], v[20:21], v[124:125]
    v_pk_fma_f32 v[22:23], v[124:125], v[124:125], v[22:23]
    v_pk_add_f32 v[20:21], v[20:21], v[126:127]
    v_pk_fma_f32 v[22:23], v[126:127], v[126:127], v[22:23]
    v_add_f32 v16, v20, v21
    v_add_f32 v18, v22, v23
    v_mov_b32 v20, v16
    v_mov_b32 v22, v18
    s_nop 0
    v_permlane32_swap_b32 v16, v20
    v_permlane32_swap_b32 v18, v22
    v_add_f32 v16, v16, v20
    v_add_f32 v18, v18, v22
    s_mov_b32 exec_lo, 0xffffffff
    s_mov_b32 exec_hi, 0x00000000
    s_cmp_lg_u32 s70, 0
    s_cbranch_scc1 P3_FAR
    buffer_store_dwordx4 v[16:19], v2, s[44:47], s63 offen
P3_FARX:
    s_mov_b64 exec, -1
    v_cvt_pk_bf16_f32 v24, v112, v113
    v_cvt_pk_bf16_f32 v25, v114, v115
    v_cvt_pk_bf16_f32 v26, v116, v117
    v_cvt_pk_bf16_f32 v27, v118, v119
    v_cvt_pk_bf16_f32 v28, v120, v121
    v_cvt_pk_bf16_f32 v29, v122, v123
    v_cvt_pk_bf16_f32 v30, v124, v125
    v_cvt_pk_bf16_f32 v31, v126, v127
    s_mul_i32 s63, s1, 14
    s_add_u32 s63, s63, s0
    s_lshl_b32 s63, s63, 11
    s_add_u32 s63, s63, 8388608
    v_mfma_f32_32x32x16_bf16 v[96:111], v[144:147], v[192:195], v[96:111]
    v_mfma_f32_32x32x16_bf16 v[96:111], v[148:151], v[196:199], v[96:111]
    v_mfma_f32_32x32x16_bf16 v[96:111], v[152:155], v[200:203], v[96:111]
    v_mfma_f32_32x32x16_bf16 v[96:111], v[156:159], v[204:207], v[96:111]
    v_mfma_f32_32x32x16_bf16 v[96:111], v[160:163], v[208:211], v[96:111]
    v_mfma_f32_32x32x16_bf16 v[96:111], v[164:167], v[212:215], v[96:111]
    v_mfma_f32_32x32x16_bf16 v[96:111], v[168:171], v[216:219], v[96:111]
    v_mfma_f32_32x32x16_bf16 v[96:111], v[172:175], v[220:223], v[96:111]
    buffer_load_dwordx4 v[32:35], v6, s[44:47], s67 offen offset:0 sc1
    buffer_load_dwordx4 v[36:39], v6, s[44:47], s67 offen offset:512 sc1
    buffer_load_dwordx4 v[40:43], v6, s[44:47], s67 offen offset:1024 sc1
    buffer_load_dwordx4 v[44:47], v6, s[44:47], s67 offen offset:1536 sc1
    buffer_load_dwordx4 v[48:51], v6, s[44:47], s67 offen offset:2048 sc1
    buffer_load_dwordx4 v[52:55], v6, s[44:47], s67 offen offset:2560 sc1
    buffer_load_dwordx4 v[56:59], v6, s[44:47], s67 offen offset:3072 sc1
    buffer_store_dwordx4 v[24:27], v2, s[44:47], s63 offen offset:0 sc1
    buffer_store_dwordx4 v[28:31], v2, s[44:47], s63 offen offset:1024 sc1
    s_waitcnt vmcnt(2)
    v_xor_b32 v9, s58, v33
    v_xor_b32 v4, s59, v35
    v_or_b32 v9, v9, v4
    v_xor_b32 v4, s58, v37
    v_xor_b32 v5, s59, v39
    v_or3_b32 v9, v9, v4, v5
    v_xor_b32 v4, s58, v41
    v_xor_b32 v5, s59, v43
    v_or3_b32 v9, v9, v4, v5
    v_xor_b32 v4, s58, v45
    v_xor_b32 v5, s59, v47
    v_or3_b32 v9, v9, v4, v5
    v_xor_b32 v4, s58, v49
    v_xor_b32 v5, s59, v51
    v_or3_b32 v9, v9, v4, v5
    v_xor_b32 v4, s58, v53
    v_xor_b32 v5, s59, v55
    v_or3_b32 v9, v9, v4, v5
    v_xor_b32 v4, s58, v57
    v_xor_b32 v5, s59, v59
    v_or3_b32 v9, v9, v4, v5
    v_cmp_ne_u32 vcc, 0, v9
    s_cbranch_vccnz P3_GH
P3_GX:
    v_add_f32 v32, v32, v36
    v_add_f32 v34, v34, v38
    v_add_f32 v32, v32, v40
    v_add_f32 v34, v34, v42
    v_add_f32 v32, v32, v44
    v_add_f32 v34, v34, v46
    v_add_f32 v32, v32, v48
    v_add_f32 v34, v34, v50
    v_add_f32 v32, v32, v52
    v_add_f32 v34, v34, v54
    v_add_f32 v32, v32, v56
    v_add_f32 v34, v34, v58
    v_mov_b32 v8, v32
    v_mov_b32 v9, v34
    s_nop 0
    v_permlane32_swap_b32 v32, v8
    v_permlane32_swap_b32 v34, v9
    v_add_f32 v32, v32, v8
    v_add_f32 v34, v34, v9
    v_mul_f32 v32, 0x3b124925, v32
    v_mul_f32 v34, 0x3b124925, v34
    v_fma_f32 v34, -v32, v32, v34
    v_max_f32 v34, 0, v34
    v_add_f32 v8, 0x3727c5ac, v34
    v_mul_f32 v8, 0x3727c5ac, v8
    v_add_f32 v34, v34, v8
    v_rsq_f32 v34, v34
    s_add_u32 s63, s94, 8192
    v_mul_f32 v32, v32, v34
    v_cndmask_b32 v8, v34, v32, s[60:61]
    v_lshl_add_u32 v9, v1, 2, s63
    ds_write_b32 v9, v8
    v_lshrrev_b32 v4, 5, v1
    v_lshl_add_u32 v4, v4, 4, s63
    ds_read_b128 v[64:67], v4 offset:0
    ds_read_b128 v[80:83], v4 offset:128
    ds_read_b128 v[68:71], v4 offset:32
    ds_read_b128 v[84:87], v4 offset:160
    ds_read_b128 v[72:75], v4 offset:64
    ds_read_b128 v[88:91], v4 offset:192
    ds_read_b128 v[76:79], v4 offset:96
    ds_read_b128 v[92:95], v4 offset:224
    s_lshl_b32 s63, s0, 17
    s_lshl_b32 s64, s1, 11
    s_add_u32 s63, s63, s64
    s_add_u32 s63, s63, 0
    s_waitcnt lgkmcnt(4)
    v_pk_fma_f32 v[96:97], v[96:97], v[64:65], v[80:81] neg_lo:[0,0,1] neg_hi:[0,0,1]
    v_pk_fma_f32 v[98:99], v[98:99], v[66:67], v[82:83] neg_lo:[0,0,1] neg_hi:[0,0,1]
    v_pk_fma_f32 v[100:101], v[100:101], v[68:69], v[84:85] neg_lo:[0,0,1] neg_hi:[0,0,1]
    v_pk_fma_f32 v[102:103], v[102:103], v[70:71], v[86:87] neg_lo:[0,0,1] neg_hi:[0,0,1]
    v_cvt_pk_bf16_f32 v16, v96, v97
    v_cvt_pk_bf16_f32 v17, v98, v99
    v_cvt_pk_bf16_f32 v18, v100, v101
    v_cvt_pk_bf16_f32 v19, v102, v103
    v_or_b32 v19, 0x10000, v19
    s_waitcnt vmcnt(0)
    buffer_store_dwordx4 v[16:19], v2, s[44:47], s63 offen offset:0 sc1
    s_waitcnt lgkmcnt(0)
    v_pk_fma_f32 v[104:105], v[104:105], v[72:73], v[88:89] neg_lo:[0,0,1] neg_hi:[0,0,1]
    v_pk_fma_f32 v[106:107], v[106:107], v[74:75], v[90:91] neg_lo:[0,0,1] neg_hi:[0,0,1]
    v_pk_fma_f32 v[108:109], v[108:109], v[76:77], v[92:93] neg_lo:[0,0,1] neg_hi:[0,0,1]
    v_pk_fma_f32 v[110:111], v[110:111], v[78:79], v[94:95] neg_lo:[0,0,1] neg_hi:[0,0,1]
    v_cvt_pk_bf16_f32 v20, v104, v105
    v_cvt_pk_bf16_f32 v21, v106, v107
    v_cvt_pk_bf16_f32 v22, v108, v109
    v_cvt_pk_bf16_f32 v23, v110, v111
    v_or_b32 v23, 0x10000, v23
    buffer_store_dwordx4 v[20:23], v2, s[44:47], s63 offen offset:1024 sc1
P3_END:
    ds_read_b64_tr_b16 v[128:129], v240 offset:0
    ds_read_b64_tr_b16 v[130:131], v240 offset:1024
    ds_read_b64_tr_b16 v[132:133], v241 offset:0
    ds_read_b64_tr_b16 v[134:135], v241 offset:1024
    ds_read_b64_tr_b16 v[136:137], v240 offset:2048
    ds_read_b64_tr_b16 v[138:139], v240 offset:3072
    ds_read_b64_tr_b16 v[140:141], v241 offset:2048
    ds_read_b64_tr_b16 v[142:143], v241 offset:3072
    ds_read_b64_tr_b16 v[144:145], v240 offset:4096
    ds_read_b64_tr_b16 v[146:147], v240 offset:5120
    ds_read_b64_tr_b16 v[148:149], v241 offset:4096
    ds_read_b64_tr_b16 v[150:151], v241 offset:5120
    ds_read_b64_tr_b16 v[152:153], v240 offset:6144
    ds_read_b64_tr_b16 v[154:155], v240 offset:7168
    ds_read_b64_tr_b16 v[156:157], v241 offset:6144
    ds_read_b64_tr_b16 v[158:159], v241 offset:7168
    ds_read_b64_tr_b16 v[160:161], v240 offset:8192
    ds_read_b64_tr_b16 v[162:163], v240 offset:9216
    ds_read_b64_tr_b16 v[164:165], v241 offset:8192
    ds_read_b64_tr_b16 v[166:167], v241 offset:9216
    ds_read_b64_tr_b16 v[168:169], v240 offset:10240
    ds_read_b64_tr_b16 v[170:171], v240 offset:11264
    ds_read_b64_tr_b16 v[172:173], v241 offset:10240
    ds_read_b64_tr_b16 v[174:175], v241 offset:11264
    ds_read_b64_tr_b16 v[176:177], v240 offset:12288
    ds_read_b64_tr_b16 v[178:179], v240 offset:13312
    ds_read_b64_tr_b16 v[180:181], v241 offset:12288
    ds_read_b64_tr_b16 v[182:183], v241 offset:13312
    ds_read_b64_tr_b16 v[184:185], v240 offset:14336
    ds_read_b64_tr_b16 v[186:187], v240 offset:15360
    ds_read_b64_tr_b16 v[188:189], v241 offset:14336
    ds_read_b64_tr_b16 v[190:191], v241 offset:15360
    ds_read_b64_tr_b16 v[192:193], v240 offset:16384
    ds_read_b64_tr_b16 v[194:195], v240 offset:17408
    ds_read_b64_tr_b16 v[196:197], v241 offset:16384
    ds_read_b64_tr_b16 v[198:199], v241 offset:17408
    ds_read_b64_tr_b16 v[200:201], v240 offset:18432
    ds_read_b64_tr_b16 v[202:203], v240 offset:19456
    ds_read_b64_tr_b16 v[204:205], v241 offset:18432
    ds_read_b64_tr_b16 v[206:207], v241 offset:19456
    ds_read_b64_tr_b16 v[208:209], v240 offset:20480
    ds_read_b64_tr_b16 v[210:211], v240 offset:21504
    ds_read_b64_tr_b16 v[212:213], v241 offset:20480
    ds_read_b64_tr_b16 v[214:215], v241 offset:21504
    ds_read_b64_tr_b16 v[216:217], v240 offset:22528
    ds_read_b64_tr_b16 v[218:219], v240 offset:23552
    ds_read_b64_tr_b16 v[220:221], v241 offset:22528
    ds_read_b64_tr_b16 v[222:223], v241 offset:23552
    s_and_b32 s63, s48, 1
    s_lshl_b32 s63, s63, 5
    v_xor_b32 v240, s63, v240
    v_xor_b32 v241, s63, v241
    s_waitcnt lgkmcnt(0)
    s_barrier
    s_barrier
    s_cmp_lg_u32 s56, 0
    s_cbranch_scc1 P4_GOA
    s_cmp_ge_u32 s51, 28
    s_cbranch_scc1 MLP_ENDA
    s_waitcnt lgkmcnt(0)
    s_barrier
    ds_read_b64_tr_b16 v[128:129], v240 offset:0
    ds_read_b64_tr_b16 v[130:131], v240 offset:1024
    ds_read_b64_tr_b16 v[132:133], v241 offset:0
    ds_read_b64_tr_b16 v[134:135], v241 offset:1024
    ds_read_b64_tr_b16 v[136:137], v240 offset:2048
    ds_read_b64_tr_b16 v[138:139], v240 offset:3072
    ds_read_b64_tr_b16 v[140:141], v241 offset:2048
    ds_read_b64_tr_b16 v[142:143], v241 offset:3072
    ds_read_b64_tr_b16 v[144:145], v240 offset:4096
    ds_read_b64_tr_b16 v[146:147], v240 offset:5120
    ds_read_b64_tr_b16 v[148:149], v241 offset:4096
    ds_read_b64_tr_b16 v[150:151], v241 offset:5120
    ds_read_b64_tr_b16 v[152:153], v240 offset:6144
    ds_read_b64_tr_b16 v[154:155], v240 offset:7168
    ds_read_b64_tr_b16 v[156:157], v241 offset:6144
    ds_read_b64_tr_b16 v[158:159], v241 offset:7168
    ds_read_b64_tr_b16 v[160:161], v240 offset:8192
    ds_read_b64_tr_b16 v[162:163], v240 offset:9216
    ds_read_b64_tr_b16 v[164:165], v241 offset:8192
    ds_read_b64_tr_b16 v[166:167], v241 offset:9216
    ds_read_b64_tr_b16 v[168:169], v240 offset:10240
    ds_read_b64_tr_b16 v[170:171], v240 offset:11264
    ds_read_b64_tr_b16 v[172:173], v241 offset:10240
    ds_read_b64_tr_b16 v[174:175], v241 offset:11264
    s_waitcnt lgkmcnt(0)
    s_add_u32 s66, s97, 6144
    s_sub_u32 s67, s66, 28672
    s_min_u32 s66, s66, s67
    s_lshl_b32 s66, s66, 6
    s_add_u32 m0, s95, 0
    s_nop 0
    buffer_load_dwordx4 v246, s[28:31], s66 offen offset:0 lds
    buffer_load_dwordx4 v247, s[28:31], s66 offen offset:1024 lds
    s_add_u32 s66, s97, 7168
    s_sub_u32 s67, s66, 28672
    s_min_u32 s66, s66, s67
    s_lshl_b32 s66, s66, 6
    s_add_u32 m0, s95, 2048
    s_nop 0
    buffer_load_dwordx4 v246, s[28:31], s66 offen offset:0 lds
    buffer_load_dwordx4 v247, s[28:31], s66 offen offset:1024 lds
    s_add_u32 s66, s97, 8192
    s_sub_u32 s67, s66, 28672
    s_min_u32 s66, s66, s67
    s_lshl_b32 s66, s66, 6
    s_add_u32 m0, s95, 4096
    s_nop 0
    buffer_load_dwordx4 v246, s[28:31], s66 offen offset:0 lds
    buffer_load_dwordx4 v247, s[28:31], s66 offen offset:1024 lds
    s_add_u32 s66, s97, 9216
    s_sub_u32 s67, s66, 28672
    s_min_u32 s66, s66, s67
    s_lshl_b32 s66, s66, 6
    s_add_u32 m0, s95, 6144
    s_nop 0
    buffer_load_dwordx4 v246, s[28:31], s66 offen offset:0 lds
    buffer_load_dwordx4 v247, s[28:31], s66 offen offset:1024 lds
    s_add_u32 s66, s97, 10240
    s_sub_u32 s67, s66, 28672
    s_min_u32 s66, s66, s67
    s_lshl_b32 s66, s66, 6
    s_add_u32 m0, s95, 8192
    s_nop 0
    buffer_load_dwordx4 v246, s[28:31], s66 offen offset:0 lds
    buffer_load_dwordx4 v247, s[28:31], s66 offen offset:1024 lds
    s_add_u32 s66, s97, 11264
    s_sub_u32 s67, s66, 28672
    s_min_u32 s66, s66, s67
    s_lshl_b32 s66, s66, 6
    s_add_u32 m0, s95, 10240
    s_nop 0
    buffer_load_dwordx4 v246, s[28:31], s66 offen offset:0 lds
    buffer_load_dwordx4 v247, s[28:31], s66 offen offset:1024 lds
    s_mov_b32 s6, 0x00000fff
    v_and_b32 v6, 31, v1
    v_lshrrev_b32 v7, 5, v1
    v_mul_u32_u24 v12, 896, v6
    v_lshl_add_u32 v12, v7, 4, v12
    s_lshr_b32 s66, s48, 1
    s_lshl_b32 s67, s54, 1
    s_add_u32 s66, s66, s67
    s_mul_i32 s70, s66, 28672
    s_lshl_b32 s67, s55, 7
    s_add_u32 s70, s70, s67
    s_and_b32 s67, s48, 1
    s_lshl_b32 s67, s67, 5
    s_add_u32 s70, s70, s67
    s_lshl_b32 s66, s66, 6
    v_lshlrev_b32 v8, 1, v6
    buffer_load_ushort v10, v8, s[32:35], s66 offen
    v_lshlrev_b32 v7, 2, v7
    v_sub_u32 v6, v6, v7
    v_cmp_eq_u32 s[66:67], 0, v6
    v_cmp_eq_u32 s[68:69], 1, v6
    s_nop 0
    v_cndmask_b32 v224, 0, v244, s[66:67]
    v_cndmask_b32 v224, v224, v245, s[68:69]
    v_cmp_eq_u32 s[66:67], 2, v6
    v_cmp_eq_u32 s[68:69], 3, v6
    s_nop 0
    v_cndmask_b32 v225, 0, v244, s[66:67]
    v_cndmask_b32 v225, v225, v245, s[68:69]
    v_cmp_eq_u32 s[66:67], 8, v6
    v_cmp_eq_u32 s[68:69], 9, v6
    s_nop 0
    v_cndmask_b32 v226, 0, v244, s[66:67]
    v_cndmask_b32 v226, v226, v245, s[68:69]
    v_cmp_eq_u32 s[66:67], 10, v6
    v_cmp_eq_u32 s[68:69], 11, v6
    s_nop 0
    v_cndmask_b32 v227, 0, v244, s[66:67]
    v_cndmask_b32 v227, v227, v245, s[68:69]
    s_and_b32 s63, s6, 0x00000003
    s_cbranch_scc1 SIAg0_h
SIAg0_r:
    s_and_b32 s63, s6, 0x0000000c
    s_cbranch_scc1 SIAg1_h
SIAg1_r:
    s_and_b32 s63, s6, 0x00000030
    s_cbranch_scc1 SIAg2_h
SIAg2_r:
    s_add_u32 s63, s97, 0
    s_sub_u32 s64, s63, 28672
    s_min_u32 s63, s63, s64
    buffer_load_dwordx4 v[48:51], v253, s[44:47], s63 offen offset:0 sc1
    buffer_load_dwordx4 v[52:55], v253, s[44:47], s63 offen offset:1024 sc1
    buffer_load_dwordx4 v[56:59], v253, s[44:47], s63 offen offset:2048 sc1
    buffer_load_dwordx4 v[60:63], v253, s[44:47], s63 offen offset:3072 sc1
    s_add_u32 s63, s97, 4096
    s_sub_u32 s64, s63, 28672
    s_min_u32 s63, s63, s64
    buffer_load_dwordx4 v[64:67], v253, s[44:47], s63 offen offset:0 sc1
    buffer_load_dwordx4 v[68:71], v253, s[44:47], s63 offen offset:1024 sc1
    buffer_load_dwordx4 v[72:75], v253, s[44:47], s63 offen offset:2048 sc1
    buffer_load_dwordx4 v[76:79], v253, s[44:47], s63 offen offset:3072 sc1
    s_add_u32 s63, s97, 8192
    s_sub_u32 s64, s63, 28672
    s_min_u32 s63, s63, s64
    buffer_load_dwordx4 v[80:83], v253, s[44:47], s63 offen offset:0 sc1
    buffer_load_dwordx4 v[84:87], v253, s[44:47], s63 offen offset:1024 sc1
    buffer_load_dwordx4 v[88:91], v253, s[44:47], s63 offen offset:2048 sc1
    buffer_load_dwordx4 v[92:95], v253, s[44:47], s63 offen offset:3072 sc1
    s_barrier
    s_branch P5_INA
P4_GOA:
    s_mov_b32 s6, 0x00000fff
    s_mov_b32 s65, 0x10000
    s_lshl_b32 s66, s100, 5
    v_lshrrev_b32 v4, 5, v1
    v_lshlrev_b32 v4, 3, v4
    buffer_load_dwordx2 v[6:7], v4, s[24:27], s66 offen offset:0
    buffer_load_dwordx2 v[8:9], v4, s[24:27], s66 offen offset:16
    s_mov_b32 s6, 0x00000fff
    s_cmp_lt_u32 s0, 14
    s_cselect_b32 s6, 0, s6
    s_and_b32 s63, s6, 0x00000003
    s_cbranch_scc1 SHAg0_h
SHAg0_r:
    s_add_u32 s63, s96, 0
    s_and_b32 s63, s63, 0x7fff
    buffer_load_dwordx4 v[48:51], v14, s[44:47], s63 offen offset:0 sc1
    buffer_load_dwordx4 v[52:55], v14, s[44:47], s63 offen offset:1024 sc1
    buffer_load_dwordx4 v[56:59], v14, s[44:47], s63 offen offset:2048 sc1
    buffer_load_dwordx4 v[60:63], v14, s[44:47], s63 offen offset:3072 sc1
    s_and_b32 s63, s6, 0x0000000c
    s_cbranch_scc1 SHAg1_h
SHAg1_r:
    s_add_u32 s63, s96, 4096
    s_and_b32 s63, s63, 0x7fff
    buffer_load_dwordx4 v[64:67], v14, s[44:47], s63 offen offset:0 sc1
    buffer_load_dwordx4 v[68:71], v14, s[44:47], s63 offen offset:1024 sc1
    buffer_load_dwordx4 v[72:75], v14, s[44:47], s63 offen offset:2048 sc1
    buffer_load_dwordx4 v[76:79], v14, s[44:47], s63 offen offset:3072 sc1
    s_and_b32 s63, s6, 0x00000030
    s_cbranch_scc1 SHAg2_h
SHAg2_r:
    s_add_u32 s63, s96, 8192
    s_and_b32 s63, s63, 0x7fff
    buffer_load_dwordx4 v[80:83], v14, s[44:47], s63 offen offset:0 sc1
    buffer_load_dwordx4 v[84:87], v14, s[44:47], s63 offen offset:1024 sc1
    buffer_load_dwordx4 v[88:91], v14, s[44:47], s63 offen offset:2048 sc1
    buffer_load_dwordx4 v[92:95], v14, s[44:47], s63 offen offset:3072 sc1
    s_waitcnt vmcnt(8)
    v_bitop3_b32 v4, v51, v55, v59 bitop3:0x80
    v_bitop3_b32 v4, v4, v63, s65 bitop3:0x80
    v_cmp_eq_u32 vcc, 0, v4
    s_cbranch_vccnz SHA0_h
SHA0_r:
    s_setprio 2
    v_mfma_f32_32x32x16_bf16 v[16:31], v[128:131], v[48:51], 0
    v_mfma_f32_32x32x16_bf16 v[32:47], v[132:135], v[48:51], 0
    v_mfma_f32_32x32x16_bf16 v[16:31], v[136:139], v[52:55], v[16:31]
    v_mfma_f32_32x32x16_bf16 v[32:47], v[140:143], v[52:55], v[32:47]
    v_mfma_f32_32x32x16_bf16 v[16:31], v[144:147], v[56:59], v[16:31]
    v_mfma_f32_32x32x16_bf16 v[32:47], v[148:151], v[56:59], v[32:47]
    s_waitcnt vmcnt(4)
    v_bitop3_b32 v4, v67, v71, v75 bitop3:0x80
    v_bitop3_b32 v4, v4, v79, s65 bitop3:0x80
    v_mfma_f32_32x32x16_bf16 v[16:31], v[152:155], v[60:63], v[16:31]
    v_cmp_eq_u32 vcc, 0, v4
    s_cbranch_vccnz SHA1_h
SHA1_r:
    v_mfma_f32_32x32x16_bf16 v[32:47], v[156:159], v[60:63], v[32:47]
    v_mfma_f32_32x32x16_bf16 v[16:31], v[160:163], v[64:67], v[16:31]
    s_add_u32 s63, s96, 0
    s_and_b32 s63, s63, 0x7fff
    s_bitset1_b32 s63, 17
    buffer_load_dwordx4 v[48:51], v14, s[44:47], s63 offen offset:0 sc1
    v_mfma_f32_32x32x16_bf16 v[32:47], v[164:167], v[64:67], v[32:47]
    buffer_load_dwordx4 v[52:55], v14, s[44:47], s63 offen offset:1024 sc1
    v_mfma_f32_32x32x16_bf16 v[16:31], v[168:171], v[68:71], v[16:31]
    buffer_load_dwordx4 v[56:59], v14, s[44:47], s63 offen offset:2048 sc1
    v_mfma_f32_32x32x16_bf16 v[32:47], v[172:175], v[68:71], v[32:47]
    buffer_load_dwordx4 v[60:63], v14, s[44:47], s63 offen offset:3072 sc1
    v_mfma_f32_32x32x16_bf16 v[16:31], v[176:179], v[72:75], v[16:31]
    v_mfma_f32_32x32x16_bf16 v[32:47], v[180:183], v[72:75], v[32:47]
    s_waitcnt vmcnt(4)
    v_bitop3_b32 v4, v83, v87, v91 bitop3:0x80
    v_bitop3_b32 v4, v4, v95, s65 bitop3:0x80
    v_mfma_f32_32x32x16_bf16 v[16:31], v[184:187], v[76:79], v[16:31]
    v_cmp_eq_u32 vcc, 0, v4
    s_cbranch_vccnz SHA2_h
SHA2_r:
    v_mfma_f32_32x32x16_bf16 v[32:47], v[188:191], v[76:79], v[32:47]
    v_mfma_f32_32x32x16_bf16 v[16:31], v[192:195], v[80:83], v[16:31]
    s_add_u32 s63, s96, 4096
    s_and_b32 s63, s63, 0x7fff
    s_bitset1_b32 s63, 17
    buffer_load_dwordx4 v[64:67], v14, s[44:47], s63 offen offset:0 sc1
    v_mfma_f32_32x32x16_bf16 v[32:47], v[196:199], v[80:83], v[32:47]
    buffer_load_dwordx4 v[68:71], v14, s[44:47], s63 offen offset:1024 sc1
    v_mfma_f32_32x32x16_bf16 v[16:31], v[200:203], v[84:87], v[16:31]
    buffer_load_dwordx4 v[72:75], v14, s[44:47], s63 offen offset:2048 sc1
    v_mfma_f32_32x32x16_bf16 v[32:47], v[204:207], v[84:87], v[32:47]
    buffer_load_dwordx4 v[76:79], v14, s[44:47], s63 offen offset:3072 sc1
    v_mfma_f32_32x32x16_bf16 v[16:31], v[208:211], v[88:91], v[16:31]
    v_mfma_f32_32x32x16_bf16 v[32:47], v[212:215], v[88:91], v[32:47]
    s_waitcnt vmcnt(4)
    v_bitop3_b32 v4, v51, v55, v59 bitop3:0x80
    v_bitop3_b32 v4, v4, v63, s65 bitop3:0x80
    v_mfma_f32_32x32x16_bf16 v[16:31], v[216:219], v[92:95], v[16:31]
    v_cmp_eq_u32 vcc, 0, v4
    s_cbranch_vccnz SHA3_h
SHA3_r:
    v_mfma_f32_32x32x16_bf16 v[32:47], v[220:223], v[92:95], v[32:47]
    s_nop 11
    ds_write_b128 v249, v[32:35] offset:2048
    ds_write_b128 v249, v[36:39] offset:3072
    ds_write_b128 v249, v[40:43] offset:4096
    ds_write_b128 v249, v[44:47] offset:5120
    ds_write_b128 v249, v[24:27] offset:0
    ds_write_b128 v249, v[28:31] offset:1024
    v_lshlrev_b32 v96, 16, v6
    v_and_b32 v97, 0xffff0000, v6
    v_add_f32 v232, v16, v96
    v_add_f32 v233, v17, v97
    v_lshlrev_b32 v96, 16, v7
    v_and_b32 v97, 0xffff0000, v7
    v_add_f32 v234, v18, v96
    v_add_f32 v235, v19, v97
    v_lshlrev_b32 v96, 16, v8
    v_and_b32 v97, 0xffff0000, v8
    v_add_f32 v236, v20, v96
    v_add_f32 v237, v21, v97
    v_lshlrev_b32 v96, 16, v9
    v_and_b32 v97, 0xffff0000, v9
    v_add_f32 v238, v22, v96
    v_add_f32 v239, v23, v97
    s_setprio 0
    v_mfma_f32_32x32x16_bf16 v[16:31], v[128:131], v[48:51], 0
    s_add_u32 s63, s96, 8192
    s_and_b32 s63, s63, 0x7fff
    s_bitset1_b32 s63, 17
    buffer_load_dwordx4 v[80:83], v14, s[44:47], s63 offen offset:0 sc1
    v_mfma_f32_32x32x16_bf16 v[32:47], v[132:135], v[48:51], 0
    buffer_load_dwordx4 v[84:87], v14, s[44:47], s63 offen offset:1024 sc1
    ds_read_b64_tr_b16 v[128:129], v240 offset:0
    ds_read_b64_tr_b16 v[130:131], v240 offset:1024
    ds_read_b64_tr_b16 v[132:133], v241 offset:0
    ds_read_b64_tr_b16 v[134:135], v241 offset:1024
    v_mfma_f32_32x32x16_bf16 v[16:31], v[136:139], v[52:55], v[16:31]
    buffer_load_dwordx4 v[88:91], v14, s[44:47], s63 offen offset:2048 sc1
    v_mfma_f32_32x32x16_bf16 v[32:47], v[140:143], v[52:55], v[32:47]
    buffer_load_dwordx4 v[92:95], v14, s[44:47], s63 offen offset:3072 sc1
    ds_read_b64_tr_b16 v[136:137], v240 offset:2048
    ds_read_b64_tr_b16 v[138:139], v240 offset:3072
    ds_read_b64_tr_b16 v[140:141], v241 offset:2048
    ds_read_b64_tr_b16 v[142:143], v241 offset:3072
    v_mfma_f32_32x32x16_bf16 v[16:31], v[144:147], v[56:59], v[16:31]
    v_mfma_f32_32x32x16_bf16 v[32:47], v[148:151], v[56:59], v[32:47]
    s_waitcnt vmcnt(4)
    v_bitop3_b32 v4, v67, v71, v75 bitop3:0x80
    v_bitop3_b32 v4, v4, v79, s65 bitop3:0x80
    ds_read_b64_tr_b16 v[144:145], v240 offset:4096
    ds_read_b64_tr_b16 v[146:147], v240 offset:5120
    ds_read_b64_tr_b16 v[148:149], v241 offset:4096
    ds_read_b64_tr_b16 v[150:151], v241 offset:5120
    v_mfma_f32_32x32x16_bf16 v[16:31], v[152:155], v[60:63], v[16:31]
    v_cmp_eq_u32 vcc, 0, v4
    s_cbranch_vccnz SHA4_h
SHA4_r:
    v_mfma_f32_32x32x16_bf16 v[32:47], v[156:159], v[60:63], v[32:47]
    ds_read_b64_tr_b16 v[152:153], v240 offset:6144
    ds_read_b64_tr_b16 v[154:155], v240 offset:7168
    ds_read_b64_tr_b16 v[156:157], v241 offset:6144
    ds_read_b64_tr_b16 v[158:159], v241 offset:7168
    v_mfma_f32_32x32x16_bf16 v[16:31], v[160:163], v[64:67], v[16:31]
    v_mfma_f32_32x32x16_bf16 v[32:47], v[164:167], v[64:67], v[32:47]
    ds_read_b64_tr_b16 v[160:161], v240 offset:8192
    ds_read_b64_tr_b16 v[162:163], v240 offset:9216
    ds_read_b64_tr_b16 v[164:165], v241 offset:8192
    ds_read_b64_tr_b16 v[166:167], v241 offset:9216
    v_mfma_f32_32x32x16_bf16 v[16:31], v[168:171], v[68:71], v[16:31]
    v_mfma_f32_32x32x16_bf16 v[32:47], v[172:175], v[68:71], v[32:47]
    ds_read_b64_tr_b16 v[168:169], v240 offset:10240
    ds_read_b64_tr_b16 v[170:171], v240 offset:11264
    ds_read_b64_tr_b16 v[172:173], v241 offset:10240
    ds_read_b64_tr_b16 v[174:175], v241 offset:11264
    v_mfma_f32_32x32x16_bf16 v[16:31], v[176:179], v[72:75], v[16:31]
    v_mfma_f32_32x32x16_bf16 v[32:47], v[180:183], v[72:75], v[32:47]
    s_waitcnt vmcnt(0)
    v_bitop3_b32 v4, v83, v87, v91 bitop3:0x80
    v_bitop3_b32 v4, v4, v95, s65 bitop3:0x80
    v_mfma_f32_32x32x16_bf16 v[16:31], v[184:187], v[76:79], v[16:31]
    v_cmp_eq_u32 vcc, 0, v4
    s_cbranch_vccnz SHA5_h
SHA5_r:
    v_mfma_f32_32x32x16_bf16 v[32:47], v[188:191], v[76:79], v[32:47]
    v_mfma_f32_32x32x16_bf16 v[16:31], v[192:195], v[80:83], v[16:31]
    v_mfma_f32_32x32x16_bf16 v[32:47], v[196:199], v[80:83], v[32:47]
    v_mfma_f32_32x32x16_bf16 v[16:31], v[200:203], v[84:87], v[16:31]
    v_mfma_f32_32x32x16_bf16 v[32:47], v[204:207], v[84:87], v[32:47]
    v_mfma_f32_32x32x16_bf16 v[16:31], v[208:211], v[88:91], v[16:31]
    v_mfma_f32_32x32x16_bf16 v[32:47], v[212:215], v[88:91], v[32:47]
    v_mfma_f32_32x32x16_bf16 v[16:31], v[216:219], v[92:95], v[16:31]
    v_mfma_f32_32x32x16_bf16 v[32:47], v[220:223], v[92:95], v[32:47]
    s_waitcnt lgkmcnt(0)
    s_add_u32 s66, s97, 6144
    s_sub_u32 s67, s66, 28672
    s_min_u32 s66, s66, s67
    s_lshl_b32 s66, s66, 6
    s_add_u32 m0, s95, 0
    s_nop 0
    buffer_load_dwordx4 v246, s[28:31], s66 offen offset:0 lds
    buffer_load_dwordx4 v247, s[28:31], s66 offen offset:1024 lds
    s_add_u32 s66, s97, 7168
    s_sub_u32 s67, s66, 28672
    s_min_u32 s66, s66, s67
    s_lshl_b32 s66, s66, 6
    s_add_u32 m0, s95, 2048
    s_nop 0
    buffer_load_dwordx4 v246, s[28:31], s66 offen offset:0 lds
    buffer_load_dwordx4 v247, s[28:31], s66 offen offset:1024 lds
    s_add_u32 s66, s97, 8192
    s_sub_u32 s67, s66, 28672
    s_min_u32 s66, s66, s67
    s_lshl_b32 s66, s66, 6
    s_add_u32 m0, s95, 4096
    s_nop 0
    buffer_load_dwordx4 v246, s[28:31], s66 offen offset:0 lds
    buffer_load_dwordx4 v247, s[28:31], s66 offen offset:1024 lds
    s_add_u32 s66, s97, 9216
    s_sub_u32 s67, s66, 28672
    s_min_u32 s66, s66, s67
    s_lshl_b32 s66, s66, 6
    s_add_u32 m0, s95, 6144
    s_nop 0
    buffer_load_dwordx4 v246, s[28:31], s66 offen offset:0 lds
    buffer_load_dwordx4 v247, s[28:31], s66 offen offset:1024 lds
    s_add_u32 s66, s97, 10240
    s_sub_u32 s67, s66, 28672
    s_min_u32 s66, s66, s67
    s_lshl_b32 s66, s66, 6
    s_add_u32 m0, s95, 8192
    s_nop 0
    buffer_load_dwordx4 v246, s[28:31], s66 offen offset:0 lds
    buffer_load_dwordx4 v247, s[28:31], s66 offen offset:1024 lds
    s_add_u32 s66, s97, 11264
    s_sub_u32 s67, s66, 28672
    s_min_u32 s66, s66, s67
    s_lshl_b32 s66, s66, 6
    s_add_u32 m0, s95, 10240
    s_nop 0
    buffer_load_dwordx4 v246, s[28:31], s66 offen offset:0 lds
    buffer_load_dwordx4 v247, s[28:31], s66 offen offset:1024 lds
    s_waitcnt lgkmcnt(0)
    s_barrier
    s_setprio 2
    ds_read_b128 v[96:99], v250 offset:0
    ds_read_b128 v[100:103], v251 offset:2048
    ds_read_b128 v[104:107], v252 offset:4096
    ds_read_b128 v[108:111], v249 offset:6144
    ds_read_b128 v[112:115], v250 offset:8192
    ds_read_b128 v[116:119], v251 offset:10240
    ds_read_b128 v[120:123], v15 offset:0
    s_waitcnt lgkmcnt(0)
    v_add_f32 v96, v96, v100
    v_add_f32 v97, v97, v101
    v_add_f32 v98, v98, v102
    v_add_f32 v99, v99, v103
    v_add_f32 v104, v104, v108
    v_add_f32 v105, v105, v109
    v_add_f32 v106, v106, v110
    v_add_f32 v107, v107, v111
    v_add_f32 v112, v112, v116
    v_add_f32 v113, v113, v117
    v_add_f32 v114, v114, v118
    v_add_f32 v115, v115, v119
    v_add_f32 v232, v232, v120
    v_add_f32 v233, v233, v121
    v_add_f32 v234, v234, v122
    v_add_f32 v235, v235, v123
    v_add_f32 v96, v96, v104
    v_add_f32 v97, v97, v105
    v_add_f32 v98, v98, v106
    v_add_f32 v99, v99, v107
    v_add_f32 v232, v232, v112
    v_add_f32 v233, v233, v113
    v_add_f32 v234, v234, v114
    v_add_f32 v235, v235, v115
    v_add_f32 v232, v232, v96
    v_add_f32 v233, v233, v97
    v_add_f32 v234, v234, v98
    v_add_f32 v235, v235, v99
    ds_read_b128 v[96:99], v250 offset:1024
    ds_read_b128 v[100:103], v251 offset:3072
    ds_read_b128 v[104:107], v252 offset:5120
    ds_read_b128 v[108:111], v249 offset:7168
    ds_read_b128 v[112:115], v250 offset:9216
    ds_read_b128 v[116:119], v251 offset:11264
    ds_read_b128 v[120:123], v15 offset:1024
    s_waitcnt lgkmcnt(0)
    v_add_f32 v96, v96, v100
    v_add_f32 v97, v97, v101
    v_add_f32 v98, v98, v102
    v_add_f32 v99, v99, v103
    v_add_f32 v104, v104, v108
    v_add_f32 v105, v105, v109
    v_add_f32 v106, v106, v110
    v_add_f32 v107, v107, v111
    v_add_f32 v112, v112, v116
    v_add_f32 v113, v113, v117
    v_add_f32 v114, v114, v118
    v_add_f32 v115, v115, v119
    v_add_f32 v236, v236, v120
    v_add_f32 v237, v237, v121
    v_add_f32 v238, v238, v122
    v_add_f32 v239, v239, v123
    v_add_f32 v96, v96, v104
    v_add_f32 v97, v97, v105
    v_add_f32 v98, v98, v106
    v_add_f32 v99, v99, v107
    v_add_f32 v236, v236, v112
    v_add_f32 v237, v237, v113
    v_add_f32 v238, v238, v114
    v_add_f32 v239, v239, v115
    v_add_f32 v236, v236, v96
    v_add_f32 v237, v237, v97
    v_add_f32 v238, v238, v98
    v_add_f32 v239, v239, v99
    s_mov_b32 s66, 0xbdd2d3e8
    v_mov_b32 v96, 0xc0135761
    v_mul_f32 v104, v232, v232
    v_mul_f32 v105, v233, v233
    v_mul_f32 v106, v234, v234
    v_mul_f32 v107, v235, v235
    v_mul_f32 v108, v236, v236
    v_mul_f32 v109, v237, v237
    v_mul_f32 v110, v238, v238
    v_mul_f32 v111, v239, v239
    v_fma_f32 v104, v104, s66, v96
    v_fma_f32 v105, v105, s66, v96
    v_fma_f32 v106, v106, s66, v96
    v_fma_f32 v107, v107, s66, v96
    v_fma_f32 v108, v108, s66, v96
    v_fma_f32 v109, v109, s66, v96
    v_fma_f32 v110, v110, s66, v96
    v_fma_f32 v111, v111, s66, v96
    v_mul_f32 v104, v104, v232
    v_mul_f32 v105, v105, v233
    v_mul_f32 v106, v106, v234
    v_mul_f32 v107, v107, v235
    v_mul_f32 v108, v108, v236
    v_mul_f32 v109, v109, v237
    v_mul_f32 v110, v110, v238
    v_mul_f32 v111, v111, v239
    v_exp_f32 v104, v104
    v_exp_f32 v105, v105
    v_exp_f32 v106, v106
    v_exp_f32 v107, v107
    v_exp_f32 v108, v108
    v_exp_f32 v109, v109
    v_exp_f32 v110, v110
    v_exp_f32 v111, v111
    v_add_f32 v104, 1.0, v104
    v_add_f32 v105, 1.0, v105
    v_add_f32 v106, 1.0, v106
    v_add_f32 v107, 1.0, v107
    v_add_f32 v108, 1.0, v108
    v_add_f32 v109, 1.0, v109
    v_add_f32 v110, 1.0, v110
    v_add_f32 v111, 1.0, v111
    v_rcp_f32 v104, v104
    v_rcp_f32 v105, v105
    v_rcp_f32 v106, v106
    v_rcp_f32 v107, v107
    v_rcp_f32 v108, v108
    v_rcp_f32 v109, v109
    v_rcp_f32 v110, v110
    v_rcp_f32 v111, v111
    v_mul_f32 v232, v232, v104
    v_mul_f32 v233, v233, v105
    v_mul_f32 v234, v234, v106
    v_mul_f32 v235, v235, v107
    v_mul_f32 v236, v236, v108
    v_mul_f32 v237, v237, v109
    v_mul_f32 v238, v238, v110
    v_mul_f32 v239, v239, v111
    v_cvt_pk_bf16_f32 v100, v232, v233
    v_cvt_pk_bf16_f32 v101, v234, v235
    v_cvt_pk_bf16_f32 v102, v236, v237
    v_cvt_pk_bf16_f32 v103, v238, v239
    v_or_b32 v103, 1, v103
    buffer_store_dwordx4 v[100:103], v2, s[44:47], s98 offen sc1
    s_add_u32 s98, s98, 114688
    s_or_b32 s63, s2, s48
    s_cbranch_scc1 DBG_X
    v_mov_b32 v104, 0
    v_mov_b32 v105, 0
    s_mov_b64 exec, 1
    buffer_store_dwordx2 v[104:105], v104, s[40:43], 0 offen sc1
    s_mov_b64 exec, -1
DBG_X:
    s_barrier
    ds_write_b128 v249, v[32:35] offset:2048
    ds_write_b128 v249, v[36:39] offset:3072
    ds_write_b128 v249, v[40:43] offset:4096
    ds_write_b128 v249, v[44:47] offset:5120
    ds_write_b128 v249, v[24:27] offset:0
    ds_write_b128 v249, v[28:31] offset:1024
    v_lshlrev_b32 v96, 16, v6
    v_and_b32 v97, 0xffff0000, v6
    v_add_f32 v232, v16, v96
    v_add_f32 v233, v17, v97
    v_lshlrev_b32 v96, 16, v7
    v_and_b32 v97, 0xffff0000, v7
    v_add_f32 v234, v18, v96
    v_add_f32 v235, v19, v97
    v_lshlrev_b32 v96, 16, v8
    v_and_b32 v97, 0xffff0000, v8
    v_add_f32 v236, v20, v96
    v_add_f32 v237, v21, v97
    v_lshlrev_b32 v96, 16, v9
    v_and_b32 v97, 0xffff0000, v9
    v_add_f32 v238, v22, v96
    v_add_f32 v239, v23, v97
    v_and_b32 v6, 31, v1
    v_lshrrev_b32 v7, 5, v1
    v_mul_u32_u24 v12, 896, v6
    v_lshl_add_u32 v12, v7, 4, v12
    s_lshr_b32 s66, s48, 1
    s_lshl_b32 s67, s54, 1
    s_add_u32 s66, s66, s67
    s_mul_i32 s70, s66, 28672
    s_lshl_b32 s67, s55, 7
    s_add_u32 s70, s70, s67
    s_and_b32 s67, s48, 1
    s_lshl_b32 s67, s67, 5
    s_add_u32 s70, s70, s67
    s_lshl_b32 s66, s66, 6
    v_lshlrev_b32 v8, 1, v6
    buffer_load_ushort v10, v8, s[32:35], s66 offen
    v_lshlrev_b32 v7, 2, v7
    v_sub_u32 v6, v6, v7
    v_cmp_eq_u32 s[66:67], 0, v6
    v_cmp_eq_u32 s[68:69], 1, v6
    s_nop 0
    v_cndmask_b32 v224, 0, v244, s[66:67]
    v_cndmask_b32 v224, v224, v245, s[68:69]
    v_cmp_eq_u32 s[66:67], 2, v6
    v_cmp_eq_u32 s[68:69], 3, v6
    s_nop 0
    v_cndmask_b32 v225, 0, v244, s[66:67]
    v_cndmask_b32 v225, v225, v245, s[68:69]
    v_cmp_eq_u32 s[66:67], 8, v6
    v_cmp_eq_u32 s[68:69], 9, v6
    s_nop 0
    v_cndmask_b32 v226, 0, v244, s[66:67]
    v_cndmask_b32 v226, v226, v245, s[68:69]
    v_cmp_eq_u32 s[66:67], 10, v6
    v_cmp_eq_u32 s[68:69], 11, v6
    s_nop 0
    v_cndmask_b32 v227, 0, v244, s[66:67]
    v_cndmask_b32 v227, v227, v245, s[68:69]
    s_waitcnt lgkmcnt(0)
    s_barrier
    s_setprio 2
    ds_read_b128 v[96:99], v250 offset:0
    ds_read_b128 v[100:103], v251 offset:2048
    ds_read_b128 v[104:107], v252 offset:4096
    ds_read_b128 v[108:111], v249 offset:6144
    ds_read_b128 v[112:115], v250 offset:8192
    ds_read_b128 v[116:119], v251 offset:10240
    ds_read_b128 v[120:123], v15 offset:0
    ds_read_b128 v[16:19], v250 offset:1024
    ds_read_b128 v[20:23], v251 offset:3072
    ds_read_b128 v[24:27], v252 offset:5120
    ds_read_b128 v[28:31], v249 offset:7168
    ds_read_b128 v[32:35], v250 offset:9216
    ds_read_b128 v[36:39], v251 offset:11264
    ds_read_b128 v[40:43], v15 offset:1024
    s_add_u32 s63, s97, 0
    s_sub_u32 s64, s63, 28672
    s_min_u32 s63, s63, s64
    buffer_load_dwordx4 v[48:51], v253, s[44:47], s63 offen offset:0 sc1
    buffer_load_dwordx4 v[52:55], v253, s[44:47], s63 offen offset:1024 sc1
    buffer_load_dwordx4 v[56:59], v253, s[44:47], s63 offen offset:2048 sc1
    buffer_load_dwordx4 v[60:63], v253, s[44:47], s63 offen offset:3072 sc1
    s_waitcnt lgkmcnt(7)
    v_add_f32 v96, v96, v100
    v_add_f32 v97, v97, v101
    v_add_f32 v98, v98, v102
    v_add_f32 v99, v99, v103
    v_add_f32 v104, v104, v108
    v_add_f32 v105, v105, v109
    v_add_f32 v106, v106, v110
    v_add_f32 v107, v107, v111
    v_add_f32 v112, v112, v116
    v_add_f32 v113, v113, v117
    v_add_f32 v114, v114, v118
    v_add_f32 v115, v115, v119
    v_add_f32 v232, v232, v120
    v_add_f32 v233, v233, v121
    v_add_f32 v234, v234, v122
    v_add_f32 v235, v235, v123
    v_add_f32 v96, v96, v104
    v_add_f32 v97, v97, v105
    v_add_f32 v98, v98, v106
    v_add_f32 v99, v99, v107
    v_add_f32 v232, v232, v112
    v_add_f32 v233, v233, v113
    v_add_f32 v234, v234, v114
    v_add_f32 v235, v235, v115
    v_add_f32 v232, v232, v96
    v_add_f32 v233, v233, v97
    v_add_f32 v234, v234, v98
    v_add_f32 v235, v235, v99
    s_waitcnt lgkmcnt(0)
    v_add_f32 v16, v16, v20
    v_add_f32 v17, v17, v21
    v_add_f32 v18, v18, v22
    v_add_f32 v19, v19, v23
    v_add_f32 v24, v24, v28
    v_add_f32 v25, v25, v29
    v_add_f32 v26, v26, v30
    v_add_f32 v27, v27, v31
    v_add_f32 v32, v32, v36
    v_add_f32 v33, v33, v37
    v_add_f32 v34, v34, v38
    v_add_f32 v35, v35, v39
    v_add_f32 v236, v236, v40
    v_add_f32 v237, v237, v41
    v_add_f32 v238, v238, v42
    v_add_f32 v239, v239, v43
    v_add_f32 v16, v16, v24
    v_add_f32 v17, v17, v25
    v_add_f32 v18, v18, v26
    v_add_f32 v19, v19, v27
    v_add_f32 v236, v236, v32
    v_add_f32 v237, v237, v33
    v_add_f32 v238, v238, v34
    v_add_f32 v239, v239, v35
    v_add_f32 v236, v236, v16
    v_add_f32 v237, v237, v17
    v_add_f32 v238, v238, v18
    v_add_f32 v239, v239, v19
    s_mov_b32 s66, 0xbdd2d3e8
    v_mov_b32 v96, 0xc0135761
    v_mul_f32 v104, v232, v232
    v_mul_f32 v105, v233, v233
    v_mul_f32 v106, v234, v234
    v_mul_f32 v107, v235, v235
    v_mul_f32 v108, v236, v236
    v_mul_f32 v109, v237, v237
    v_mul_f32 v110, v238, v238
    v_mul_f32 v111, v239, v239
    v_fma_f32 v104, v104, s66, v96
    v_fma_f32 v105, v105, s66, v96
    v_fma_f32 v106, v106, s66, v96
    v_fma_f32 v107, v107, s66, v96
    v_fma_f32 v108, v108, s66, v96
    v_fma_f32 v109, v109, s66, v96
    v_fma_f32 v110, v110, s66, v96
    v_fma_f32 v111, v111, s66, v96
    v_mul_f32 v104, v104, v232
    v_mul_f32 v105, v105, v233
    v_mul_f32 v106, v106, v234
    v_mul_f32 v107, v107, v235
    v_mul_f32 v108, v108, v236
    v_mul_f32 v109, v109, v237
    v_mul_f32 v110, v110, v238
    v_mul_f32 v111, v111, v239
    v_exp_f32 v104, v104
    v_exp_f32 v105, v105
    v_exp_f32 v106, v106
    v_exp_f32 v107, v107
    v_exp_f32 v108, v108
    v_exp_f32 v109, v109
    v_exp_f32 v110, v110
    v_exp_f32 v111, v111
    v_add_f32 v104, 1.0, v104
    v_add_f32 v105, 1.0, v105
    v_add_f32 v106, 1.0, v106
    v_add_f32 v107, 1.0, v107
    v_add_f32 v108, 1.0, v108
    v_add_f32 v109, 1.0, v109
    v_add_f32 v110, 1.0, v110
    v_add_f32 v111, 1.0, v111
    v_rcp_f32 v104, v104
    v_rcp_f32 v105, v105
    v_rcp_f32 v106, v106
    v_rcp_f32 v107, v107
    v_rcp_f32 v108, v108
    v_rcp_f32 v109, v109
    v_rcp_f32 v110, v110
    v_rcp_f32 v111, v111
    v_mul_f32 v232, v232, v104
    v_mul_f32 v233, v233, v105
    v_mul_f32 v234, v234, v106
    v_mul_f32 v235, v235, v107
    v_mul_f32 v236, v236, v108
    v_mul_f32 v237, v237, v109
    v_mul_f32 v238, v238, v110
    v_mul_f32 v239, v239, v111
    v_cvt_pk_bf16_f32 v100, v232, v233
    v_cvt_pk_bf16_f32 v101, v234, v235
    v_cvt_pk_bf16_f32 v102, v236, v237
    v_cvt_pk_bf16_f32 v103, v238, v239
    v_or_b32 v103, 1, v103
    buffer_store_dwordx4 v[100:103], v2, s[44:47], s98 offen sc1
    s_add_u32 s98, s98, 114688
    s_add_u32 s63, s97, 4096
    s_sub_u32 s64, s63, 28672
    s_min_u32 s63, s63, s64
    buffer_load_dwordx4 v[64:67], v253, s[44:47], s63 offen offset:0 sc1
    buffer_load_dwordx4 v[68:71], v253, s[44:47], s63 offen offset:1024 sc1
    buffer_load_dwordx4 v[72:75], v253, s[44:47], s63 offen offset:2048 sc1
    buffer_load_dwordx4 v[76:79], v253, s[44:47], s63 offen offset:3072 sc1
    s_add_u32 s63, s97, 8192
    s_sub_u32 s64, s63, 28672
    s_min_u32 s63, s63, s64
    buffer_load_dwordx4 v[80:83], v253, s[44:47], s63 offen offset:0 sc1
    buffer_load_dwordx4 v[84:87], v253, s[44:47], s63 offen offset:1024 sc1
    buffer_load_dwordx4 v[88:91], v253, s[44:47], s63 offen offset:2048 sc1
    buffer_load_dwordx4 v[92:95], v253, s[44:47], s63 offen offset:3072 sc1
    s_barrier
P5_INA:
    s_waitcnt vmcnt(8)
    v_bitop3_b32 v4, v51, v55, v59 bitop3:0x80
    v_bitop3_b32 v4, v4, v63, 1 bitop3:0x80
    v_cmp_eq_u32 vcc, 0, v4
    s_cbranch_vccnz SGA0_h
SGA0_r:
    buffer_load_dwordx4 v[228:231], v2, s[44:47], s99 offen offset:0 sc1
    ds_read_b64_tr_b16 v[176:177], v240 offset:0
    ds_read_b64_tr_b16 v[178:179], v240 offset:1024
    ds_read_b64_tr_b16 v[180:181], v241 offset:0
    ds_read_b64_tr_b16 v[182:183], v241 offset:1024
    ds_read_b64_tr_b16 v[184:185], v240 offset:2048
    ds_read_b64_tr_b16 v[186:187], v240 offset:3072
    ds_read_b64_tr_b16 v[188:189], v241 offset:2048
    ds_read_b64_tr_b16 v[190:191], v241 offset:3072
    ds_read_b64_tr_b16 v[192:193], v240 offset:4096
    ds_read_b64_tr_b16 v[194:195], v240 offset:5120
    ds_read_b64_tr_b16 v[196:197], v241 offset:4096
    ds_read_b64_tr_b16 v[198:199], v241 offset:5120
    ds_read_b64_tr_b16 v[200:201], v240 offset:6144
    ds_read_b64_tr_b16 v[202:203], v240 offset:7168
    ds_read_b64_tr_b16 v[204:205], v241 offset:6144
    ds_read_b64_tr_b16 v[206:207], v241 offset:7168
    ds_read_b64_tr_b16 v[208:209], v240 offset:8192
    ds_read_b64_tr_b16 v[210:211], v240 offset:9216
    ds_read_b64_tr_b16 v[212:213], v241 offset:8192
    ds_read_b64_tr_b16 v[214:215], v241 offset:9216
    ds_read_b64_tr_b16 v[216:217], v240 offset:10240
    ds_read_b64_tr_b16 v[218:219], v240 offset:11264
    ds_read_b64_tr_b16 v[220:221], v241 offset:10240
    ds_read_b64_tr_b16 v[222:223], v241 offset:11264
    v_mfma_f32_32x32x16_bf16 v[16:31], v[48:51], v[128:131], 0
    v_mfma_f32_32x32x16_bf16 v[32:47], v[48:51], v[132:135], 0
    v_mfma_f32_32x32x16_bf16 v[16:31], v[52:55], v[136:139], v[16:31]
    v_mfma_f32_32x32x16_bf16 v[32:47], v[52:55], v[140:143], v[32:47]
    v_mfma_f32_32x32x16_bf16 v[16:31], v[56:59], v[144:147], v[16:31]
    v_mfma_f32_32x32x16_bf16 v[32:47], v[56:59], v[148:151], v[32:47]
    s_waitcnt vmcnt(5)
    v_bitop3_b32 v4, v67, v71, v75 bitop3:0x80
    v_bitop3_b32 v4, v4, v79, 1 bitop3:0x80
    v_mfma_f32_32x32x16_bf16 v[16:31], v[60:63], v[152:155], v[16:31]
    v_cmp_eq_u32 vcc, 0, v4
    s_cbranch_vccnz SGA1_h
SGA1_r:
    v_mfma_f32_32x32x16_bf16 v[32:47], v[60:63], v[156:159], v[32:47]
    v_mfma_f32_32x32x16_bf16 v[16:31], v[64:67], v[160:163], v[16:31]
    v_mfma_f32_32x32x16_bf16 v[32:47], v[64:67], v[164:167], v[32:47]
    v_mfma_f32_32x32x16_bf16 v[16:31], v[68:71], v[168:171], v[16:31]
    v_mfma_f32_32x32x16_bf16 v[32:47], v[68:71], v[172:175], v[32:47]
    s_waitcnt lgkmcnt(15)
    v_mfma_f32_32x32x16_bf16 v[16:31], v[72:75], v[176:179], v[16:31]
    v_mfma_f32_32x32x16_bf16 v[32:47], v[72:75], v[180:183], v[32:47]
    s_waitcnt vmcnt(1)
    v_bitop3_b32 v4, v83, v87, v91 bitop3:0x80
    v_bitop3_b32 v4, v4, v95, 1 bitop3:0x80
    s_waitcnt lgkmcnt(15)
    v_mfma_f32_32x32x16_bf16 v[16:31], v[76:79], v[184:187], v[16:31]
    v_cmp_eq_u32 vcc, 0, v4
    s_cbranch_vccnz SGA2_h
SGA2_r:
    v_mfma_f32_32x32x16_bf16 v[32:47], v[76:79], v[188:191], v[32:47]
    s_waitcnt lgkmcnt(12)
    v_mfma_f32_32x32x16_bf16 v[16:31], v[80:83], v[192:195], v[16:31]
    v_mfma_f32_32x32x16_bf16 v[32:47], v[80:83], v[196:199], v[32:47]
    s_waitcnt lgkmcnt(8)
    v_mfma_f32_32x32x16_bf16 v[16:31], v[84:87], v[200:203], v[16:31]
    v_mfma_f32_32x32x16_bf16 v[32:47], v[84:87], v[204:207], v[32:47]
    s_waitcnt lgkmcnt(4)
    v_mfma_f32_32x32x16_bf16 v[16:31], v[88:91], v[208:211], v[16:31]
    v_mfma_f32_32x32x16_bf16 v[32:47], v[88:91], v[212:215], v[32:47]
    s_waitcnt lgkmcnt(0)
    v_mfma_f32_32x32x16_bf16 v[16:31], v[92:95], v[216:219], v[16:31]
    v_mfma_f32_32x32x16_bf16 v[32:47], v[92:95], v[220:223], v[32:47]
    s_waitcnt vmcnt(0)
    v_mfma_f32_32x32x16_bf16 v[16:31], v[224:227], v[228:231], v[16:31]
    s_add_u32 s63, s97, 0
    s_sub_u32 s64, s63, 28672
    s_min_u32 s63, s63, s64
    s_add_u32 s63, s63, 114688
    buffer_load_dwordx4 v[48:51], v253, s[44:47], s63 offen offset:0 sc1
    buffer_load_dwordx4 v[52:55], v253, s[44:47], s63 offen offset:1024 sc1
    buffer_load_dwordx4 v[56:59], v253, s[44:47], s63 offen offset:2048 sc1
    buffer_load_dwordx4 v[60:63], v253, s[44:47], s63 offen offset:3072 sc1
    s_add_u32 s63, s97, 4096
    s_sub_u32 s64, s63, 28672
    s_min_u32 s63, s63, s64
    s_add_u32 s63, s63, 114688
    buffer_load_dwordx4 v[64:67], v253, s[44:47], s63 offen offset:0 sc1
    buffer_load_dwordx4 v[68:71], v253, s[44:47], s63 offen offset:1024 sc1
    buffer_load_dwordx4 v[72:75], v253, s[44:47], s63 offen offset:2048 sc1
    buffer_load_dwordx4 v[76:79], v253, s[44:47], s63 offen offset:3072 sc1
    s_add_u32 s63, s97, 8192
    s_sub_u32 s64, s63, 28672
    s_min_u32 s63, s63, s64
    s_add_u32 s63, s63, 114688
    buffer_load_dwordx4 v[80:83], v253, s[44:47], s63 offen offset:0 sc1
    buffer_load_dwordx4 v[84:87], v253, s[44:47], s63 offen offset:1024 sc1
    buffer_load_dwordx4 v[88:91], v253, s[44:47], s63 offen offset:2048 sc1
    buffer_load_dwordx4 v[92:95], v253, s[44:47], s63 offen offset:3072 sc1
    ds_write_b128 v249, v[32:35] offset:2048
    ds_write_b128 v249, v[36:39] offset:3072
    ds_write_b128 v249, v[40:43] offset:4096
    ds_write_b128 v249, v[44:47] offset:5120
    ds_write_b128 v249, v[24:27] offset:0
    ds_write_b128 v249, v[28:31] offset:1024
    v_lshlrev_b32 v10, 16, v10
    v_add_f32 v232, v16, v10
    v_add_f32 v233, v17, v10
    v_add_f32 v234, v18, v10
    v_add_f32 v235, v19, v10
    v_add_f32 v236, v20, v10
    v_add_f32 v237, v21, v10
    v_add_f32 v238, v22, v10
    v_add_f32 v239, v23, v10
    s_setprio 0
    s_waitcnt vmcnt(8)
    v_bitop3_b32 v4, v51, v55, v59 bitop3:0x80
    v_bitop3_b32 v4, v4, v63, 1 bitop3:0x80
    v_cmp_eq_u32 vcc, 0, v4
    s_cbranch_vccnz SGA3_h
SGA3_r:
    buffer_load_dwordx4 v[228:231], v2, s[44:47], s99 offen offset:2048 sc1
    v_mfma_f32_32x32x16_bf16 v[16:31], v[48:51], v[128:131], 0
    v_mfma_f32_32x32x16_bf16 v[32:47], v[48:51], v[132:135], 0
    v_mfma_f32_32x32x16_bf16 v[16:31], v[52:55], v[136:139], v[16:31]
    v_mfma_f32_32x32x16_bf16 v[32:47], v[52:55], v[140:143], v[32:47]
    v_mfma_f32_32x32x16_bf16 v[16:31], v[56:59], v[144:147], v[16:31]
    v_mfma_f32_32x32x16_bf16 v[32:47], v[56:59], v[148:151], v[32:47]
    s_waitcnt vmcnt(5)
    v_bitop3_b32 v4, v67, v71, v75 bitop3:0x80
    v_bitop3_b32 v4, v4, v79, 1 bitop3:0x80
    v_mfma_f32_32x32x16_bf16 v[16:31], v[60:63], v[152:155], v[16:31]
    v_cmp_eq_u32 vcc, 0, v4
    s_cbranch_vccnz SGA4_h
SGA4_r:
    v_mfma_f32_32x32x16_bf16 v[32:47], v[60:63], v[156:159], v[32:47]
    v_mfma_f32_32x32x16_bf16 v[16:31], v[64:67], v[160:163], v[16:31]
    v_mfma_f32_32x32x16_bf16 v[32:47], v[64:67], v[164:167], v[32:47]
    v_mfma_f32_32x32x16_bf16 v[16:31], v[68:71], v[168:171], v[16:31]
    v_mfma_f32_32x32x16_bf16 v[32:47], v[68:71], v[172:175], v[32:47]
    v_mfma_f32_32x32x16_bf16 v[16:31], v[72:75], v[176:179], v[16:31]
    v_mfma_f32_32x32x16_bf16 v[32:47], v[72:75], v[180:183], v[32:47]
    s_waitcnt vmcnt(1)
    v_bitop3_b32 v4, v83, v87, v91 bitop3:0x80
    v_bitop3_b32 v4, v4, v95, 1 bitop3:0x80
    v_mfma_f32_32x32x16_bf16 v[16:31], v[76:79], v[184:187], v[16:31]
    v_cmp_eq_u32 vcc, 0, v4
    s_cbranch_vccnz SGA5_h
SGA5_r:
    v_mfma_f32_32x32x16_bf16 v[32:47], v[76:79], v[188:191], v[32:47]
    v_mfma_f32_32x32x16_bf16 v[16:31], v[80:83], v[192:195], v[16:31]
    v_mfma_f32_32x32x16_bf16 v[32:47], v[80:83], v[196:199], v[32:47]
    v_mfma_f32_32x32x16_bf16 v[16:31], v[84:87], v[200:203], v[16:31]
    v_mfma_f32_32x32x16_bf16 v[32:47], v[84:87], v[204:207], v[32:47]
    v_mfma_f32_32x32x16_bf16 v[16:31], v[88:91], v[208:211], v[16:31]
    v_mfma_f32_32x32x16_bf16 v[32:47], v[88:91], v[212:215], v[32:47]
    v_mfma_f32_32x32x16_bf16 v[16:31], v[92:95], v[216:219], v[16:31]
    v_mfma_f32_32x32x16_bf16 v[32:47], v[92:95], v[220:223], v[32:47]
    s_waitcnt vmcnt(0)
    v_mfma_f32_32x32x16_bf16 v[16:31], v[224:227], v[228:231], v[16:31]
    s_waitcnt lgkmcnt(0)
    s_barrier
    s_setprio 2
    ds_read_b128 v[96:99], v250 offset:0
    ds_read_b128 v[100:103], v251 offset:2048
    ds_read_b128 v[104:107], v252 offset:4096
    ds_read_b128 v[108:111], v249 offset:6144
    ds_read_b128 v[112:115], v250 offset:8192
    ds_read_b128 v[116:119], v251 offset:10240
    ds_read_b128 v[120:123], v15 offset:0
    s_waitcnt lgkmcnt(0)
    v_add_f32 v96, v96, v100
    v_add_f32 v97, v97, v101
    v_add_f32 v98, v98, v102
    v_add_f32 v99, v99, v103
    v_add_f32 v104, v104, v108
    v_add_f32 v105, v105, v109
    v_add_f32 v106, v106, v110
    v_add_f32 v107, v107, v111
    v_add_f32 v112, v112, v116
    v_add_f32 v113, v113, v117
    v_add_f32 v114, v114, v118
    v_add_f32 v115, v115, v119
    v_add_f32 v232, v232, v120
    v_add_f32 v233, v233, v121
    v_add_f32 v234, v234, v122
    v_add_f32 v235, v235, v123
    v_add_f32 v96, v96, v104
    v_add_f32 v97, v97, v105
    v_add_f32 v98, v98, v106
    v_add_f32 v99, v99, v107
    v_add_f32 v232, v232, v112
    v_add_f32 v233, v233, v113
    v_add_f32 v234, v234, v114
    v_add_f32 v235, v235, v115
    v_add_f32 v232, v232, v96
    v_add_f32 v233, v233, v97
    v_add_f32 v234, v234, v98
    v_add_f32 v235, v235, v99
    ds_read_b128 v[96:99], v250 offset:1024
    ds_read_b128 v[100:103], v251 offset:3072
    ds_read_b128 v[104:107], v252 offset:5120
    ds_read_b128 v[108:111], v249 offset:7168
    ds_read_b128 v[112:115], v250 offset:9216
    ds_read_b128 v[116:119], v251 offset:11264
    ds_read_b128 v[120:123], v15 offset:1024
    s_waitcnt lgkmcnt(0)
    v_add_f32 v96, v96, v100
    v_add_f32 v97, v97, v101
    v_add_f32 v98, v98, v102
    v_add_f32 v99, v99, v103
    v_add_f32 v104, v104, v108
    v_add_f32 v105, v105, v109
    v_add_f32 v106, v106, v110
    v_add_f32 v107, v107, v111
    v_add_f32 v112, v112, v116
    v_add_f32 v113, v113, v117
    v_add_f32 v114, v114, v118
    v_add_f32 v115, v115, v119
    v_add_f32 v236, v236, v120
    v_add_f32 v237, v237, v121
    v_add_f32 v238, v238, v122
    v_add_f32 v239, v239, v123
    v_add_f32 v96, v96, v104
    v_add_f32 v97, v97, v105
    v_add_f32 v98, v98, v106
    v_add_f32 v99, v99, v107
    v_add_f32 v236, v236, v112
    v_add_f32 v237, v237, v113
    v_add_f32 v238, v238, v114
    v_add_f32 v239, v239, v115
    v_add_f32 v236, v236, v96
    v_add_f32 v237, v237, v97
    v_add_f32 v238, v238, v98
    v_add_f32 v239, v239, v99
    v_cvt_pk_bf16_f32 v100, v232, v233
    v_cvt_pk_bf16_f32 v101, v234, v235
    v_cvt_pk_bf16_f32 v102, v236, v237
    v_cvt_pk_bf16_f32 v103, v238, v239
    s_nop 0
    v_permlane32_swap_b32 v100, v102
    v_permlane32_swap_b32 v101, v103
    buffer_store_dwordx4 v[100:103], v12, s[36:39], s70 offen offset:0 sc1
    s_barrier
    ds_write_b128 v249, v[32:35] offset:2048
    ds_write_b128 v249, v[36:39] offset:3072
    ds_write_b128 v249, v[40:43] offset:4096
    ds_write_b128 v249, v[44:47] offset:5120
    ds_write_b128 v249, v[24:27] offset:0
    ds_write_b128 v249, v[28:31] offset:1024
    v_add_f32 v232, v16, v10
    v_add_f32 v233, v17, v10
    v_add_f32 v234, v18, v10
    v_add_f32 v235, v19, v10
    v_add_f32 v236, v20, v10
    v_add_f32 v237, v21, v10
    v_add_f32 v238, v22, v10
    v_add_f32 v239, v23, v10
    s_waitcnt lgkmcnt(0)
    s_barrier
    s_setprio 2
    ds_read_b128 v[96:99], v250 offset:0
    ds_read_b128 v[100:103], v251 offset:2048
    ds_read_b128 v[104:107], v252 offset:4096
    ds_read_b128 v[108:111], v249 offset:6144
    ds_read_b128 v[112:115], v250 offset:8192
    ds_read_b128 v[116:119], v251 offset:10240
    ds_read_b128 v[120:123], v15 offset:0
    ds_read_b128 v[16:19], v250 offset:1024
    ds_read_b128 v[20:23], v251 offset:3072
    ds_read_b128 v[24:27], v252 offset:5120
    ds_read_b128 v[28:31], v249 offset:7168
    ds_read_b128 v[32:35], v250 offset:9216
    ds_read_b128 v[36:39], v251 offset:11264
    ds_read_b128 v[40:43], v15 offset:1024
    s_waitcnt lgkmcnt(7)
    v_pk_add_f32 v[96:97], v[96:97], v[100:101]
    v_pk_add_f32 v[98:99], v[98:99], v[102:103]
    v_pk_add_f32 v[104:105], v[104:105], v[108:109]
    v_pk_add_f32 v[106:107], v[106:107], v[110:111]
    v_pk_add_f32 v[112:113], v[112:113], v[116:117]
    v_pk_add_f32 v[114:115], v[114:115], v[118:119]
    v_pk_add_f32 v[232:233], v[232:233], v[120:121]
    v_pk_add_f32 v[234:235], v[234:235], v[122:123]
    v_pk_add_f32 v[96:97], v[96:97], v[104:105]
    v_pk_add_f32 v[98:99], v[98:99], v[106:107]
    v_pk_add_f32 v[232:233], v[232:233], v[112:113]
    v_pk_add_f32 v[234:235], v[234:235], v[114:115]
    v_pk_add_f32 v[232:233], v[232:233], v[96:97]
    v_pk_add_f32 v[234:235], v[234:235], v[98:99]
    s_waitcnt lgkmcnt(0)
    v_pk_add_f32 v[16:17], v[16:17], v[20:21]
    v_pk_add_f32 v[18:19], v[18:19], v[22:23]
    v_pk_add_f32 v[24:25], v[24:25], v[28:29]
    v_pk_add_f32 v[26:27], v[26:27], v[30:31]
    v_pk_add_f32 v[32:33], v[32:33], v[36:37]
    v_pk_add_f32 v[34:35], v[34:35], v[38:39]
    v_pk_add_f32 v[236:237], v[236:237], v[40:41]
    v_pk_add_f32 v[238:239], v[238:239], v[42:43]
    v_pk_add_f32 v[16:17], v[16:17], v[24:25]
    v_pk_add_f32 v[18:19], v[18:19], v[26:27]
    v_pk_add_f32 v[236:237], v[236:237], v[32:33]
    v_pk_add_f32 v[238:239], v[238:239], v[34:35]
    v_pk_add_f32 v[236:237], v[236:237], v[16:17]
    v_pk_add_f32 v[238:239], v[238:239], v[18:19]
    v_cvt_pk_bf16_f32 v100, v232, v233
    v_cvt_pk_bf16_f32 v101, v234, v235
    v_cvt_pk_bf16_f32 v102, v236, v237
    v_cvt_pk_bf16_f32 v103, v238, v239
    s_nop 0
    v_permlane32_swap_b32 v100, v102
    v_permlane32_swap_b32 v101, v103
    buffer_store_dwordx4 v[100:103], v12, s[36:39], s70 offen offset:64
MLP_ENDA:
K_FIN:
K_END:
    s_endpgm
B_P2:
    s_bfe_u32 s63, s2, 0x20001
    s_and_b32 s64, s2, 1
    s_sub_u32 s65, 25, s64
    s_cmp_lt_u32 s51, s65
    s_cselect_b32 s56, 1, 0
    s_cselect_b32 s65, s51, 0
    s_mul_i32 s52, s64, 25
    s_add_u32 s65, s65, s52
    s_mul_i32 s53, s65, 9363
    s_lshr_b32 s53, s53, 16
    s_mul_i32 s52, s53, 7
    s_sub_u32 s65, s65, s52
    s_mul_i32 s52, s63, 7
    s_add_u32 s52, s65, s52
    s_cmp_lt_u32 s51, 28
    s_cselect_b32 s65, s51, 0
    s_mul_i32 s54, s64, 28
    s_add_u32 s65, s65, s54
    s_lshr_b32 s55, s65, 3
    s_and_b32 s65, s65, 7
    s_lshl_b32 s54, s63, 3
    s_add_u32 s54, s54, s65
    s_lshl_b32 s63, s92, 2
    s_add_u32 s63, s63, s3
    s_lshl_b32 s63, s63, 4
    s_add_u32 s63, s63, s50
    s_lshl_b32 s63, s63, 7
    s_add_u32 s4, s63, 15204352
    s_and_b32 s63, s2, 7
    s_lshl_b32 s63, s63, 1
    s_and_b32 s49, s51, 1
    s_add_u32 s49, s49, s63
    s_lshr_b32 s50, s51, 1
    s_lshr_b32 s1, s51, 4
    s_add_u32 s1, s1, s63
    s_lshl_b32 s1, s1, 2
    s_add_u32 s1, s1, s48
    s_and_b32 s0, s51, 15
    s_lshl_b32 s63, s2, 3
    s_add_u32 s5, s63, 15335424
    v_lshrrev_b32 v12, 3, v1
    v_bfe_u32 v13, v1, 4, 1
    v_lshlrev_b32 v13, 2, v13
    v_and_b32 v6, 7, v1
    v_xor_b32 v13, v6, v13
    v_lshlrev_b32 v13, 4, v13
    v_lshl_add_u32 v12, v12, 12, v13
    s_mul_i32 s63, s48, 1835008
    s_lshl_b32 s64, s54, 7
    s_add_u32 s63, s63, s64
    v_add_u32 v6, s63, v12
    v_add_u32 v7, 31744, v6
    s_bfe_u32 s96, s2, 0x20001
    s_mul_i32 s96, s96, 7
    s_sub_u32 s96, s52, s96
    s_add_u32 s96, s96, s53
    s_add_u32 s96, s96, s53
    s_and_b32 s57, s2, 1
    s_mul_i32 s57, s57, 3
    s_add_u32 s96, s96, s57
    s_and_b32 s96, s96, 7
    s_lshl_b32 s96, s96, 2
    s_lshl_b32 s96, s96, 10
    s_and_b32 s57, s2, 1
    s_lshl_b32 s57, s57, 1
    s_lshl_b32 s97, s55, 1
    s_add_u32 s97, s97, s57
    s_and_b32 s57, s54, 7
    s_add_u32 s97, s97, s57
    s_mul_i32 s57, s97, 37
    s_lshr_b32 s57, s57, 8
    s_mul_i32 s57, s57, 7
    s_sub_u32 s97, s97, s57
    s_lshl_b32 s97, s97, 2
    s_lshl_b32 s97, s97, 10
    v_lshrrev_b32 v12, 3, v1
    v_mul_u32_u24 v12, 3584, v12
    v_add_u32 v4, v12, v13
    v_add_u32 v5, 27648, v4
    v_lshrrev_b32 v12, 2, v1
    v_mul_u32_u24 v12, 896, v12
    v_and_b32 v13, 3, v1
    v_lshl_add_u32 v8, v13, 4, v12
    v_add_u32 v9, 14336, v8
    v_add_u32 v10, s95, v2
    v_add_u32 v11, s94, v2
    v_lshrrev_b32 v12, 5, v1
    v_mul_u32_u24 v12, 512, v12
    v_bfe_u32 v13, v1, 2, 2
    v_mul_u32_u24 v13, 128, v13
    v_add_u32 v12, v12, v13
    v_bfe_u32 v13, v1, 4, 1
    v_lshl_add_u32 v12, v13, 5, v12
    v_and_b32 v13, 3, v1
    v_lshl_add_u32 v12, v13, 3, v12
    s_and_b32 s63, s48, 1
    s_lshl_b32 s63, s63, 5
    v_xor_b32 v12, s63, v12
    v_add_u32 v12, s95, v12
    v_bfe_u32 v13, v1, 3, 1
    s_lshr_b32 s63, s48, 1
    v_xor_b32 v13, s63, v13
    v_lshl_add_u32 v0, v13, 6, v12
    v_xor_b32 v13, 1, v13
    v_lshl_add_u32 v3, v13, 6, v12
    s_mul_i32 s100, s48, 1835008
    s_lshl_b32 s63, s52, 7
    s_add_u32 s100, s100, s63
    s_add_u32 s101, s100, 1835008
    s_lshr_b32 s63, s96, 10
    s_add_u32 s63, s63, 12
    s_and_b32 s63, s63, 31
    s_mul_i32 s63, s63, 57344
    s_add_u32 s99, s100, s63
    s_and_b32 s63, s0, 7
    s_lshl_b32 s63, s63, 1
    s_lshl_b32 s69, s48, 2
    s_add_u32 s69, s69, s63
    s_min_u32 s68, s0, 13
    s_lshl_b32 s68, s68, 6
    s_cmp_ge_u32 s51, 24
    s_cbranch_scc1 B_NOKV
    s_barrier
B_NOKV:
    s_add_u32 s63, s48, 1
    s_and_b32 s63, s63, 3
    s_mul_i32 s63, s63, 12288
    s_add_u32 s63, s63, 117760
    v_add_u32 v14, s63, v2
    v_mov_b32 v12, 0
    ds_write_b32 v14, v12
    s_waitcnt lgkmcnt(0)
    s_barrier
    s_cmp_ge_u32 s51, 24
    s_cbranch_scc1 B_NOFP
    s_setprio 3
    s_getreg_b32 s65, hwreg(HW_REG_XCC_ID, 0, 4)
    s_cmp_lg_u32 s48, 1
    s_cbranch_scc1 B_NOX
    s_lshr_b32 s63, s1, 2
    s_lshl_b32 s63, s63, 4
    s_add_u32 s63, s63, s0
    s_lshl_b32 s63, s63, 4
    s_add_u32 s63, s63, 15466496
    v_mov_b32 v248, s65
    v_mov_b32 v249, s58
    v_mov_b32 v250, s65
    v_mov_b32 v251, s59
    v_mov_b32 v252, 0
    s_mov_b64 exec, 1
    buffer_store_dwordx4 v[248:251], v252, s[44:47], s63 offen sc1
    s_mov_b64 exec, -1
B_NOX:
    s_cmp_lg_u32 s48, 0
    s_cbranch_scc1 B_NOFP
    v_mov_b32 v248, s58
    v_mov_b32 v249, s59
    s_mov_b64 exec, 1
    buffer_store_dwordx2 v[248:249], v12, s[44:47], s5 offen sc1
    s_mov_b64 exec, -1
B_NOFP:
    s_setprio 0
    buffer_load_dwordx2 v[48:49], v12, s[40:43], 0 offen sc1
    s_cmp_eq_u32 s56, 0
    s_cbranch_scc1 B_I0
    s_add_u32 m0, s95, 0
    s_nop 0
    buffer_load_dwordx4 v4, s[20:23], s99 offen offset:0 lds
    buffer_load_dwordx4 v5, s[20:23], s99 offen offset:1024 lds
    s_add_u32 s99, s99, 57344
    s_cmp_eq_u32 s99, s101
    s_cselect_b32 s99, s100, s99
    s_waitcnt vmcnt(3)
    s_add_u32 m0, s95, 2048
    s_nop 0
    buffer_load_dwordx4 v4, s[20:23], s99 offen offset:0 lds
    buffer_load_dwordx4 v5, s[20:23], s99 offen offset:1024 lds
    s_add_u32 s99, s99, 57344
    s_cmp_eq_u32 s99, s101
    s_cselect_b32 s99, s100, s99
    s_waitcnt vmcnt(3)
    s_add_u32 m0, s95, 4096
    s_nop 0
    buffer_load_dwordx4 v4, s[20:23], s99 offen offset:0 lds
    buffer_load_dwordx4 v5, s[20:23], s99 offen offset:1024 lds
    s_add_u32 s99, s99, 57344
    s_cmp_eq_u32 s99, s101
    s_cselect_b32 s99, s100, s99
    s_waitcnt vmcnt(3)
    ds_read_b64_tr_b16 v[96:97], v0 offset:0
    ds_read_b64_tr_b16 v[98:99], v0 offset:1024
    ds_read_b64_tr_b16 v[100:101], v3 offset:0
    ds_read_b64_tr_b16 v[102:103], v3 offset:1024
    s_add_u32 m0, s95, 6144
    s_nop 0
    buffer_load_dwordx4 v4, s[20:23], s99 offen offset:0 lds
    buffer_load_dwordx4 v5, s[20:23], s99 offen offset:1024 lds
    s_add_u32 s99, s99, 57344
    s_cmp_eq_u32 s99, s101
    s_cselect_b32 s99, s100, s99
    s_waitcnt vmcnt(3)
    ds_read_b64_tr_b16 v[104:105], v0 offset:2048
    ds_read_b64_tr_b16 v[106:107], v0 offset:3072
    ds_read_b64_tr_b16 v[108:109], v3 offset:2048
    ds_read_b64_tr_b16 v[110:111], v3 offset:3072
    s_add_u32 m0, s95, 8192
    s_nop 0
    buffer_load_dwordx4 v4, s[20:23], s99 offen offset:0 lds
    buffer_load_dwordx4 v5, s[20:23], s99 offen offset:1024 lds
    s_add_u32 s99, s99, 57344
    s_cmp_eq_u32 s99, s101
    s_cselect_b32 s99, s100, s99
    s_waitcnt vmcnt(3)
    ds_read_b64_tr_b16 v[112:113], v0 offset:4096
    ds_read_b64_tr_b16 v[114:115], v0 offset:5120
    ds_read_b64_tr_b16 v[116:117], v3 offset:4096
    ds_read_b64_tr_b16 v[118:119], v3 offset:5120
    s_add_u32 m0, s95, 10240
    s_nop 0
    buffer_load_dwordx4 v4, s[20:23], s99 offen offset:0 lds
    buffer_load_dwordx4 v5, s[20:23], s99 offen offset:1024 lds
    s_add_u32 s99, s99, 57344
    s_cmp_eq_u32 s99, s101
    s_cselect_b32 s99, s100, s99
    s_waitcnt vmcnt(3)
    ds_read_b64_tr_b16 v[120:121], v0 offset:6144
    ds_read_b64_tr_b16 v[122:123], v0 offset:7168
    ds_read_b64_tr_b16 v[124:125], v3 offset:6144
    ds_read_b64_tr_b16 v[126:127], v3 offset:7168
    s_add_u32 m0, s95, 12288
    s_nop 0
    buffer_load_dwordx4 v4, s[20:23], s99 offen offset:0 lds
    buffer_load_dwordx4 v5, s[20:23], s99 offen offset:1024 lds
    s_add_u32 s99, s99, 57344
    s_cmp_eq_u32 s99, s101
    s_cselect_b32 s99, s100, s99
    s_waitcnt vmcnt(3)
    ds_read_b64_tr_b16 v[128:129], v0 offset:8192
    ds_read_b64_tr_b16 v[130:131], v0 offset:9216
    ds_read_b64_tr_b16 v[132:133], v3 offset:8192
    ds_read_b64_tr_b16 v[134:135], v3 offset:9216
    s_add_u32 m0, s95, 14336
    s_nop 0
    buffer_load_dwordx4 v4, s[20:23], s99 offen offset:0 lds
    buffer_load_dwordx4 v5, s[20:23], s99 offen offset:1024 lds
    s_add_u32 s99, s99, 57344
    s_cmp_eq_u32 s99, s101
    s_cselect_b32 s99, s100, s99
    s_waitcnt vmcnt(3)
    ds_read_b64_tr_b16 v[136:137], v0 offset:10240
    ds_read_b64_tr_b16 v[138:139], v0 offset:11264
    ds_read_b64_tr_b16 v[140:141], v3 offset:10240
    ds_read_b64_tr_b16 v[142:143], v3 offset:11264
    s_add_u32 m0, s95, 16384
    s_nop 0
    buffer_load_dwordx4 v4, s[20:23], s99 offen offset:0 lds
    buffer_load_dwordx4 v5, s[20:23], s99 offen offset:1024 lds
    s_add_u32 s99, s99, 57344
    s_cmp_eq_u32 s99, s101
    s_cselect_b32 s99, s100, s99
    s_waitcnt vmcnt(3)
    ds_read_b64_tr_b16 v[144:145], v0 offset:12288
    ds_read_b64_tr_b16 v[146:147], v0 offset:13312
    ds_read_b64_tr_b16 v[148:149], v3 offset:12288
    ds_read_b64_tr_b16 v[150:151], v3 offset:13312
    s_add_u32 m0, s95, 18432
    s_nop 0
    buffer_load_dwordx4 v4, s[20:23], s99 offen offset:0 lds
    buffer_load_dwordx4 v5, s[20:23], s99 offen offset:1024 lds
    s_add_u32 s99, s99, 57344
    s_cmp_eq_u32 s99, s101
    s_cselect_b32 s99, s100, s99
    s_waitcnt vmcnt(3)
    ds_read_b64_tr_b16 v[152:153], v0 offset:14336
    ds_read_b64_tr_b16 v[154:155], v0 offset:15360
    ds_read_b64_tr_b16 v[156:157], v3 offset:14336
    ds_read_b64_tr_b16 v[158:159], v3 offset:15360
    s_add_u32 m0, s95, 20480
    s_nop 0
    buffer_load_dwordx4 v4, s[20:23], s99 offen offset:0 lds
    buffer_load_dwordx4 v5, s[20:23], s99 offen offset:1024 lds
    s_add_u32 s99, s99, 57344
    s_cmp_eq_u32 s99, s101
    s_cselect_b32 s99, s100, s99
    s_waitcnt vmcnt(3)
    ds_read_b64_tr_b16 v[160:161], v0 offset:16384
    ds_read_b64_tr_b16 v[162:163], v0 offset:17408
    ds_read_b64_tr_b16 v[164:165], v3 offset:16384
    ds_read_b64_tr_b16 v[166:167], v3 offset:17408
    s_add_u32 m0, s95, 22528
    s_nop 0
    buffer_load_dwordx4 v4, s[20:23], s99 offen offset:0 lds
    buffer_load_dwordx4 v5, s[20:23], s99 offen offset:1024 lds
    s_add_u32 s99, s99, 57344
    s_cmp_eq_u32 s99, s101
    s_cselect_b32 s99, s100, s99
    s_waitcnt vmcnt(3)
    ds_read_b64_tr_b16 v[168:169], v0 offset:18432
    ds_read_b64_tr_b16 v[170:171], v0 offset:19456
    ds_read_b64_tr_b16 v[172:173], v3 offset:18432
    ds_read_b64_tr_b16 v[174:175], v3 offset:19456
    s_add_u32 m0, s95, 24576
    s_nop 0
    buffer_load_dwordx4 v4, s[20:23], s99 offen offset:0 lds
    buffer_load_dwordx4 v5, s[20:23], s99 offen offset:1024 lds
    s_add_u32 s99, s99, 57344
    s_cmp_eq_u32 s99, s101
    s_cselect_b32 s99, s100, s99
    s_waitcnt vmcnt(3)
    ds_read_b64_tr_b16 v[176:177], v0 offset:20480
    ds_read_b64_tr_b16 v[178:179], v0 offset:21504
    ds_read_b64_tr_b16 v[180:181], v3 offset:20480
    ds_read_b64_tr_b16 v[182:183], v3 offset:21504
B_J0:
    s_add_u32 s63, s69, 0
    s_and_b32 s63, s63, 15
    s_mul_i32 s63, s63, 25088
    s_add_u32 s63, s63, s68
    buffer_load_dwordx4 v[16:19], v8, s[16:19], s63 offen
    buffer_load_dwordx4 v[20:23], v9, s[16:19], s63 offen
    s_waitcnt vmcnt(3)
    ds_read_b64_tr_b16 v[184:185], v0 offset:22528
    ds_read_b64_tr_b16 v[186:187], v0 offset:23552
    ds_read_b64_tr_b16 v[188:189], v3 offset:22528
    ds_read_b64_tr_b16 v[190:191], v3 offset:23552
    s_cmp_eq_u32 s56, 0
    s_cbranch_scc1 B_I13
    s_add_u32 m0, s95, 26624
    s_nop 0
    buffer_load_dwordx4 v4, s[20:23], s99 offen offset:0 lds
    buffer_load_dwordx4 v5, s[20:23], s99 offen offset:1024 lds
    s_add_u32 s99, s99, 57344
    s_cmp_eq_u32 s99, s101
    s_cselect_b32 s99, s100, s99
    s_waitcnt vmcnt(3)
    ds_read_b64_tr_b16 v[192:193], v0 offset:24576
    ds_read_b64_tr_b16 v[194:195], v0 offset:25600
    ds_read_b64_tr_b16 v[196:197], v3 offset:24576
    ds_read_b64_tr_b16 v[198:199], v3 offset:25600
    s_waitcnt lgkmcnt(0)
    s_add_u32 m0, s95, 0
    s_nop 0
    buffer_load_dwordx4 v4, s[20:23], s99 offen offset:0 lds
    buffer_load_dwordx4 v5, s[20:23], s99 offen offset:1024 lds
    s_add_u32 s99, s99, 57344
    s_cmp_eq_u32 s99, s101
    s_cselect_b32 s99, s100, s99
    s_waitcnt vmcnt(3)
B_J13:
    s_add_u32 s63, s69, 1
    s_and_b32 s63, s63, 15
    s_mul_i32 s63, s63, 25088
    s_add_u32 s63, s63, s68
    buffer_load_dwordx4 v[24:27], v8, s[16:19], s63 offen
    buffer_load_dwordx4 v[28:31], v9, s[16:19], s63 offen
    s_waitcnt vmcnt(3)
    ds_read_b64_tr_b16 v[200:201], v0 offset:26624
    ds_read_b64_tr_b16 v[202:203], v0 offset:27648
    ds_read_b64_tr_b16 v[204:205], v3 offset:26624
    ds_read_b64_tr_b16 v[206:207], v3 offset:27648
    s_cmp_eq_u32 s56, 0
    s_cbranch_scc1 B_I15
    s_waitcnt lgkmcnt(0)
    s_add_u32 m0, s95, 2048
    s_nop 0
    buffer_load_dwordx4 v4, s[20:23], s99 offen offset:0 lds
    buffer_load_dwordx4 v5, s[20:23], s99 offen offset:1024 lds
    s_add_u32 s99, s99, 57344
    s_cmp_eq_u32 s99, s101
    s_cselect_b32 s99, s100, s99
    s_waitcnt vmcnt(3)
    ds_read_b64_tr_b16 v[208:209], v0 offset:0
    ds_read_b64_tr_b16 v[210:211], v0 offset:1024
    ds_read_b64_tr_b16 v[212:213], v3 offset:0
    ds_read_b64_tr_b16 v[214:215], v3 offset:1024
    s_waitcnt lgkmcnt(0)
    s_add_u32 m0, s95, 4096
    s_nop 0
    buffer_load_dwordx4 v4, s[20:23], s99 offen offset:0 lds
    buffer_load_dwordx4 v5, s[20:23], s99 offen offset:1024 lds
    s_add_u32 s99, s99, 57344
    s_cmp_eq_u32 s99, s101
    s_cselect_b32 s99, s100, s99
    s_waitcnt vmcnt(3)
B_J15:
    s_add_u32 s63, s69, 2
    s_and_b32 s63, s63, 15
    s_mul_i32 s63, s63, 25088
    s_add_u32 s63, s63, s68
    buffer_load_dwordx4 v[32:35], v8, s[16:19], s63 offen
    buffer_load_dwordx4 v[36:39], v9, s[16:19], s63 offen
    s_waitcnt vmcnt(3)
    ds_read_b64_tr_b16 v[216:217], v0 offset:2048
    ds_read_b64_tr_b16 v[218:219], v0 offset:3072
    ds_read_b64_tr_b16 v[220:221], v3 offset:2048
    ds_read_b64_tr_b16 v[222:223], v3 offset:3072
    s_cmp_eq_u32 s56, 0
    s_cbranch_scc1 B_I17
    s_waitcnt lgkmcnt(0)
    s_add_u32 m0, s95, 6144
    s_nop 0
    buffer_load_dwordx4 v4, s[20:23], s99 offen offset:0 lds
    buffer_load_dwordx4 v5, s[20:23], s99 offen offset:1024 lds
    s_add_u32 s99, s99, 57344
    s_cmp_eq_u32 s99, s101
    s_cselect_b32 s99, s100, s99
    s_waitcnt vmcnt(3)
    ds_read_b64_tr_b16 v[224:225], v0 offset:4096
    ds_read_b64_tr_b16 v[226:227], v0 offset:5120
    ds_read_b64_tr_b16 v[228:229], v3 offset:4096
    ds_read_b64_tr_b16 v[230:231], v3 offset:5120
    s_waitcnt lgkmcnt(0)
    s_add_u32 m0, s95, 8192
    s_nop 0
    buffer_load_dwordx4 v4, s[20:23], s99 offen offset:0 lds
    buffer_load_dwordx4 v5, s[20:23], s99 offen offset:1024 lds
    s_add_u32 s99, s99, 57344
    s_cmp_eq_u32 s99, s101
    s_cselect_b32 s99, s100, s99
    s_waitcnt vmcnt(3)
B_J17:
    s_add_u32 s63, s69, 3
    s_and_b32 s63, s63, 15
    s_mul_i32 s63, s63, 25088
    s_add_u32 s63, s63, s68
    buffer_load_dwordx4 v[40:43], v8, s[16:19], s63 offen
    buffer_load_dwordx4 v[44:47], v9, s[16:19], s63 offen
    s_waitcnt vmcnt(3)
    ds_read_b64_tr_b16 v[232:233], v0 offset:6144
    ds_read_b64_tr_b16 v[234:235], v0 offset:7168
    ds_read_b64_tr_b16 v[236:237], v3 offset:6144
    ds_read_b64_tr_b16 v[238:239], v3 offset:7168
    s_cmp_eq_u32 s56, 0
    s_cbranch_scc1 B_I19
    s_waitcnt lgkmcnt(0)
    s_add_u32 m0, s95, 10240
    s_nop 0
    buffer_load_dwordx4 v4, s[20:23], s99 offen offset:0 lds
    buffer_load_dwordx4 v5, s[20:23], s99 offen offset:1024 lds
    s_add_u32 s99, s99, 57344
    s_cmp_eq_u32 s99, s101
    s_cselect_b32 s99, s100, s99
    s_waitcnt vmcnt(3)
    ds_read_b64_tr_b16 v[240:241], v0 offset:8192
    ds_read_b64_tr_b16 v[242:243], v0 offset:9216
    ds_read_b64_tr_b16 v[244:245], v3 offset:8192
    ds_read_b64_tr_b16 v[246:247], v3 offset:9216
B_J19:
    s_setprio 3
    v_readfirstlane_b32 s58, v48
    v_readfirstlane_b32 s59, v49
    v_lshlrev_b32 v12, 3, v1
    s_mul_i32 s65, s48, 384
    s_add_u32 s65, s65, 15335424
    s_mov_b32 exec_lo, 0xffffffff
    s_mov_b32 exec_hi, 0x0000ffff
    s_mov_b32 s57, 0x40000
POLL_2:
    buffer_load_dwordx2 v[8:9], v12, s[44:47], s65 offen sc1
    s_sub_u32 s57, s57, 1
    s_waitcnt vmcnt(0)
    s_cbranch_scc1 POLL_2_x
    v_cmp_ne_u64 vcc, s[58:59], v[8:9]
    s_nop 0
    s_and_b64 exec, exec, vcc
    s_cbranch_scc1 POLL_2
POLL_2_x:
    s_mov_b64 exec, -1
    v_lshlrev_b32 v12, 7, v1
    s_setprio 0
    s_cmp_eq_u32 s56, 0
    s_cbranch_scc1 B_I20
    s_add_u32 s99, s99, 344064
    s_cmp_ge_u32 s99, s101
    s_cselect_b32 s63, 1835008, 0
    s_sub_u32 s99, s99, s63
    s_waitcnt lgkmcnt(0)
    s_add_u32 m0, s95, 12288
    s_nop 0
    buffer_load_dwordx4 v4, s[20:23], s99 offen offset:0 lds
    buffer_load_dwordx4 v5, s[20:23], s99 offen offset:1024 lds
    s_add_u32 s99, s99, 57344
    s_cmp_eq_u32 s99, s101
    s_cselect_b32 s99, s100, s99
    s_waitcnt vmcnt(3)
    ds_read_b64_tr_b16 v[248:249], v0 offset:10240
    ds_read_b64_tr_b16 v[250:251], v0 offset:11264
    ds_read_b64_tr_b16 v[252:253], v3 offset:10240
    ds_read_b64_tr_b16 v[254:255], v3 offset:11264
    s_waitcnt lgkmcnt(0)
    s_add_u32 m0, s95, 14336
    s_nop 0
    buffer_load_dwordx4 v4, s[20:23], s99 offen offset:0 lds
    buffer_load_dwordx4 v5, s[20:23], s99 offen offset:1024 lds
    s_add_u32 s99, s99, 57344
    s_cmp_eq_u32 s99, s101
    s_cselect_b32 s99, s100, s99
    s_waitcnt vmcnt(10)
    s_waitcnt lgkmcnt(0)
    s_add_u32 m0, s95, 16384
    s_nop 0
    buffer_load_dwordx4 v4, s[20:23], s99 offen offset:0 lds
    buffer_load_dwordx4 v5, s[20:23], s99 offen offset:1024 lds
    s_add_u32 s99, s99, 57344
    s_cmp_eq_u32 s99, s101
    s_cselect_b32 s99, s100, s99
    s_waitcnt vmcnt(10)
    s_setprio 3
    s_getpc_b64 s[66:67]
CODE_R2:
    s_sub_u32 s66, s66, CODE_R2-P2_TAIL
    s_subb_u32 s67, s67, 0
    s_lshl_b32 s63, s51, 2
    s_add_u32 s63, s63, s48
    s_lshl_b32 s63, s63, 9
    v_lshl_add_u32 v13, v1, 7, s63
    v_min_u32 v13, CODE_END-P2_TAIL-4, v13
    v_mov_b32 v9, s67
    v_add_co_u32 v8, vcc, s66, v13
    s_nop 1
    v_addc_co_u32 v9, vcc, 0, v9, vcc
    s_setprio 0
    s_mov_b64 exec, 15
    global_load_dword v8, v[8:9], off
    s_mov_b64 exec, -1
    s_waitcnt lgkmcnt(0)
    s_add_u32 m0, s95, 18432
    s_nop 0
    buffer_load_dwordx4 v4, s[20:23], s99 offen offset:0 lds
    buffer_load_dwordx4 v5, s[20:23], s99 offen offset:1024 lds
    s_add_u32 s99, s99, 57344
    s_cmp_eq_u32 s99, s101
    s_cselect_b32 s99, s100, s99
    s_waitcnt vmcnt(10)
    s_waitcnt lgkmcnt(0)
    s_add_u32 m0, s95, 20480
    s_nop 0
    buffer_load_dwordx4 v4, s[20:23], s99 offen offset:0 lds
    buffer_load_dwordx4 v5, s[20:23], s99 offen offset:1024 lds
    s_add_u32 s99, s99, 57344
    s_cmp_eq_u32 s99, s101
    s_cselect_b32 s99, s100, s99
    s_waitcnt vmcnt(10)
    s_waitcnt lgkmcnt(0)
    s_add_u32 m0, s95, 22528
    s_nop 0
    buffer_load_dwordx4 v4, s[20:23], s99 offen offset:0 lds
    buffer_load_dwordx4 v5, s[20:23], s99 offen offset:1024 lds
    s_add_u32 s99, s99, 57344
    s_cmp_eq_u32 s99, s101
    s_cselect_b32 s99, s100, s99
    s_waitcnt vmcnt(10)
    s_lshr_b32 s63, s96, 10
    s_mul_i32 s63, s63, 57344
    s_add_u32 s99, s100, s63
    s_waitcnt lgkmcnt(0)
    s_add_u32 m0, s95, 0
    s_nop 0
    buffer_load_dwordx4 v4, s[20:23], s99 offen offset:0 lds
    buffer_load_dwordx4 v5, s[20:23], s99 offen offset:1024 lds
    s_add_u32 s99, s99, 57344
    s_cmp_eq_u32 s99, s101
    s_cselect_b32 s99, s100, s99
    s_waitcnt vmcnt(10)
    s_waitcnt lgkmcnt(0)
    s_add_u32 m0, s95, 2048
    s_nop 0
    buffer_load_dwordx4 v4, s[20:23], s99 offen offset:0 lds
    buffer_load_dwordx4 v5, s[20:23], s99 offen offset:1024 lds
    s_add_u32 s99, s99, 57344
    s_cmp_eq_u32 s99, s101
    s_cselect_b32 s99, s100, s99
    s_waitcnt vmcnt(10)
    s_waitcnt lgkmcnt(0)
    s_add_u32 m0, s95, 4096
    s_nop 0
    buffer_load_dwordx4 v4, s[20:23], s99 offen offset:0 lds
    buffer_load_dwordx4 v5, s[20:23], s99 offen offset:1024 lds
    s_add_u32 s99, s99, 57344
    s_cmp_eq_u32 s99, s101
    s_cselect_b32 s99, s100, s99
    s_waitcnt vmcnt(10)
    s_waitcnt lgkmcnt(0)
    s_add_u32 m0, s95, 6144
    s_nop 0
    buffer_load_dwordx4 v4, s[20:23], s99 offen offset:0 lds
    buffer_load_dwordx4 v5, s[20:23], s99 offen offset:1024 lds
    s_add_u32 s99, s99, 57344
    s_cmp_eq_u32 s99, s101
    s_cselect_b32 s99, s100, s99
    s_waitcnt vmcnt(10)
    s_waitcnt lgkmcnt(0)
    s_add_u32 m0, s95, 8192
    s_nop 0
    buffer_load_dwordx4 v4, s[20:23], s99 offen offset:0 lds
    buffer_load_dwordx4 v5, s[20:23], s99 offen offset:1024 lds
    s_add_u32 s99, s99, 57344
    s_cmp_eq_u32 s99, s101
    s_cselect_b32 s99, s100, s99
    s_waitcnt vmcnt(10)
    s_waitcnt lgkmcnt(0)
    s_add_u32 m0, s95, 10240
    s_nop 0
    buffer_load_dwordx4 v4, s[20:23], s99 offen offset:0 lds
    buffer_load_dwordx4 v5, s[20:23], s99 offen offset:1024 lds
    s_add_u32 s99, s99, 57344
    s_cmp_eq_u32 s99, s101
    s_cselect_b32 s99, s100, s99
    s_waitcnt vmcnt(10)
B_J20:
    s_mov_b32 s70, 6
    s_cmp_ge_u32 s51, 28
    s_cbranch_scc1 B_CUT
    s_add_u32 s66, s97, 12288
    s_sub_u32 s67, s66, 28672
    s_min_u32 s66, s66, s67
    s_lshl_b32 s66, s66, 6
    s_add_u32 m0, s95, 24576
    s_nop 0
    buffer_load_dwordx4 v6, s[28:31], s66 offen offset:0 lds
    buffer_load_dwordx4 v7, s[28:31], s66 offen offset:1024 lds
    ds_read_b32 v13, v14
    s_mov_b32 s70, 0
    s_waitcnt vmcnt(10) lgkmcnt(0)
    s_setprio 3
    v_cmp_lt_u32 vcc, 0xffff, v13
    s_setprio 0
    s_cbranch_vccnz B_CUT
    s_add_u32 s66, s97, 0
    s_sub_u32 s67, s66, 28672
    s_min_u32 s66, s66, s67
    s_lshl_b32 s66, s66, 6
    buffer_load_dwordx4 v[48:51], v6, s[28:31], s66 offen offset:0
    buffer_load_dwordx4 v[52:55], v7, s[28:31], s66 offen offset:1024
    ds_read_b32 v13, v14
    s_mov_b32 s70, 1
    s_waitcnt vmcnt(10) lgkmcnt(0)
    s_setprio 3
    v_cmp_lt_u32 vcc, 0xffff, v13
    s_setprio 0
    s_cbranch_vccnz B_CUT
    s_add_u32 s66, s97, 1024
    s_sub_u32 s67, s66, 28672
    s_min_u32 s66, s66, s67
    s_lshl_b32 s66, s66, 6
    buffer_load_dwordx4 v[56:59], v6, s[28:31], s66 offen offset:0
    buffer_load_dwordx4 v[60:63], v7, s[28:31], s66 offen offset:1024
    ds_read_b32 v13, v14
    s_mov_b32 s70, 2
    s_waitcnt vmcnt(10) lgkmcnt(0)
    s_setprio 3
    v_cmp_lt_u32 vcc, 0xffff, v13
    s_setprio 0
    s_cbranch_vccnz B_CUT
    s_add_u32 s66, s97, 2048
    s_sub_u32 s67, s66, 28672
    s_min_u32 s66, s66, s67
    s_lshl_b32 s66, s66, 6
    buffer_load_dwordx4 v[64:67], v6, s[28:31], s66 offen offset:0
    buffer_load_dwordx4 v[68:71], v7, s[28:31], s66 offen offset:1024
    ds_read_b32 v13, v14
    s_mov_b32 s70, 3
    s_waitcnt vmcnt(10) lgkmcnt(0)
    s_setprio 3
    v_cmp_lt_u32 vcc, 0xffff, v13
    s_setprio 0
    s_cbranch_vccnz B_CUT
    s_add_u32 s66, s97, 3072
    s_sub_u32 s67, s66, 28672
    s_min_u32 s66, s66, s67
    s_lshl_b32 s66, s66, 6
    buffer_load_dwordx4 v[72:75], v6, s[28:31], s66 offen offset:0
    buffer_load_dwordx4 v[76:79], v7, s[28:31], s66 offen offset:1024
    ds_read_b32 v13, v14
    s_mov_b32 s70, 4
    s_waitcnt vmcnt(10) lgkmcnt(0)
    s_setprio 3
    v_cmp_lt_u32 vcc, 0xffff, v13
    s_setprio 0
    s_cbranch_vccnz B_CUT
    s_add_u32 s66, s97, 4096
    s_sub_u32 s67, s66, 28672
    s_min_u32 s66, s66, s67
    s_lshl_b32 s66, s66, 6
    buffer_load_dwordx4 v[80:83], v6, s[28:31], s66 offen offset:0
    buffer_load_dwordx4 v[84:87], v7, s[28:31], s66 offen offset:1024
    ds_read_b32 v13, v14
    s_mov_b32 s70, 5
    s_waitcnt vmcnt(10) lgkmcnt(0)
    s_setprio 3
    v_cmp_lt_u32 vcc, 0xffff, v13
    s_setprio 0
    s_cbranch_vccnz B_CUT
    s_add_u32 s66, s97, 5120
    s_sub_u32 s67, s66, 28672
    s_min_u32 s66, s66, s67
    s_lshl_b32 s66, s66, 6
    buffer_load_dwordx4 v[88:91], v6, s[28:31], s66 offen offset:0
    buffer_load_dwordx4 v[92:95], v7, s[28:31], s66 offen offset:1024
    s_mov_b32 s70, 6
B_CUT:
    s_setprio 3
    v_min_u32 v12, 5, v1
    v_lshlrev_b32 v12, 12, v12
    v_add_u32 v12, 118276, v12
    s_setprio 0
B_RED:
    s_barrier
    ds_read_b32 v13, v12
    s_waitcnt lgkmcnt(0)
    v_cmp_ne_u32 vcc, 0, v13
    s_cbranch_vccz B_OK
    s_cmp_lg_u32 s71, 0
    s_cbranch_scc1 B_OK
    s_mov_b32 s71, -1
    s_barrier
    s_barrier
    s_barrier
    s_branch B_RED
B_OK:
    s_waitcnt vmcnt(0)
    s_barrier
    ds_write_b128 v11, v[16:19] offset:0
    ds_write_b128 v11, v[20:23] offset:1024
    ds_write_b128 v11, v[24:27] offset:2048
    ds_write_b128 v11, v[28:31] offset:3072
    ds_write_b128 v11, v[32:35] offset:4096
    ds_write_b128 v11, v[36:39] offset:5120
    ds_write_b128 v11, v[40:43] offset:6144
    ds_write_b128 v11, v[44:47] offset:7168
    s_cmp_gt_u32 s70, 0
    s_cbranch_scc1 B_SK0
    s_add_u32 s66, s97, 0
    s_sub_u32 s67, s66, 28672
    s_min_u32 s66, s66, s67
    s_lshl_b32 s66, s66, 6
    buffer_load_dwordx4 v[48:51], v6, s[28:31], s66 offen offset:0
    buffer_load_dwordx4 v[52:55], v7, s[28:31], s66 offen offset:1024
B_SK0:
    s_cmp_gt_u32 s70, 1
    s_cbranch_scc1 B_SK1
    s_add_u32 s66, s97, 1024
    s_sub_u32 s67, s66, 28672
    s_min_u32 s66, s66, s67
    s_lshl_b32 s66, s66, 6
    buffer_load_dwordx4 v[56:59], v6, s[28:31], s66 offen offset:0
    buffer_load_dwordx4 v[60:63], v7, s[28:31], s66 offen offset:1024
B_SK1:
    s_cmp_gt_u32 s70, 2
    s_cbranch_scc1 B_SK2
    s_add_u32 s66, s97, 2048
    s_sub_u32 s67, s66, 28672
    s_min_u32 s66, s66, s67
    s_lshl_b32 s66, s66, 6
    buffer_load_dwordx4 v[64:67], v6, s[28:31], s66 offen offset:0
    buffer_load_dwordx4 v[68:71], v7, s[28:31], s66 offen offset:1024
B_SK2:
    s_cmp_gt_u32 s70, 3
    s_cbranch_scc1 B_SK3
    s_add_u32 s66, s97, 3072
    s_sub_u32 s67, s66, 28672
    s_min_u32 s66, s66, s67
    s_lshl_b32 s66, s66, 6
    buffer_load_dwordx4 v[72:75], v6, s[28:31], s66 offen offset:0
    buffer_load_dwordx4 v[76:79], v7, s[28:31], s66 offen offset:1024
B_SK3:
    s_cmp_gt_u32 s70, 4
    s_cbranch_scc1 B_SK4
    s_add_u32 s66, s97, 4096
    s_sub_u32 s67, s66, 28672
    s_min_u32 s66, s66, s67
    s_lshl_b32 s66, s66, 6
    buffer_load_dwordx4 v[80:83], v6, s[28:31], s66 offen offset:0
    buffer_load_dwordx4 v[84:87], v7, s[28:31], s66 offen offset:1024
B_SK4:
    s_cmp_gt_u32 s70, 5
    s_cbranch_scc1 B_SK5
    s_add_u32 s66, s97, 5120
    s_sub_u32 s67, s66, 28672
    s_min_u32 s66, s66, s67
    s_lshl_b32 s66, s66, 6
    buffer_load_dwordx4 v[88:91], v6, s[28:31], s66 offen offset:0
    buffer_load_dwordx4 v[92:95], v7, s[28:31], s66 offen offset:1024
B_SK5:
    s_waitcnt lgkmcnt(0)
    s_barrier
    s_and_b32 s63, s48, 1
    s_lshl_b32 s63, s63, 5
    v_xor_b32 v0, s63, v0
    v_xor_b32 v3, s63, v3
    s_lshl_b32 s63, s48, 15
    s_add_u32 s63, s63, 0
    s_lshl_b32 s67, s53, 18
    s_add_u32 s67, s67, s63
    v_add_u32 v4, s67, v2
    s_add_u32 s63, s96, 12288
    v_lshl_add_u32 v8, v1, 11, s63
    v_and_b32 v8, 0x7fff, v8
    s_add_u32 s63, s67, 2044
    v_add_u32 v8, s63, v8
    s_mul_i32 s63, s48, 28672
    s_add_u32 s63, s63, 2097152
    s_mul_i32 s67, s55, 229376
    s_add_u32 s67, s67, s63
    s_and_b32 s63, s48, 1
    s_lshl_b32 s63, s63, 8
    v_xor_b32 v5, s63, v2
    v_add_u32 v5, s67, v5
    s_add_u32 s63, s97, 12288
    v_min_u32 v12, 7, v1
    v_lshl_add_u32 v9, v12, 11, s63
    v_subrev_u32 v12, 28672, v9
    v_min_u32 v9, v9, v12
    s_add_u32 s63, s67, 2044
    v_add_u32 v9, s63, v9
    s_waitcnt vmcnt(0)
    s_barrier
    s_cmp_ge_u32 s51, 28
    s_cbranch_scc1 B_ND
    ds_write_b128 v10, v[48:51] offset:0
    ds_write_b128 v10, v[52:55] offset:1024
    s_add_u32 s66, s97, 13312
    s_sub_u32 s67, s66, 28672
    s_min_u32 s66, s66, s67
    s_lshl_b32 s66, s66, 6
    s_add_u32 m0, s95, 12288
    s_nop 0
    buffer_load_dwordx4 v6, s[28:31], s66 offen offset:0 lds
    buffer_load_dwordx4 v7, s[28:31], s66 offen offset:1024 lds
    ds_write_b128 v10, v[56:59] offset:2048
    ds_write_b128 v10, v[60:63] offset:3072
    s_add_u32 s66, s97, 14336
    s_sub_u32 s67, s66, 28672
    s_min_u32 s66, s66, s67
    s_lshl_b32 s66, s66, 6
    s_add_u32 m0, s95, 14336
    s_nop 0
    buffer_load_dwordx4 v6, s[28:31], s66 offen offset:0 lds
    buffer_load_dwordx4 v7, s[28:31], s66 offen offset:1024 lds
    ds_write_b128 v10, v[64:67] offset:4096
    ds_write_b128 v10, v[68:71] offset:5120
    s_add_u32 s66, s97, 15360
    s_sub_u32 s67, s66, 28672
    s_min_u32 s66, s66, s67
    s_lshl_b32 s66, s66, 6
    s_add_u32 m0, s95, 16384
    s_nop 0
    buffer_load_dwordx4 v6, s[28:31], s66 offen offset:0 lds
    buffer_load_dwordx4 v7, s[28:31], s66 offen offset:1024 lds
    ds_write_b128 v10, v[72:75] offset:6144
    ds_write_b128 v10, v[76:79] offset:7168
    s_add_u32 s66, s97, 16384
    s_sub_u32 s67, s66, 28672
    s_min_u32 s66, s66, s67
    s_lshl_b32 s66, s66, 6
    s_add_u32 m0, s95, 18432
    s_nop 0
    buffer_load_dwordx4 v6, s[28:31], s66 offen offset:0 lds
    buffer_load_dwordx4 v7, s[28:31], s66 offen offset:1024 lds
    ds_write_b128 v10, v[80:83] offset:8192
    ds_write_b128 v10, v[84:87] offset:9216
    s_add_u32 s66, s97, 17408
    s_sub_u32 s67, s66, 28672
    s_min_u32 s66, s66, s67
    s_lshl_b32 s66, s66, 6
    s_add_u32 m0, s95, 20480
    s_nop 0
    buffer_load_dwordx4 v6, s[28:31], s66 offen offset:0 lds
    buffer_load_dwordx4 v7, s[28:31], s66 offen offset:1024 lds
    ds_write_b128 v10, v[88:91] offset:10240
    ds_write_b128 v10, v[92:95] offset:11264
    s_add_u32 s66, s97, 18432
    s_sub_u32 s67, s66, 28672
    s_min_u32 s66, s66, s67
    s_lshl_b32 s66, s66, 6
    s_add_u32 m0, s95, 22528
    s_nop 0
    buffer_load_dwordx4 v6, s[28:31], s66 offen offset:0 lds
    buffer_load_dwordx4 v7, s[28:31], s66 offen offset:1024 lds
B_ND:
    s_waitcnt lgkmcnt(0)
    s_barrier
    s_cmp_lg_u32 s56, 0
    s_cbranch_scc1 P4_GOB
    s_cmp_ge_u32 s51, 28
    s_cbranch_scc1 MLP_ENDB
    s_waitcnt lgkmcnt(0)
    s_barrier
    ds_read_b64_tr_b16 v[96:97], v0 offset:24576
    ds_read_b64_tr_b16 v[98:99], v0 offset:25600
    ds_read_b64_tr_b16 v[100:101], v3 offset:24576
    ds_read_b64_tr_b16 v[102:103], v3 offset:25600
    s_waitcnt vmcnt(10)
    ds_read_b64_tr_b16 v[104:105], v0 offset:12288
    ds_read_b64_tr_b16 v[106:107], v0 offset:13312
    ds_read_b64_tr_b16 v[108:109], v3 offset:12288
    ds_read_b64_tr_b16 v[110:111], v3 offset:13312
    s_waitcnt vmcnt(8)
    ds_read_b64_tr_b16 v[112:113], v0 offset:14336
    ds_read_b64_tr_b16 v[114:115], v0 offset:15360
    ds_read_b64_tr_b16 v[116:117], v3 offset:14336
    ds_read_b64_tr_b16 v[118:119], v3 offset:15360
    s_waitcnt vmcnt(6)
    ds_read_b64_tr_b16 v[120:121], v0 offset:16384
    ds_read_b64_tr_b16 v[122:123], v0 offset:17408
    ds_read_b64_tr_b16 v[124:125], v3 offset:16384
    ds_read_b64_tr_b16 v[126:127], v3 offset:17408
    s_waitcnt vmcnt(4)
    ds_read_b64_tr_b16 v[128:129], v0 offset:18432
    ds_read_b64_tr_b16 v[130:131], v0 offset:19456
    ds_read_b64_tr_b16 v[132:133], v3 offset:18432
    ds_read_b64_tr_b16 v[134:135], v3 offset:19456
    s_waitcnt vmcnt(2)
    ds_read_b64_tr_b16 v[136:137], v0 offset:20480
    ds_read_b64_tr_b16 v[138:139], v0 offset:21504
    ds_read_b64_tr_b16 v[140:141], v3 offset:20480
    ds_read_b64_tr_b16 v[142:143], v3 offset:21504
    s_waitcnt vmcnt(0)
    ds_read_b64_tr_b16 v[144:145], v0 offset:22528
    ds_read_b64_tr_b16 v[146:147], v0 offset:23552
    ds_read_b64_tr_b16 v[148:149], v3 offset:22528
    ds_read_b64_tr_b16 v[150:151], v3 offset:23552
    s_waitcnt lgkmcnt(0)
    s_add_u32 s66, s97, 19456
    s_sub_u32 s67, s66, 28672
    s_min_u32 s66, s66, s67
    s_lshl_b32 s66, s66, 6
    s_add_u32 m0, s95, 24576
    s_nop 0
    buffer_load_dwordx4 v6, s[28:31], s66 offen offset:0 lds
    buffer_load_dwordx4 v7, s[28:31], s66 offen offset:1024 lds
    s_add_u32 s66, s97, 20480
    s_sub_u32 s67, s66, 28672
    s_min_u32 s66, s66, s67
    s_lshl_b32 s66, s66, 6
    s_add_u32 m0, s95, 12288
    s_nop 0
    buffer_load_dwordx4 v6, s[28:31], s66 offen offset:0 lds
    buffer_load_dwordx4 v7, s[28:31], s66 offen offset:1024 lds
    s_add_u32 s66, s97, 21504
    s_sub_u32 s67, s66, 28672
    s_min_u32 s66, s66, s67
    s_lshl_b32 s66, s66, 6
    s_add_u32 m0, s95, 14336
    s_nop 0
    buffer_load_dwordx4 v6, s[28:31], s66 offen offset:0 lds
    buffer_load_dwordx4 v7, s[28:31], s66 offen offset:1024 lds
    s_add_u32 s66, s97, 22528
    s_sub_u32 s67, s66, 28672
    s_min_u32 s66, s66, s67
    s_lshl_b32 s66, s66, 6
    s_add_u32 m0, s95, 16384
    s_nop 0
    buffer_load_dwordx4 v6, s[28:31], s66 offen offset:0 lds
    buffer_load_dwordx4 v7, s[28:31], s66 offen offset:1024 lds
    s_add_u32 s66, s97, 23552
    s_sub_u32 s67, s66, 28672
    s_min_u32 s66, s66, s67
    s_lshl_b32 s66, s66, 6
    s_add_u32 m0, s95, 18432
    s_nop 0
    buffer_load_dwordx4 v6, s[28:31], s66 offen offset:0 lds
    buffer_load_dwordx4 v7, s[28:31], s66 offen offset:1024 lds
    s_add_u32 s66, s97, 24576
    s_sub_u32 s67, s66, 28672
    s_min_u32 s66, s66, s67
    s_lshl_b32 s66, s66, 6
    s_add_u32 m0, s95, 20480
    s_nop 0
    buffer_load_dwordx4 v6, s[28:31], s66 offen offset:0 lds
    buffer_load_dwordx4 v7, s[28:31], s66 offen offset:1024 lds
    s_add_u32 s66, s97, 25600
    s_sub_u32 s67, s66, 28672
    s_min_u32 s66, s66, s67
    s_lshl_b32 s66, s66, 6
    s_add_u32 m0, s95, 22528
    s_nop 0
    buffer_load_dwordx4 v6, s[28:31], s66 offen offset:0 lds
    buffer_load_dwordx4 v7, s[28:31], s66 offen offset:1024 lds
    s_mov_b32 s6, 0x0000ffff
    s_and_b32 s63, s6, 0x00000003
    s_cbranch_scc1 SIBg0_h
SIBg0_r:
    s_and_b32 s63, s6, 0x0000000c
    s_cbranch_scc1 SIBg1_h
SIBg1_r:
    s_and_b32 s63, s6, 0x00000030
    s_cbranch_scc1 SIBg2_h
SIBg2_r:
    s_and_b32 s63, s6, 0x000000c0
    s_cbranch_scc1 SIBg3_h
SIBg3_r:
    s_add_u32 s63, s97, 12288
    s_sub_u32 s64, s63, 28672
    s_min_u32 s63, s63, s64
    buffer_load_dwordx4 v[64:67], v5, s[44:47], s63 offen offset:0 sc1
    buffer_load_dwordx4 v[68:71], v5, s[44:47], s63 offen offset:1024 sc1
    buffer_load_dwordx4 v[72:75], v5, s[44:47], s63 offen offset:2048 sc1
    buffer_load_dwordx4 v[76:79], v5, s[44:47], s63 offen offset:3072 sc1
    s_add_u32 s63, s97, 16384
    s_sub_u32 s64, s63, 28672
    s_min_u32 s63, s63, s64
    buffer_load_dwordx4 v[80:83], v5, s[44:47], s63 offen offset:0 sc1
    buffer_load_dwordx4 v[84:87], v5, s[44:47], s63 offen offset:1024 sc1
    buffer_load_dwordx4 v[88:91], v5, s[44:47], s63 offen offset:2048 sc1
    buffer_load_dwordx4 v[92:95], v5, s[44:47], s63 offen offset:3072 sc1
    s_add_u32 s63, s97, 20480
    s_sub_u32 s64, s63, 28672
    s_min_u32 s63, s63, s64
    buffer_load_dwordx4 v[48:51], v5, s[44:47], s63 offen offset:0 sc1
    buffer_load_dwordx4 v[52:55], v5, s[44:47], s63 offen offset:1024 sc1
    buffer_load_dwordx4 v[56:59], v5, s[44:47], s63 offen offset:2048 sc1
    buffer_load_dwordx4 v[60:63], v5, s[44:47], s63 offen offset:3072 sc1
    s_branch P5_INB
P4_GOB:
    s_mov_b32 s6, 0x0000ffff
    s_mov_b32 s65, 0x10000
    s_mov_b32 s6, 0x000fffff
    s_cmp_lt_u32 s0, 14
    s_cselect_b32 s6, 0, s6
    s_and_b32 s63, s6, 0x00000003
    s_cbranch_scc1 SHBg0_h
SHBg0_r:
    s_add_u32 s63, s96, 12288
    s_and_b32 s63, s63, 0x7fff
    buffer_load_dwordx4 v[48:51], v4, s[44:47], s63 offen offset:0 sc1
    buffer_load_dwordx4 v[52:55], v4, s[44:47], s63 offen offset:1024 sc1
    buffer_load_dwordx4 v[56:59], v4, s[44:47], s63 offen offset:2048 sc1
    buffer_load_dwordx4 v[60:63], v4, s[44:47], s63 offen offset:3072 sc1
    s_and_b32 s63, s6, 0x0000000c
    s_cbranch_scc1 SHBg1_h
SHBg1_r:
    s_add_u32 s63, s96, 16384
    s_and_b32 s63, s63, 0x7fff
    buffer_load_dwordx4 v[64:67], v4, s[44:47], s63 offen offset:0 sc1
    buffer_load_dwordx4 v[68:71], v4, s[44:47], s63 offen offset:1024 sc1
    buffer_load_dwordx4 v[72:75], v4, s[44:47], s63 offen offset:2048 sc1
    buffer_load_dwordx4 v[76:79], v4, s[44:47], s63 offen offset:3072 sc1
    s_and_b32 s63, s6, 0x00000030
    s_cbranch_scc1 SHBg2_h
SHBg2_r:
    s_add_u32 s63, s96, 20480
    s_and_b32 s63, s63, 0x7fff
    buffer_load_dwordx4 v[80:83], v4, s[44:47], s63 offen offset:0 sc1
    buffer_load_dwordx4 v[84:87], v4, s[44:47], s63 offen offset:1024 sc1
    buffer_load_dwordx4 v[88:91], v4, s[44:47], s63 offen offset:2048 sc1
    buffer_load_dwordx4 v[92:95], v4, s[44:47], s63 offen offset:3072 sc1
    s_waitcnt vmcnt(8)
    v_bitop3_b32 v12, v51, v55, v59 bitop3:0x80
    v_bitop3_b32 v12, v12, v63, s65 bitop3:0x80
    v_cmp_eq_u32 vcc, 0, v12
    s_cbranch_vccnz SHB0_h
SHB0_r:
    s_setprio 1
    v_mfma_f32_32x32x16_bf16 v[16:31], v[96:99], v[48:51], 0
    v_mfma_f32_32x32x16_bf16 v[32:47], v[100:103], v[48:51], 0
    v_mfma_f32_32x32x16_bf16 v[16:31], v[104:107], v[52:55], v[16:31]
    v_mfma_f32_32x32x16_bf16 v[32:47], v[108:111], v[52:55], v[32:47]
    v_mfma_f32_32x32x16_bf16 v[16:31], v[112:115], v[56:59], v[16:31]
    v_mfma_f32_32x32x16_bf16 v[32:47], v[116:119], v[56:59], v[32:47]
    s_waitcnt vmcnt(4)
    v_bitop3_b32 v12, v67, v71, v75 bitop3:0x80
    v_bitop3_b32 v12, v12, v79, s65 bitop3:0x80
    v_mfma_f32_32x32x16_bf16 v[16:31], v[120:123], v[60:63], v[16:31]
    v_cmp_eq_u32 vcc, 0, v12
    s_cbranch_vccnz SHB1_h
SHB1_r:
    v_mfma_f32_32x32x16_bf16 v[32:47], v[124:127], v[60:63], v[32:47]
    v_mfma_f32_32x32x16_bf16 v[16:31], v[128:131], v[64:67], v[16:31]
    s_and_b32 s63, s6, 0x000000c0
    s_cbranch_scc1 SHBg3_h
SHBg3_r:
    s_add_u32 s63, s96, 24576
    s_and_b32 s63, s63, 0x7fff
    buffer_load_dwordx4 v[48:51], v4, s[44:47], s63 offen offset:0 sc1
    v_mfma_f32_32x32x16_bf16 v[32:47], v[132:135], v[64:67], v[32:47]
    buffer_load_dwordx4 v[52:55], v4, s[44:47], s63 offen offset:1024 sc1
    v_mfma_f32_32x32x16_bf16 v[16:31], v[136:139], v[68:71], v[16:31]
    buffer_load_dwordx4 v[56:59], v4, s[44:47], s63 offen offset:2048 sc1
    v_mfma_f32_32x32x16_bf16 v[32:47], v[140:143], v[68:71], v[32:47]
    buffer_load_dwordx4 v[60:63], v4, s[44:47], s63 offen offset:3072 sc1
    v_mfma_f32_32x32x16_bf16 v[16:31], v[144:147], v[72:75], v[16:31]
    v_mfma_f32_32x32x16_bf16 v[32:47], v[148:151], v[72:75], v[32:47]
    s_waitcnt vmcnt(4)
    v_bitop3_b32 v12, v83, v87, v91 bitop3:0x80
    v_bitop3_b32 v12, v12, v95, s65 bitop3:0x80
    v_mfma_f32_32x32x16_bf16 v[16:31], v[152:155], v[76:79], v[16:31]
    v_cmp_eq_u32 vcc, 0, v12
    s_cbranch_vccnz SHB2_h
SHB2_r:
    v_mfma_f32_32x32x16_bf16 v[32:47], v[156:159], v[76:79], v[32:47]
    v_mfma_f32_32x32x16_bf16 v[16:31], v[160:163], v[80:83], v[16:31]
    s_and_b32 s63, s6, 0x00000300
    s_cbranch_scc1 SHBg4_h
SHBg4_r:
    s_add_u32 s63, s96, 28672
    s_and_b32 s63, s63, 0x7fff
    buffer_load_dwordx4 v[64:67], v4, s[44:47], s63 offen offset:0 sc1
    v_mfma_f32_32x32x16_bf16 v[32:47], v[164:167], v[80:83], v[32:47]
    buffer_load_dwordx4 v[68:71], v4, s[44:47], s63 offen offset:1024 sc1
    v_mfma_f32_32x32x16_bf16 v[16:31], v[168:171], v[84:87], v[16:31]
    buffer_load_dwordx4 v[72:75], v4, s[44:47], s63 offen offset:2048 sc1
    v_mfma_f32_32x32x16_bf16 v[32:47], v[172:175], v[84:87], v[32:47]
    buffer_load_dwordx4 v[76:79], v4, s[44:47], s63 offen offset:3072 sc1
    v_mfma_f32_32x32x16_bf16 v[16:31], v[176:179], v[88:91], v[16:31]
    v_mfma_f32_32x32x16_bf16 v[32:47], v[180:183], v[88:91], v[32:47]
    s_waitcnt vmcnt(4)
    v_bitop3_b32 v12, v51, v55, v59 bitop3:0x80
    v_bitop3_b32 v12, v12, v63, s65 bitop3:0x80
    v_mfma_f32_32x32x16_bf16 v[16:31], v[184:187], v[92:95], v[16:31]
    v_cmp_eq_u32 vcc, 0, v12
    s_cbranch_vccnz SHB3_h
SHB3_r:
    v_mfma_f32_32x32x16_bf16 v[32:47], v[188:191], v[92:95], v[32:47]
    v_mfma_f32_32x32x16_bf16 v[16:31], v[192:195], v[48:51], v[16:31]
    s_add_u32 s63, s96, 12288
    s_and_b32 s63, s63, 0x7fff
    s_bitset1_b32 s63, 17
    buffer_load_dwordx4 v[80:83], v4, s[44:47], s63 offen offset:0 sc1
    v_mfma_f32_32x32x16_bf16 v[32:47], v[196:199], v[48:51], v[32:47]
    buffer_load_dwordx4 v[84:87], v4, s[44:47], s63 offen offset:1024 sc1
    v_mfma_f32_32x32x16_bf16 v[16:31], v[200:203], v[52:55], v[16:31]
    buffer_load_dwordx4 v[88:91], v4, s[44:47], s63 offen offset:2048 sc1
    v_mfma_f32_32x32x16_bf16 v[32:47], v[204:207], v[52:55], v[32:47]
    buffer_load_dwordx4 v[92:95], v4, s[44:47], s63 offen offset:3072 sc1
    v_mfma_f32_32x32x16_bf16 v[16:31], v[208:211], v[56:59], v[16:31]
    v_mfma_f32_32x32x16_bf16 v[32:47], v[212:215], v[56:59], v[32:47]
    s_waitcnt vmcnt(4)
    v_bitop3_b32 v12, v67, v71, v75 bitop3:0x80
    v_bitop3_b32 v12, v12, v79, s65 bitop3:0x80
    v_mfma_f32_32x32x16_bf16 v[16:31], v[216:219], v[60:63], v[16:31]
    v_cmp_eq_u32 vcc, 0, v12
    s_cbranch_vccnz SHB4_h
SHB4_r:
    v_mfma_f32_32x32x16_bf16 v[32:47], v[220:223], v[60:63], v[32:47]
    v_mfma_f32_32x32x16_bf16 v[32:47], v[228:231], v[64:67], v[32:47]
    s_add_u32 s63, s96, 16384
    s_and_b32 s63, s63, 0x7fff
    s_bitset1_b32 s63, 17
    buffer_load_dwordx4 v[48:51], v4, s[44:47], s63 offen offset:0 sc1
    v_mfma_f32_32x32x16_bf16 v[32:47], v[236:239], v[68:71], v[32:47]
    buffer_load_dwordx4 v[52:55], v4, s[44:47], s63 offen offset:1024 sc1
    v_mfma_f32_32x32x16_bf16 v[32:47], v[244:247], v[72:75], v[32:47]
    buffer_load_dwordx4 v[56:59], v4, s[44:47], s63 offen offset:2048 sc1
    v_mfma_f32_32x32x16_bf16 v[32:47], v[252:255], v[76:79], v[32:47]
    buffer_load_dwordx4 v[60:63], v4, s[44:47], s63 offen offset:3072 sc1
    v_mfma_f32_32x32x16_bf16 v[16:31], v[224:227], v[64:67], v[16:31]
    s_nop 9
    ds_write_b128 v11, v[32:35] offset:10240
    v_mfma_f32_32x32x16_bf16 v[16:31], v[232:235], v[68:71], v[16:31]
    ds_write_b128 v11, v[36:39] offset:11264
    s_waitcnt vmcnt(4)
    v_bitop3_b32 v12, v83, v87, v91 bitop3:0x80
    v_bitop3_b32 v12, v12, v95, s65 bitop3:0x80
    v_mfma_f32_32x32x16_bf16 v[16:31], v[240:243], v[72:75], v[16:31]
    ds_write_b128 v10, v[40:43] offset:26624
    v_cmp_eq_u32 vcc, 0, v12
    s_cbranch_vccnz SHB5_h
SHB5_r:
    v_mfma_f32_32x32x16_bf16 v[16:31], v[248:251], v[76:79], v[16:31]
    ds_write_b128 v10, v[44:47] offset:27648
    v_mfma_f32_32x32x16_bf16 v[32:47], v[100:103], v[80:83], 0
    s_nop 9
    ds_write_b128 v11, v[16:19] offset:6144
    s_add_u32 s63, s96, 20480
    s_and_b32 s63, s63, 0x7fff
    s_bitset1_b32 s63, 17
    buffer_load_dwordx4 v[64:67], v4, s[44:47], s63 offen offset:0 sc1
    v_mfma_f32_32x32x16_bf16 v[32:47], v[108:111], v[84:87], v[32:47]
    ds_write_b128 v11, v[20:23] offset:7168
    buffer_load_dwordx4 v[68:71], v4, s[44:47], s63 offen offset:1024 sc1
    v_mfma_f32_32x32x16_bf16 v[32:47], v[116:119], v[88:91], v[32:47]
    ds_write_b128 v11, v[24:27] offset:8192
    buffer_load_dwordx4 v[72:75], v4, s[44:47], s63 offen offset:2048 sc1
    v_mfma_f32_32x32x16_bf16 v[32:47], v[124:127], v[92:95], v[32:47]
    ds_write_b128 v11, v[28:31] offset:9216
    buffer_load_dwordx4 v[76:79], v4, s[44:47], s63 offen offset:3072 sc1
    s_waitcnt lgkmcnt(0)
    s_barrier
    v_mfma_f32_32x32x16_bf16 v[16:31], v[96:99], v[80:83], 0
    ds_read_b64_tr_b16 v[96:97], v0 offset:24576
    ds_read_b64_tr_b16 v[98:99], v0 offset:25600
    ds_read_b64_tr_b16 v[100:101], v3 offset:24576
    ds_read_b64_tr_b16 v[102:103], v3 offset:25600
    v_mfma_f32_32x32x16_bf16 v[16:31], v[104:107], v[84:87], v[16:31]
    s_waitcnt vmcnt(4)
    v_bitop3_b32 v12, v51, v55, v59 bitop3:0x80
    v_bitop3_b32 v12, v12, v63, s65 bitop3:0x80
    ds_read_b64_tr_b16 v[104:105], v0 offset:12288
    ds_read_b64_tr_b16 v[106:107], v0 offset:13312
    ds_read_b64_tr_b16 v[108:109], v3 offset:12288
    ds_read_b64_tr_b16 v[110:111], v3 offset:13312
    v_mfma_f32_32x32x16_bf16 v[16:31], v[112:115], v[88:91], v[16:31]
    v_cmp_eq_u32 vcc, 0, v12
    s_cbranch_vccnz SHB6_h
SHB6_r:
    ds_read_b64_tr_b16 v[112:113], v0 offset:14336
    ds_read_b64_tr_b16 v[114:115], v0 offset:15360
    ds_read_b64_tr_b16 v[116:117], v3 offset:14336
    ds_read_b64_tr_b16 v[118:119], v3 offset:15360
    v_mfma_f32_32x32x16_bf16 v[16:31], v[120:123], v[92:95], v[16:31]
    ds_read_b64_tr_b16 v[120:121], v0 offset:16384
    ds_read_b64_tr_b16 v[122:123], v0 offset:17408
    ds_read_b64_tr_b16 v[124:125], v3 offset:16384
    ds_read_b64_tr_b16 v[126:127], v3 offset:17408
    v_mfma_f32_32x32x16_bf16 v[16:31], v[128:131], v[48:51], v[16:31]
    s_add_u32 s63, s96, 24576
    s_and_b32 s63, s63, 0x7fff
    s_bitset1_b32 s63, 17
    buffer_load_dwordx4 v[80:83], v4, s[44:47], s63 offen offset:0 sc1
    v_mfma_f32_32x32x16_bf16 v[32:47], v[132:135], v[48:51], v[32:47]
    buffer_load_dwordx4 v[84:87], v4, s[44:47], s63 offen offset:1024 sc1
    ds_read_b64_tr_b16 v[128:129], v0 offset:18432
    ds_read_b64_tr_b16 v[130:131], v0 offset:19456
    ds_read_b64_tr_b16 v[132:133], v3 offset:18432
    ds_read_b64_tr_b16 v[134:135], v3 offset:19456
    s_waitcnt lgkmcnt(15)
    s_add_u32 s66, s97, 19456
    s_sub_u32 s67, s66, 28672
    s_min_u32 s66, s66, s67
    s_lshl_b32 s66, s66, 6
    s_add_u32 m0, s95, 24576
    s_nop 0
    buffer_load_dwordx4 v6, s[28:31], s66 offen offset:0 lds
    buffer_load_dwordx4 v7, s[28:31], s66 offen offset:1024 lds
    v_mfma_f32_32x32x16_bf16 v[16:31], v[136:139], v[52:55], v[16:31]
    buffer_load_dwordx4 v[88:91], v4, s[44:47], s63 offen offset:2048 sc1
    v_mfma_f32_32x32x16_bf16 v[32:47], v[140:143], v[52:55], v[32:47]
    buffer_load_dwordx4 v[92:95], v4, s[44:47], s63 offen offset:3072 sc1
    ds_read_b64_tr_b16 v[136:137], v0 offset:20480
    ds_read_b64_tr_b16 v[138:139], v0 offset:21504
    ds_read_b64_tr_b16 v[140:141], v3 offset:20480
    ds_read_b64_tr_b16 v[142:143], v3 offset:21504
    s_waitcnt lgkmcnt(15)
    s_add_u32 s66, s97, 20480
    s_sub_u32 s67, s66, 28672
    s_min_u32 s66, s66, s67
    s_lshl_b32 s66, s66, 6
    s_add_u32 m0, s95, 12288
    s_nop 0
    buffer_load_dwordx4 v6, s[28:31], s66 offen offset:0 lds
    buffer_load_dwordx4 v7, s[28:31], s66 offen offset:1024 lds
    v_mfma_f32_32x32x16_bf16 v[16:31], v[144:147], v[56:59], v[16:31]
    v_mfma_f32_32x32x16_bf16 v[32:47], v[148:151], v[56:59], v[32:47]
    s_waitcnt vmcnt(8)
    v_bitop3_b32 v12, v67, v71, v75 bitop3:0x80
    v_bitop3_b32 v12, v12, v79, s65 bitop3:0x80
    ds_read_b64_tr_b16 v[144:145], v0 offset:22528
    ds_read_b64_tr_b16 v[146:147], v0 offset:23552
    ds_read_b64_tr_b16 v[148:149], v3 offset:22528
    ds_read_b64_tr_b16 v[150:151], v3 offset:23552
    s_waitcnt lgkmcnt(15)
    s_add_u32 s66, s97, 21504
    s_sub_u32 s67, s66, 28672
    s_min_u32 s66, s66, s67
    s_lshl_b32 s66, s66, 6
    s_add_u32 m0, s95, 14336
    s_nop 0
    buffer_load_dwordx4 v6, s[28:31], s66 offen offset:0 lds
    buffer_load_dwordx4 v7, s[28:31], s66 offen offset:1024 lds
    v_mfma_f32_32x32x16_bf16 v[16:31], v[152:155], v[60:63], v[16:31]
    v_cmp_eq_u32 vcc, 0, v12
    s_cbranch_vccnz SHB7_h
SHB7_r:
    v_mfma_f32_32x32x16_bf16 v[32:47], v[156:159], v[60:63], v[32:47]
    s_waitcnt lgkmcnt(12)
    s_add_u32 s66, s97, 22528
    s_sub_u32 s67, s66, 28672
    s_min_u32 s66, s66, s67
    s_lshl_b32 s66, s66, 6
    s_add_u32 m0, s95, 16384
    s_nop 0
    buffer_load_dwordx4 v6, s[28:31], s66 offen offset:0 lds
    buffer_load_dwordx4 v7, s[28:31], s66 offen offset:1024 lds
    v_mfma_f32_32x32x16_bf16 v[16:31], v[160:163], v[64:67], v[16:31]
    s_add_u32 s63, s96, 28672
    s_and_b32 s63, s63, 0x7fff
    s_bitset1_b32 s63, 17
    buffer_load_dwordx4 v[48:51], v4, s[44:47], s63 offen offset:0 sc1
    v_mfma_f32_32x32x16_bf16 v[32:47], v[164:167], v[64:67], v[32:47]
    buffer_load_dwordx4 v[52:55], v4, s[44:47], s63 offen offset:1024 sc1
    s_waitcnt lgkmcnt(8)
    s_add_u32 s66, s97, 23552
    s_sub_u32 s67, s66, 28672
    s_min_u32 s66, s66, s67
    s_lshl_b32 s66, s66, 6
    s_add_u32 m0, s95, 18432
    s_nop 0
    buffer_load_dwordx4 v6, s[28:31], s66 offen offset:0 lds
    buffer_load_dwordx4 v7, s[28:31], s66 offen offset:1024 lds
    v_mfma_f32_32x32x16_bf16 v[16:31], v[168:171], v[68:71], v[16:31]
    buffer_load_dwordx4 v[56:59], v4, s[44:47], s63 offen offset:2048 sc1
    v_mfma_f32_32x32x16_bf16 v[32:47], v[172:175], v[68:71], v[32:47]
    buffer_load_dwordx4 v[60:63], v4, s[44:47], s63 offen offset:3072 sc1
    s_waitcnt lgkmcnt(4)
    s_add_u32 s66, s97, 24576
    s_sub_u32 s67, s66, 28672
    s_min_u32 s66, s66, s67
    s_lshl_b32 s66, s66, 6
    s_add_u32 m0, s95, 20480
    s_nop 0
    buffer_load_dwordx4 v6, s[28:31], s66 offen offset:0 lds
    buffer_load_dwordx4 v7, s[28:31], s66 offen offset:1024 lds
    v_mfma_f32_32x32x16_bf16 v[16:31], v[176:179], v[72:75], v[16:31]
    v_mfma_f32_32x32x16_bf16 v[32:47], v[180:183], v[72:75], v[32:47]
    s_waitcnt vmcnt(14)
    v_bitop3_b32 v12, v83, v87, v91 bitop3:0x80
    v_bitop3_b32 v12, v12, v95, s65 bitop3:0x80
    s_waitcnt lgkmcnt(0)
    s_add_u32 s66, s97, 25600
    s_sub_u32 s67, s66, 28672
    s_min_u32 s66, s66, s67
    s_lshl_b32 s66, s66, 6
    s_add_u32 m0, s95, 22528
    s_nop 0
    buffer_load_dwordx4 v6, s[28:31], s66 offen offset:0 lds
    buffer_load_dwordx4 v7, s[28:31], s66 offen offset:1024 lds
    v_mfma_f32_32x32x16_bf16 v[16:31], v[184:187], v[76:79], v[16:31]
    v_cmp_eq_u32 vcc, 0, v12
    s_cbranch_vccnz SHB8_h
SHB8_r:
    v_mfma_f32_32x32x16_bf16 v[32:47], v[188:191], v[76:79], v[32:47]
    s_barrier
    v_mfma_f32_32x32x16_bf16 v[16:31], v[192:195], v[80:83], v[16:31]
    v_mfma_f32_32x32x16_bf16 v[32:47], v[196:199], v[80:83], v[32:47]
    v_mfma_f32_32x32x16_bf16 v[16:31], v[200:203], v[84:87], v[16:31]
    v_mfma_f32_32x32x16_bf16 v[32:47], v[204:207], v[84:87], v[32:47]
    v_mfma_f32_32x32x16_bf16 v[16:31], v[208:211], v[88:91], v[16:31]
    v_mfma_f32_32x32x16_bf16 v[32:47], v[212:215], v[88:91], v[32:47]
    s_waitcnt vmcnt(4)
    v_bitop3_b32 v12, v51, v55, v59 bitop3:0x80
    v_bitop3_b32 v12, v12, v63, s65 bitop3:0x80
    v_mfma_f32_32x32x16_bf16 v[16:31], v[216:219], v[92:95], v[16:31]
    v_cmp_eq_u32 vcc, 0, v12
    s_cbranch_vccnz SHB9_h
SHB9_r:
    v_mfma_f32_32x32x16_bf16 v[32:47], v[220:223], v[92:95], v[32:47]
    v_mfma_f32_32x32x16_bf16 v[32:47], v[228:231], v[48:51], v[32:47]
    v_mfma_f32_32x32x16_bf16 v[32:47], v[236:239], v[52:55], v[32:47]
    v_mfma_f32_32x32x16_bf16 v[32:47], v[244:247], v[56:59], v[32:47]
    v_mfma_f32_32x32x16_bf16 v[32:47], v[252:255], v[60:63], v[32:47]
    v_mfma_f32_32x32x16_bf16 v[16:31], v[224:227], v[48:51], v[16:31]
    s_nop 10
    ds_write_b128 v11, v[32:35] offset:10240
    v_mfma_f32_32x32x16_bf16 v[16:31], v[232:235], v[52:55], v[16:31]
    ds_write_b128 v11, v[36:39] offset:11264
    v_mfma_f32_32x32x16_bf16 v[16:31], v[240:243], v[56:59], v[16:31]
    ds_write_b128 v10, v[40:43] offset:26624
    v_mfma_f32_32x32x16_bf16 v[16:31], v[248:251], v[60:63], v[16:31]
    ds_write_b128 v10, v[44:47] offset:27648
    s_nop 10
    ds_write_b128 v11, v[16:19] offset:6144
    ds_write_b128 v11, v[20:23] offset:7168
    ds_write_b128 v11, v[24:27] offset:8192
    ds_write_b128 v11, v[28:31] offset:9216
    s_waitcnt lgkmcnt(0)
    s_barrier
    s_add_u32 s63, s97, 12288
    s_sub_u32 s64, s63, 28672
    s_min_u32 s63, s63, s64
    buffer_load_dwordx4 v[64:67], v5, s[44:47], s63 offen offset:0 sc1
    buffer_load_dwordx4 v[68:71], v5, s[44:47], s63 offen offset:1024 sc1
    buffer_load_dwordx4 v[72:75], v5, s[44:47], s63 offen offset:2048 sc1
    buffer_load_dwordx4 v[76:79], v5, s[44:47], s63 offen offset:3072 sc1
    s_add_u32 s63, s97, 16384
    s_sub_u32 s64, s63, 28672
    s_min_u32 s63, s63, s64
    buffer_load_dwordx4 v[80:83], v5, s[44:47], s63 offen offset:0 sc1
    buffer_load_dwordx4 v[84:87], v5, s[44:47], s63 offen offset:1024 sc1
    buffer_load_dwordx4 v[88:91], v5, s[44:47], s63 offen offset:2048 sc1
    buffer_load_dwordx4 v[92:95], v5, s[44:47], s63 offen offset:3072 sc1
    s_add_u32 s63, s97, 20480
    s_sub_u32 s64, s63, 28672
    s_min_u32 s63, s63, s64
    buffer_load_dwordx4 v[48:51], v5, s[44:47], s63 offen offset:0 sc1
    buffer_load_dwordx4 v[52:55], v5, s[44:47], s63 offen offset:1024 sc1
    buffer_load_dwordx4 v[56:59], v5, s[44:47], s63 offen offset:2048 sc1
    buffer_load_dwordx4 v[60:63], v5, s[44:47], s63 offen offset:3072 sc1
P5_INB:
    s_waitcnt vmcnt(8)
    v_bitop3_b32 v12, v67, v71, v75 bitop3:0x80
    v_bitop3_b32 v12, v12, v79, 1 bitop3:0x80
    v_cmp_eq_u32 vcc, 0, v12
    s_cbranch_vccnz SGB0_h
SGB0_r:
    v_mfma_f32_32x32x16_bf16 v[16:31], v[64:67], v[96:99], 0
    v_mfma_f32_32x32x16_bf16 v[32:47], v[64:67], v[100:103], 0
    v_mfma_f32_32x32x16_bf16 v[16:31], v[68:71], v[104:107], v[16:31]
    v_mfma_f32_32x32x16_bf16 v[32:47], v[68:71], v[108:111], v[32:47]
    v_mfma_f32_32x32x16_bf16 v[16:31], v[72:75], v[112:115], v[16:31]
    v_mfma_f32_32x32x16_bf16 v[32:47], v[72:75], v[116:119], v[32:47]
    s_waitcnt vmcnt(4)
    v_bitop3_b32 v12, v83, v87, v91 bitop3:0x80
    v_bitop3_b32 v12, v12, v95, 1 bitop3:0x80
    v_mfma_f32_32x32x16_bf16 v[16:31], v[76:79], v[120:123], v[16:31]
    v_cmp_eq_u32 vcc, 0, v12
    s_cbranch_vccnz SGB1_h
SGB1_r:
    v_mfma_f32_32x32x16_bf16 v[32:47], v[76:79], v[124:127], v[32:47]
    ds_read_b64_tr_b16 v[152:153], v0 offset:24576
    ds_read_b64_tr_b16 v[154:155], v0 offset:25600
    ds_read_b64_tr_b16 v[156:157], v3 offset:24576
    ds_read_b64_tr_b16 v[158:159], v3 offset:25600
    v_mfma_f32_32x32x16_bf16 v[16:31], v[80:83], v[128:131], v[16:31]
    s_add_u32 s63, s97, 24576
    s_sub_u32 s64, s63, 28672
    s_min_u32 s63, s63, s64
    buffer_load_dwordx4 v[64:67], v5, s[44:47], s63 offen offset:0 sc1
    v_mfma_f32_32x32x16_bf16 v[32:47], v[80:83], v[132:135], v[32:47]
    buffer_load_dwordx4 v[68:71], v5, s[44:47], s63 offen offset:1024 sc1
    ds_read_b64_tr_b16 v[160:161], v0 offset:12288
    ds_read_b64_tr_b16 v[162:163], v0 offset:13312
    ds_read_b64_tr_b16 v[164:165], v3 offset:12288
    ds_read_b64_tr_b16 v[166:167], v3 offset:13312
    s_waitcnt lgkmcnt(4)
    s_add_u32 s66, s97, 26624
    s_sub_u32 s67, s66, 28672
    s_min_u32 s66, s66, s67
    s_lshl_b32 s66, s66, 6
    s_add_u32 m0, s95, 24576
    s_nop 0
    buffer_load_dwordx4 v6, s[28:31], s66 offen offset:0 lds
    buffer_load_dwordx4 v7, s[28:31], s66 offen offset:1024 lds
    v_mfma_f32_32x32x16_bf16 v[16:31], v[84:87], v[136:139], v[16:31]
    buffer_load_dwordx4 v[72:75], v5, s[44:47], s63 offen offset:2048 sc1
    v_mfma_f32_32x32x16_bf16 v[32:47], v[84:87], v[140:143], v[32:47]
    buffer_load_dwordx4 v[76:79], v5, s[44:47], s63 offen offset:3072 sc1
    ds_read_b64_tr_b16 v[168:169], v0 offset:14336
    ds_read_b64_tr_b16 v[170:171], v0 offset:15360
    ds_read_b64_tr_b16 v[172:173], v3 offset:14336
    ds_read_b64_tr_b16 v[174:175], v3 offset:15360
    s_waitcnt lgkmcnt(4)
    s_add_u32 s66, s97, 27648
    s_sub_u32 s67, s66, 28672
    s_min_u32 s66, s66, s67
    s_lshl_b32 s66, s66, 6
    s_add_u32 m0, s95, 12288
    s_nop 0
    buffer_load_dwordx4 v6, s[28:31], s66 offen offset:0 lds
    buffer_load_dwordx4 v7, s[28:31], s66 offen offset:1024 lds
    v_mfma_f32_32x32x16_bf16 v[16:31], v[88:91], v[144:147], v[16:31]
    v_mfma_f32_32x32x16_bf16 v[32:47], v[88:91], v[148:151], v[32:47]
    s_waitcnt vmcnt(8)
    v_bitop3_b32 v12, v51, v55, v59 bitop3:0x80
    v_bitop3_b32 v12, v12, v63, 1 bitop3:0x80
    ds_read_b64_tr_b16 v[176:177], v0 offset:16384
    ds_read_b64_tr_b16 v[178:179], v0 offset:17408
    ds_read_b64_tr_b16 v[180:181], v3 offset:16384
    ds_read_b64_tr_b16 v[182:183], v3 offset:17408
    v_mfma_f32_32x32x16_bf16 v[16:31], v[92:95], v[152:155], v[16:31]
    v_cmp_eq_u32 vcc, 0, v12
    s_cbranch_vccnz SGB2_h
SGB2_r:
    v_mfma_f32_32x32x16_bf16 v[32:47], v[92:95], v[156:159], v[32:47]
    ds_read_b64_tr_b16 v[184:185], v0 offset:18432
    ds_read_b64_tr_b16 v[186:187], v0 offset:19456
    ds_read_b64_tr_b16 v[188:189], v3 offset:18432
    ds_read_b64_tr_b16 v[190:191], v3 offset:19456
    s_barrier
    v_mfma_f32_32x32x16_bf16 v[16:31], v[48:51], v[160:163], v[16:31]
    s_add_u32 s63, s97, 12288
    s_sub_u32 s64, s63, 28672
    s_min_u32 s63, s63, s64
    s_add_u32 s63, s63, 114688
    buffer_load_dwordx4 v[80:83], v5, s[44:47], s63 offen offset:0 sc1
    v_mfma_f32_32x32x16_bf16 v[32:47], v[48:51], v[164:167], v[32:47]
    buffer_load_dwordx4 v[84:87], v5, s[44:47], s63 offen offset:1024 sc1
    ds_read_b64_tr_b16 v[192:193], v0 offset:20480
    ds_read_b64_tr_b16 v[194:195], v0 offset:21504
    ds_read_b64_tr_b16 v[196:197], v3 offset:20480
    ds_read_b64_tr_b16 v[198:199], v3 offset:21504
    s_waitcnt lgkmcnt(12)
    v_mfma_f32_32x32x16_bf16 v[16:31], v[52:55], v[168:171], v[16:31]
    buffer_load_dwordx4 v[88:91], v5, s[44:47], s63 offen offset:2048 sc1
    v_mfma_f32_32x32x16_bf16 v[32:47], v[52:55], v[172:175], v[32:47]
    buffer_load_dwordx4 v[92:95], v5, s[44:47], s63 offen offset:3072 sc1
    ds_read_b64_tr_b16 v[200:201], v0 offset:22528
    ds_read_b64_tr_b16 v[202:203], v0 offset:23552
    ds_read_b64_tr_b16 v[204:205], v3 offset:22528
    ds_read_b64_tr_b16 v[206:207], v3 offset:23552
    s_waitcnt lgkmcnt(12)
    v_mfma_f32_32x32x16_bf16 v[16:31], v[56:59], v[176:179], v[16:31]
    v_mfma_f32_32x32x16_bf16 v[32:47], v[56:59], v[180:183], v[32:47]
    s_waitcnt vmcnt(6)
    v_bitop3_b32 v12, v67, v71, v75 bitop3:0x80
    v_bitop3_b32 v12, v12, v79, 1 bitop3:0x80
    ds_read_b64_tr_b16 v[208:209], v0 offset:24576
    ds_read_b64_tr_b16 v[210:211], v0 offset:25600
    ds_read_b64_tr_b16 v[212:213], v3 offset:24576
    ds_read_b64_tr_b16 v[214:215], v3 offset:25600
    s_waitcnt lgkmcnt(12)
    v_mfma_f32_32x32x16_bf16 v[16:31], v[60:63], v[184:187], v[16:31]
    v_cmp_eq_u32 vcc, 0, v12
    s_cbranch_vccnz SGB3_h
SGB3_r:
    v_mfma_f32_32x32x16_bf16 v[32:47], v[60:63], v[188:191], v[32:47]
    s_waitcnt vmcnt(4)
    ds_read_b64_tr_b16 v[216:217], v0 offset:12288
    ds_read_b64_tr_b16 v[218:219], v0 offset:13312
    ds_read_b64_tr_b16 v[220:221], v3 offset:12288
    ds_read_b64_tr_b16 v[222:223], v3 offset:13312
    s_waitcnt lgkmcnt(12)
    v_mfma_f32_32x32x16_bf16 v[32:47], v[64:67], v[196:199], v[32:47]
    s_add_u32 s63, s97, 16384
    s_sub_u32 s64, s63, 28672
    s_min_u32 s63, s63, s64
    s_add_u32 s63, s63, 114688
    buffer_load_dwordx4 v[48:51], v5, s[44:47], s63 offen offset:0 sc1
    s_waitcnt lgkmcnt(8)
    v_mfma_f32_32x32x16_bf16 v[32:47], v[68:71], v[204:207], v[32:47]
    buffer_load_dwordx4 v[52:55], v5, s[44:47], s63 offen offset:1024 sc1
    s_waitcnt lgkmcnt(4)
    v_mfma_f32_32x32x16_bf16 v[32:47], v[72:75], v[212:215], v[32:47]
    buffer_load_dwordx4 v[56:59], v5, s[44:47], s63 offen offset:2048 sc1
    s_waitcnt lgkmcnt(0)
    v_mfma_f32_32x32x16_bf16 v[32:47], v[76:79], v[220:223], v[32:47]
    buffer_load_dwordx4 v[60:63], v5, s[44:47], s63 offen offset:3072 sc1
    v_mfma_f32_32x32x16_bf16 v[16:31], v[64:67], v[192:195], v[16:31]
    s_nop 9
    ds_write_b128 v11, v[32:35] offset:10240
    v_mfma_f32_32x32x16_bf16 v[16:31], v[68:71], v[200:203], v[16:31]
    ds_write_b128 v11, v[36:39] offset:11264
    s_waitcnt vmcnt(4)
    v_bitop3_b32 v12, v83, v87, v91 bitop3:0x80
    v_bitop3_b32 v12, v12, v95, 1 bitop3:0x80
    v_mfma_f32_32x32x16_bf16 v[16:31], v[72:75], v[208:211], v[16:31]
    ds_write_b128 v10, v[40:43] offset:26624
    v_cmp_eq_u32 vcc, 0, v12
    s_cbranch_vccnz SGB4_h
SGB4_r:
    v_mfma_f32_32x32x16_bf16 v[16:31], v[76:79], v[216:219], v[16:31]
    ds_write_b128 v10, v[44:47] offset:27648
    v_mfma_f32_32x32x16_bf16 v[32:47], v[80:83], v[100:103], 0
    s_nop 9
    ds_write_b128 v11, v[16:19] offset:6144
    s_add_u32 s63, s97, 20480
    s_sub_u32 s64, s63, 28672
    s_min_u32 s63, s63, s64
    s_add_u32 s63, s63, 114688
    buffer_load_dwordx4 v[64:67], v5, s[44:47], s63 offen offset:0 sc1
    v_mfma_f32_32x32x16_bf16 v[32:47], v[84:87], v[108:111], v[32:47]
    ds_write_b128 v11, v[20:23] offset:7168
    buffer_load_dwordx4 v[68:71], v5, s[44:47], s63 offen offset:1024 sc1
    v_mfma_f32_32x32x16_bf16 v[32:47], v[88:91], v[116:119], v[32:47]
    ds_write_b128 v11, v[24:27] offset:8192
    buffer_load_dwordx4 v[72:75], v5, s[44:47], s63 offen offset:2048 sc1
    v_mfma_f32_32x32x16_bf16 v[32:47], v[92:95], v[124:127], v[32:47]
    ds_write_b128 v11, v[28:31] offset:9216
    buffer_load_dwordx4 v[76:79], v5, s[44:47], s63 offen offset:3072 sc1
    s_waitcnt lgkmcnt(0)
    s_barrier
    v_mfma_f32_32x32x16_bf16 v[16:31], v[80:83], v[96:99], 0
    v_mfma_f32_32x32x16_bf16 v[16:31], v[84:87], v[104:107], v[16:31]
    s_waitcnt vmcnt(4)
    v_bitop3_b32 v12, v51, v55, v59 bitop3:0x80
    v_bitop3_b32 v12, v12, v63, 1 bitop3:0x80
    v_mfma_f32_32x32x16_bf16 v[16:31], v[88:91], v[112:115], v[16:31]
    v_cmp_eq_u32 vcc, 0, v12
    s_cbranch_vccnz SGB5_h
SGB5_r:
    v_mfma_f32_32x32x16_bf16 v[16:31], v[92:95], v[120:123], v[16:31]
    v_mfma_f32_32x32x16_bf16 v[16:31], v[48:51], v[128:131], v[16:31]
    s_add_u32 s63, s97, 24576
    s_sub_u32 s64, s63, 28672
    s_min_u32 s63, s63, s64
    s_add_u32 s63, s63, 114688
    buffer_load_dwordx4 v[80:83], v5, s[44:47], s63 offen offset:0 sc1
    v_mfma_f32_32x32x16_bf16 v[32:47], v[48:51], v[132:135], v[32:47]
    buffer_load_dwordx4 v[84:87], v5, s[44:47], s63 offen offset:1024 sc1
    v_mfma_f32_32x32x16_bf16 v[16:31], v[52:55], v[136:139], v[16:31]
    buffer_load_dwordx4 v[88:91], v5, s[44:47], s63 offen offset:2048 sc1
    v_mfma_f32_32x32x16_bf16 v[32:47], v[52:55], v[140:143], v[32:47]
    buffer_load_dwordx4 v[92:95], v5, s[44:47], s63 offen offset:3072 sc1
    v_mfma_f32_32x32x16_bf16 v[16:31], v[56:59], v[144:147], v[16:31]
    v_mfma_f32_32x32x16_bf16 v[32:47], v[56:59], v[148:151], v[32:47]
    s_waitcnt vmcnt(4)
    v_bitop3_b32 v12, v67, v71, v75 bitop3:0x80
    v_bitop3_b32 v12, v12, v79, 1 bitop3:0x80
    v_mfma_f32_32x32x16_bf16 v[16:31], v[60:63], v[152:155], v[16:31]
    v_cmp_eq_u32 vcc, 0, v12
    s_cbranch_vccnz SGB6_h
SGB6_r:
    v_mfma_f32_32x32x16_bf16 v[32:47], v[60:63], v[156:159], v[32:47]
    v_mfma_f32_32x32x16_bf16 v[16:31], v[64:67], v[160:163], v[16:31]
    v_mfma_f32_32x32x16_bf16 v[32:47], v[64:67], v[164:167], v[32:47]
    v_mfma_f32_32x32x16_bf16 v[16:31], v[68:71], v[168:171], v[16:31]
    v_mfma_f32_32x32x16_bf16 v[32:47], v[68:71], v[172:175], v[32:47]
    v_mfma_f32_32x32x16_bf16 v[16:31], v[72:75], v[176:179], v[16:31]
    v_mfma_f32_32x32x16_bf16 v[32:47], v[72:75], v[180:183], v[32:47]
    s_waitcnt vmcnt(0)
    v_bitop3_b32 v12, v83, v87, v91 bitop3:0x80
    v_bitop3_b32 v12, v12, v95, 1 bitop3:0x80
    v_mfma_f32_32x32x16_bf16 v[16:31], v[76:79], v[184:187], v[16:31]
    v_cmp_eq_u32 vcc, 0, v12
    s_cbranch_vccnz SGB7_h
SGB7_r:
    v_mfma_f32_32x32x16_bf16 v[32:47], v[76:79], v[188:191], v[32:47]
    v_mfma_f32_32x32x16_bf16 v[32:47], v[80:83], v[196:199], v[32:47]
    v_mfma_f32_32x32x16_bf16 v[32:47], v[84:87], v[204:207], v[32:47]
    v_mfma_f32_32x32x16_bf16 v[32:47], v[88:91], v[212:215], v[32:47]
    v_mfma_f32_32x32x16_bf16 v[32:47], v[92:95], v[220:223], v[32:47]
    s_barrier
    v_mfma_f32_32x32x16_bf16 v[16:31], v[80:83], v[192:195], v[16:31]
    s_nop 9
    ds_write_b128 v11, v[32:35] offset:10240
    v_mfma_f32_32x32x16_bf16 v[16:31], v[84:87], v[200:203], v[16:31]
    ds_write_b128 v11, v[36:39] offset:11264
    v_mfma_f32_32x32x16_bf16 v[16:31], v[88:91], v[208:211], v[16:31]
    ds_write_b128 v10, v[40:43] offset:26624
    v_mfma_f32_32x32x16_bf16 v[16:31], v[92:95], v[216:219], v[16:31]
    ds_write_b128 v10, v[44:47] offset:27648
    s_nop 10
    ds_write_b128 v11, v[16:19] offset:6144
    ds_write_b128 v11, v[20:23] offset:7168
    ds_write_b128 v11, v[24:27] offset:8192
    ds_write_b128 v11, v[28:31] offset:9216
    s_waitcnt lgkmcnt(0)
    s_barrier
MLP_ENDB:
    s_branch K_FIN
P2_FALL:
    s_cmp_lg_u32 s71, 0
    s_cbranch_scc1 P2_FIN
    s_mov_b32 s71, -1
    s_waitcnt vmcnt(0) lgkmcnt(0)
    v_cndmask_b32 v22, v22, 0, s[60:61]
    v_cndmask_b32 v23, v23, 0, s[60:61]
    v_mov_b32 v112, 0xff800000
    v_cndmask_b32 v30, v30, 0, s[60:61]
    v_cndmask_b32 v31, v31, 0, s[60:61]
    v_mov_b32 v113, 0xff800000
    v_cndmask_b32 v38, v38, 0, s[60:61]
    v_cndmask_b32 v39, v39, 0, s[60:61]
    v_mov_b32 v114, 0xff800000
    v_cndmask_b32 v46, v46, 0, s[60:61]
    v_cndmask_b32 v47, v47, 0, s[60:61]
    v_mov_b32 v115, 0xff800000
    s_mov_b32 s64, 0
P2_MAXLOOP:
    buffer_load_dwordx4 v[120:123], v243, s[44:47], s64 offen offset:0 sc1
    buffer_load_dwordx4 v[124:127], v243, s[44:47], s64 offen offset:1024 sc1
    s_waitcnt vmcnt(0)
    v_mfma_f32_32x32x16_bf16 v[48:63], v[120:123], v[16:19], 0
    v_mfma_f32_32x32x16_bf16 v[48:63], v[124:127], v[20:23], v[48:63]
    v_mfma_f32_32x32x16_bf16 v[64:79], v[120:123], v[24:27], 0
    v_mfma_f32_32x32x16_bf16 v[64:79], v[124:127], v[28:31], v[64:79]
    v_mfma_f32_32x32x16_bf16 v[80:95], v[120:123], v[32:35], 0
    v_mfma_f32_32x32x16_bf16 v[80:95], v[124:127], v[36:39], v[80:95]
    v_mfma_f32_32x32x16_bf16 v[96:111], v[120:123], v[40:43], 0
    v_mfma_f32_32x32x16_bf16 v[96:111], v[124:127], v[44:47], v[96:111]
    s_nop 5
    v_max3_f32 v4, v48, v49, v50
    v_max3_f32 v5, v51, v52, v53
    v_max3_f32 v4, v4, v54, v55
    v_max3_f32 v5, v5, v56, v57
    v_max3_f32 v4, v4, v58, v59
    v_max3_f32 v5, v5, v60, v61
    v_max3_f32 v4, v4, v62, v63
    v_max3_f32 v112, v112, v4, v5
    v_max3_f32 v4, v64, v65, v66
    v_max3_f32 v5, v67, v68, v69
    v_max3_f32 v4, v4, v70, v71
    v_max3_f32 v5, v5, v72, v73
    v_max3_f32 v4, v4, v74, v75
    v_max3_f32 v5, v5, v76, v77
    v_max3_f32 v4, v4, v78, v79
    v_max3_f32 v113, v113, v4, v5
    v_max3_f32 v4, v80, v81, v82
    v_max3_f32 v5, v83, v84, v85
    v_max3_f32 v4, v4, v86, v87
    v_max3_f32 v5, v5, v88, v89
    v_max3_f32 v4, v4, v90, v91
    v_max3_f32 v5, v5, v92, v93
    v_max3_f32 v4, v4, v94, v95
    v_max3_f32 v114, v114, v4, v5
    v_max3_f32 v4, v96, v97, v98
    v_max3_f32 v5, v99, v100, v101
    v_max3_f32 v4, v4, v102, v103
    v_max3_f32 v5, v5, v104, v105
    v_max3_f32 v4, v4, v106, v107
    v_max3_f32 v5, v5, v108, v109
    v_max3_f32 v4, v4, v110, v111
    v_max3_f32 v115, v115, v4, v5
    s_add_u32 s64, s64, 4096
    s_cmp_lt_u32 s64, 65536
    s_cbranch_scc1 P2_MAXLOOP
    s_barrier
    v_and_b32 v7, 31, v1
    v_lshlrev_b32 v7, 4, v7
    v_mov_b32 v6, v112
    s_nop 1
    v_permlane32_swap_b32 v112, v6
    v_max_f32 v112, v112, v6
    s_add_u32 s63, s48, 0
    s_and_b32 s63, s63, 3
    s_lshl_b32 s63, s63, 9
    s_add_u32 s63, s63, 114688
    s_lshl_b32 s64, s48, 2
    s_add_u32 s64, s64, s63
    v_add_u32 v120, s63, v7
    v_add_u32 v6, s64, v7
    ds_write_b32 v6, v112
    v_mov_b32 v6, v113
    s_nop 1
    v_permlane32_swap_b32 v113, v6
    v_max_f32 v113, v113, v6
    s_add_u32 s63, s48, 1
    s_and_b32 s63, s63, 3
    s_lshl_b32 s63, s63, 9
    s_add_u32 s63, s63, 114688
    s_lshl_b32 s64, s48, 2
    s_add_u32 s64, s64, s63
    v_add_u32 v121, s63, v7
    v_add_u32 v6, s64, v7
    ds_write_b32 v6, v113
    v_mov_b32 v6, v114
    s_nop 1
    v_permlane32_swap_b32 v114, v6
    v_max_f32 v114, v114, v6
    s_add_u32 s63, s48, 2
    s_and_b32 s63, s63, 3
    s_lshl_b32 s63, s63, 9
    s_add_u32 s63, s63, 114688
    s_lshl_b32 s64, s48, 2
    s_add_u32 s64, s64, s63
    v_add_u32 v122, s63, v7
    v_add_u32 v6, s64, v7
    ds_write_b32 v6, v114
    v_mov_b32 v6, v115
    s_nop 1
    v_permlane32_swap_b32 v115, v6
    v_max_f32 v115, v115, v6
    s_add_u32 s63, s48, 3
    s_and_b32 s63, s63, 3
    s_lshl_b32 s63, s63, 9
    s_add_u32 s63, s63, 114688
    s_lshl_b32 s64, s48, 2
    s_add_u32 s64, s64, s63
    v_add_u32 v123, s63, v7
    v_add_u32 v6, s64, v7
    ds_write_b32 v6, v115
    s_waitcnt lgkmcnt(0)
    s_barrier
    ds_read_b128 v[48:51], v120
    ds_read_b128 v[52:55], v121
    ds_read_b128 v[56:59], v122
    ds_read_b128 v[60:63], v123
    s_add_u32 s66, s44, 4096
    s_addc_u32 s67, s45, 0
    global_load_dwordx4 v[160:163], v243, s[66:67] offset:-4096 sc1
    global_load_dwordx4 v[164:167], v243, s[66:67] offset:-3072 sc1
    global_load_dwordx4 v[168:171], v243, s[66:67] offset:-2048 sc1
    global_load_dwordx4 v[172:175], v243, s[66:67] offset:-1024 sc1
    global_load_dwordx4 v[176:179], v243, s[66:67] offset:0 sc1
    global_load_dwordx4 v[180:183], v243, s[66:67] offset:1024 sc1
    global_load_dwordx4 v[184:187], v243, s[66:67] offset:2048 sc1
    global_load_dwordx4 v[188:191], v243, s[66:67] offset:3072 sc1
    s_add_u32 s66, s66, 8192
    s_addc_u32 s67, s67, 0
    global_load_dwordx4 v[192:195], v243, s[66:67] offset:-4096 sc1
    global_load_dwordx4 v[196:199], v243, s[66:67] offset:-3072 sc1
    global_load_dwordx4 v[200:203], v243, s[66:67] offset:-2048 sc1
    global_load_dwordx4 v[204:207], v243, s[66:67] offset:-1024 sc1
    global_load_dwordx4 v[208:211], v243, s[66:67] offset:0 sc1
    global_load_dwordx4 v[212:215], v243, s[66:67] offset:1024 sc1
    global_load_dwordx4 v[216:219], v243, s[66:67] offset:2048 sc1
    global_load_dwordx4 v[220:223], v243, s[66:67] offset:3072 sc1
    s_waitcnt vmcnt(0) lgkmcnt(0)
    s_barrier
    v_max3_f32 v112, v48, v49, v50
    v_max_f32 v112, v112, v51
    v_sub_f32 v4, 0, v112
    v_and_b32 v5, 0xffff0000, v4
    v_sub_f32 v4, v4, v5
    v_and_b32 v6, 0xffff0000, v4
    v_sub_f32 v4, v4, v6
    v_lshrrev_b32 v4, 16, v4
    v_lshrrev_b32 v5, 16, v5
    v_or_b32 v5, v5, v6
    v_cndmask_b32 v22, v22, v5, s[60:61]
    v_cndmask_b32 v23, v23, v4, s[60:61]
    v_max3_f32 v113, v52, v53, v54
    v_max_f32 v113, v113, v55
    v_sub_f32 v4, 0, v113
    v_and_b32 v5, 0xffff0000, v4
    v_sub_f32 v4, v4, v5
    v_and_b32 v6, 0xffff0000, v4
    v_sub_f32 v4, v4, v6
    v_lshrrev_b32 v4, 16, v4
    v_lshrrev_b32 v5, 16, v5
    v_or_b32 v5, v5, v6
    v_cndmask_b32 v30, v30, v5, s[60:61]
    v_cndmask_b32 v31, v31, v4, s[60:61]
    v_max3_f32 v114, v56, v57, v58
    v_max_f32 v114, v114, v59
    v_sub_f32 v4, 0, v114
    v_and_b32 v5, 0xffff0000, v4
    v_sub_f32 v4, v4, v5
    v_and_b32 v6, 0xffff0000, v4
    v_sub_f32 v4, v4, v6
    v_lshrrev_b32 v4, 16, v4
    v_lshrrev_b32 v5, 16, v5
    v_or_b32 v5, v5, v6
    v_cndmask_b32 v38, v38, v5, s[60:61]
    v_cndmask_b32 v39, v39, v4, s[60:61]
    v_max3_f32 v115, v60, v61, v62
    v_max_f32 v115, v115, v63
    v_sub_f32 v4, 0, v115
    v_and_b32 v5, 0xffff0000, v4
    v_sub_f32 v4, v4, v5
    v_and_b32 v6, 0xffff0000, v4
    v_sub_f32 v4, v4, v6
    v_lshrrev_b32 v4, 16, v4
    v_lshrrev_b32 v5, 16, v5
    v_or_b32 v5, v5, v6
    v_cndmask_b32 v46, v46, v5, s[60:61]
    v_cndmask_b32 v47, v47, v4, s[60:61]
    v_mfma_f32_32x32x16_bf16 v[112:127], v[160:163], v[16:19], 0
    v_mfma_f32_32x32x16_bf16 v[112:127], v[164:167], v[20:23], v[112:127]
    s_branch P2_MAIN
SO0_h:
    s_mov_b32 s57, 0x40000
SO0_l:
    s_add_u32 s63, s101, 0
    s_and_b32 s63, s63, 0x1fffff
    buffer_load_dwordx4 v[16:19], v10, s[44:47], s63 offen offset:0 sc1
    buffer_load_dwordx4 v[20:23], v10, s[44:47], s63 offen offset:1024 sc1
    buffer_load_dwordx4 v[24:27], v11, s[44:47], s63 offen offset:0 sc1
    buffer_load_dwordx4 v[28:31], v11, s[44:47], s63 offen offset:1024 sc1
    s_sub_u32 s57, s57, 1
    s_waitcnt vmcnt(0)
    s_cbranch_scc1 SO0_r
    v_bitop3_b32 v8, v19, v23, v27 bitop3:0x80
    v_bitop3_b32 v8, v8, v31, 1 bitop3:0x80
    v_cmp_eq_u32 vcc, 0, v8
    s_cbranch_vccnz SO0_l
    s_branch SO0_r
SO1_h:
    s_mov_b32 s57, 0x40000
SO1_l:
    s_add_u32 s63, s101, 262144
    s_and_b32 s63, s63, 0x1fffff
    buffer_load_dwordx4 v[32:35], v10, s[44:47], s63 offen offset:0 sc1
    buffer_load_dwordx4 v[36:39], v10, s[44:47], s63 offen offset:1024 sc1
    buffer_load_dwordx4 v[40:43], v11, s[44:47], s63 offen offset:0 sc1
    buffer_load_dwordx4 v[44:47], v11, s[44:47], s63 offen offset:1024 sc1
    s_sub_u32 s57, s57, 1
    s_waitcnt vmcnt(0)
    s_cbranch_scc1 SO1_r
    v_bitop3_b32 v8, v35, v39, v43 bitop3:0x80
    v_bitop3_b32 v8, v8, v47, 1 bitop3:0x80
    v_cmp_eq_u32 vcc, 0, v8
    s_cbranch_vccnz SO1_l
    s_branch SO1_r
SO2_h:
    s_mov_b32 s57, 0x40000
SO2_l:
    s_add_u32 s63, s101, 524288
    s_and_b32 s63, s63, 0x1fffff
    buffer_load_dwordx4 v[48:51], v10, s[44:47], s63 offen offset:0 sc1
    buffer_load_dwordx4 v[52:55], v10, s[44:47], s63 offen offset:1024 sc1
    buffer_load_dwordx4 v[56:59], v11, s[44:47], s63 offen offset:0 sc1
    buffer_load_dwordx4 v[60:63], v11, s[44:47], s63 offen offset:1024 sc1
    s_sub_u32 s57, s57, 1
    s_waitcnt vmcnt(0)
    s_cbranch_scc1 SO2_r
    v_bitop3_b32 v8, v51, v55, v59 bitop3:0x80
    v_bitop3_b32 v8, v8, v63, 1 bitop3:0x80
    v_cmp_eq_u32 vcc, 0, v8
    s_cbranch_vccnz SO2_l
    s_branch SO2_r
SO3_h:
    s_mov_b32 s57, 0x40000
SO3_l:
    s_add_u32 s63, s101, 786432
    s_and_b32 s63, s63, 0x1fffff
    buffer_load_dwordx4 v[64:67], v10, s[44:47], s63 offen offset:0 sc1
    buffer_load_dwordx4 v[68:71], v10, s[44:47], s63 offen offset:1024 sc1
    buffer_load_dwordx4 v[72:75], v11, s[44:47], s63 offen offset:0 sc1
    buffer_load_dwordx4 v[76:79], v11, s[44:47], s63 offen offset:1024 sc1
    s_sub_u32 s57, s57, 1
    s_waitcnt vmcnt(0)
    s_cbranch_scc1 SO3_r
    v_bitop3_b32 v8, v67, v71, v75 bitop3:0x80
    v_bitop3_b32 v8, v8, v79, 1 bitop3:0x80
    v_cmp_eq_u32 vcc, 0, v8
    s_cbranch_vccnz SO3_l
    s_branch SO3_r
SO4_h:
    s_mov_b32 s57, 0x40000
SO4_l:
    s_add_u32 s63, s101, 1048576
    s_and_b32 s63, s63, 0x1fffff
    buffer_load_dwordx4 v[80:83], v10, s[44:47], s63 offen offset:0 sc1
    buffer_load_dwordx4 v[84:87], v10, s[44:47], s63 offen offset:1024 sc1
    buffer_load_dwordx4 v[88:91], v11, s[44:47], s63 offen offset:0 sc1
    buffer_load_dwordx4 v[92:95], v11, s[44:47], s63 offen offset:1024 sc1
    s_sub_u32 s57, s57, 1
    s_waitcnt vmcnt(0)
    s_cbranch_scc1 SO4_r
    v_bitop3_b32 v8, v83, v87, v91 bitop3:0x80
    v_bitop3_b32 v8, v8, v95, 1 bitop3:0x80
    v_cmp_eq_u32 vcc, 0, v8
    s_cbranch_vccnz SO4_l
    s_branch SO4_r
SO5_h:
    s_mov_b32 s57, 0x40000
SO5_l:
    s_add_u32 s63, s101, 1310720
    s_and_b32 s63, s63, 0x1fffff
    buffer_load_dwordx4 v[128:131], v10, s[44:47], s63 offen offset:0 sc1
    buffer_load_dwordx4 v[132:135], v10, s[44:47], s63 offen offset:1024 sc1
    buffer_load_dwordx4 v[136:139], v11, s[44:47], s63 offen offset:0 sc1
    buffer_load_dwordx4 v[140:143], v11, s[44:47], s63 offen offset:1024 sc1
    s_sub_u32 s57, s57, 1
    s_waitcnt vmcnt(0)
    s_cbranch_scc1 SO5_r
    v_bitop3_b32 v8, v131, v135, v139 bitop3:0x80
    v_bitop3_b32 v8, v8, v143, 1 bitop3:0x80
    v_cmp_eq_u32 vcc, 0, v8
    s_cbranch_vccnz SO5_l
    s_branch SO5_r
SO6_h:
    s_mov_b32 s57, 0x40000
SO6_l:
    s_add_u32 s63, s101, 1572864
    s_and_b32 s63, s63, 0x1fffff
    buffer_load_dwordx4 v[144:147], v10, s[44:47], s63 offen offset:0 sc1
    buffer_load_dwordx4 v[148:151], v10, s[44:47], s63 offen offset:1024 sc1
    buffer_load_dwordx4 v[152:155], v11, s[44:47], s63 offen offset:0 sc1
    buffer_load_dwordx4 v[156:159], v11, s[44:47], s63 offen offset:1024 sc1
    s_sub_u32 s57, s57, 1
    s_waitcnt vmcnt(0)
    s_cbranch_scc1 SO6_r
    v_bitop3_b32 v8, v147, v151, v155 bitop3:0x80
    v_bitop3_b32 v8, v8, v159, 1 bitop3:0x80
    v_cmp_eq_u32 vcc, 0, v8
    s_cbranch_vccnz SO6_l
    s_branch SO6_r
SO7_h:
    s_mov_b32 s57, 0x40000
SO7_l:
    s_add_u32 s63, s101, 1835008
    s_and_b32 s63, s63, 0x1fffff
    buffer_load_dwordx4 v[160:163], v10, s[44:47], s63 offen offset:0 sc1
    buffer_load_dwordx4 v[164:167], v10, s[44:47], s63 offen offset:1024 sc1
    buffer_load_dwordx4 v[168:171], v11, s[44:47], s63 offen offset:0 sc1
    buffer_load_dwordx4 v[172:175], v11, s[44:47], s63 offen offset:1024 sc1
    s_sub_u32 s57, s57, 1
    s_waitcnt vmcnt(0)
    s_cbranch_scc1 SO7_r
    v_bitop3_b32 v8, v163, v167, v171 bitop3:0x80
    v_bitop3_b32 v8, v8, v175, 1 bitop3:0x80
    v_cmp_eq_u32 vcc, 0, v8
    s_cbranch_vccnz SO7_l
    s_branch SO7_r
P3_FAR:
    buffer_store_dwordx4 v[16:19], v2, s[44:47], s63 offen sc1
    s_branch P3_FARX
P3_GH:
    s_mov_b32 s57, 0x40000
P3_GL:
    buffer_load_dwordx4 v[32:35], v6, s[44:47], s67 offen offset:0 sc1
    buffer_load_dwordx4 v[36:39], v6, s[44:47], s67 offen offset:512 sc1
    buffer_load_dwordx4 v[40:43], v6, s[44:47], s67 offen offset:1024 sc1
    buffer_load_dwordx4 v[44:47], v6, s[44:47], s67 offen offset:1536 sc1
    buffer_load_dwordx4 v[48:51], v6, s[44:47], s67 offen offset:2048 sc1
    buffer_load_dwordx4 v[52:55], v6, s[44:47], s67 offen offset:2560 sc1
    buffer_load_dwordx4 v[56:59], v6, s[44:47], s67 offen offset:3072 sc1
    s_sub_u32 s57, s57, 1
    s_waitcnt vmcnt(0)
    s_cbranch_scc1 P3_GX
    v_xor_b32 v9, s58, v33
    v_xor_b32 v4, s59, v35
    v_or_b32 v9, v9, v4
    v_xor_b32 v4, s58, v37
    v_xor_b32 v5, s59, v39
    v_or3_b32 v9, v9, v4, v5
    v_xor_b32 v4, s58, v41
    v_xor_b32 v5, s59, v43
    v_or3_b32 v9, v9, v4, v5
    v_xor_b32 v4, s58, v45
    v_xor_b32 v5, s59, v47
    v_or3_b32 v9, v9, v4, v5
    v_xor_b32 v4, s58, v49
    v_xor_b32 v5, s59, v51
    v_or3_b32 v9, v9, v4, v5
    v_xor_b32 v4, s58, v53
    v_xor_b32 v5, s59, v55
    v_or3_b32 v9, v9, v4, v5
    v_xor_b32 v4, s58, v57
    v_xor_b32 v5, s59, v59
    v_or3_b32 v9, v9, v4, v5
    v_cmp_ne_u32 vcc, 0, v9
    s_cbranch_vccnz P3_GL
    s_branch P3_GX
SIAg0_h:
    s_mov_b32 s57, 0x40000
    s_mov_b32 exec_hi, 0
SIAg0_l:
    s_and_b32 exec_lo, s6, 0x0000003f
    buffer_load_dword v5, v242, s[44:47], 0 offen sc1
    s_sub_u32 s57, s57, 1
    s_waitcnt vmcnt(0)
    s_cbranch_scc1 SIAg0_x
    v_and_b32 v5, 1, v5
    v_cmp_ne_u32 vcc, 0, v5
    s_nop 0
    s_andn2_b32 s6, s6, vcc_lo
    s_and_b32 s63, s6, 0x00000003
    s_cbranch_scc1 SIAg0_l
SIAg0_x:
    s_mov_b64 exec, -1
    s_branch SIAg0_r
SIAg1_h:
    s_mov_b32 s57, 0x40000
    s_mov_b32 exec_hi, 0
SIAg1_l:
    s_and_b32 exec_lo, s6, 0x0000003f
    buffer_load_dword v5, v242, s[44:47], 0 offen sc1
    s_sub_u32 s57, s57, 1
    s_waitcnt vmcnt(0)
    s_cbranch_scc1 SIAg1_x
    v_and_b32 v5, 1, v5
    v_cmp_ne_u32 vcc, 0, v5
    s_nop 0
    s_andn2_b32 s6, s6, vcc_lo
    s_and_b32 s63, s6, 0x0000000c
    s_cbranch_scc1 SIAg1_l
SIAg1_x:
    s_mov_b64 exec, -1
    s_branch SIAg1_r
SIAg2_h:
    s_mov_b32 s57, 0x40000
    s_mov_b32 exec_hi, 0
SIAg2_l:
    s_and_b32 exec_lo, s6, 0x0000003f
    buffer_load_dword v5, v242, s[44:47], 0 offen sc1
    s_sub_u32 s57, s57, 1
    s_waitcnt vmcnt(0)
    s_cbranch_scc1 SIAg2_x
    v_and_b32 v5, 1, v5
    v_cmp_ne_u32 vcc, 0, v5
    s_nop 0
    s_andn2_b32 s6, s6, vcc_lo
    s_and_b32 s63, s6, 0x00000030
    s_cbranch_scc1 SIAg2_l
SIAg2_x:
    s_mov_b64 exec, -1
    s_branch SIAg2_r
SHAg0_h:
    s_mov_b32 s57, 0x40000
    s_mov_b32 exec_hi, 0
SHAg0_l:
    s_and_b32 exec_lo, s6, 0x0000003f
    buffer_load_dword v5, v3, s[44:47], 0 offen sc1
    s_sub_u32 s57, s57, 1
    s_waitcnt vmcnt(0)
    s_cbranch_scc1 SHAg0_x
    v_and_b32 v5, s65, v5
    v_cmp_ne_u32 vcc, 0, v5
    s_nop 0
    s_andn2_b32 s6, s6, vcc_lo
    s_and_b32 s63, s6, 0x00000003
    s_cbranch_scc1 SHAg0_l
SHAg0_x:
    s_mov_b64 exec, -1
    s_branch SHAg0_r
SHAg1_h:
    s_mov_b32 s57, 0x40000
    s_mov_b32 exec_hi, 0
SHAg1_l:
    s_and_b32 exec_lo, s6, 0x0000003f
    buffer_load_dword v5, v3, s[44:47], 0 offen sc1
    s_sub_u32 s57, s57, 1
    s_waitcnt vmcnt(0)
    s_cbranch_scc1 SHAg1_x
    v_and_b32 v5, s65, v5
    v_cmp_ne_u32 vcc, 0, v5
    s_nop 0
    s_andn2_b32 s6, s6, vcc_lo
    s_and_b32 s63, s6, 0x0000000c
    s_cbranch_scc1 SHAg1_l
SHAg1_x:
    s_mov_b64 exec, -1
    s_branch SHAg1_r
SHAg2_h:
    s_mov_b32 s57, 0x40000
    s_mov_b32 exec_hi, 0
SHAg2_l:
    s_and_b32 exec_lo, s6, 0x0000003f
    buffer_load_dword v5, v3, s[44:47], 0 offen sc1
    s_sub_u32 s57, s57, 1
    s_waitcnt vmcnt(0)
    s_cbranch_scc1 SHAg2_x
    v_and_b32 v5, s65, v5
    v_cmp_ne_u32 vcc, 0, v5
    s_nop 0
    s_andn2_b32 s6, s6, vcc_lo
    s_and_b32 s63, s6, 0x00000030
    s_cbranch_scc1 SHAg2_l
SHAg2_x:
    s_mov_b64 exec, -1
    s_branch SHAg2_r
SHA0_h:
    s_mov_b32 s57, 0x40000
SHA0_l:
    s_add_u32 s63, s96, 0
    s_and_b32 s63, s63, 0x7fff
    buffer_load_dwordx4 v[48:51], v14, s[44:47], s63 offen offset:0 sc1
    buffer_load_dwordx4 v[52:55], v14, s[44:47], s63 offen offset:1024 sc1
    buffer_load_dwordx4 v[56:59], v14, s[44:47], s63 offen offset:2048 sc1
    buffer_load_dwordx4 v[60:63], v14, s[44:47], s63 offen offset:3072 sc1
    s_sub_u32 s57, s57, 1
    s_waitcnt vmcnt(0)
    s_cbranch_scc1 SHA0_r
    v_bitop3_b32 v4, v51, v55, v59 bitop3:0x80
    v_bitop3_b32 v4, v4, v63, s65 bitop3:0x80
    v_cmp_eq_u32 vcc, 0, v4
    s_cbranch_vccnz SHA0_l
    s_branch SHA0_r
SHA1_h:
    s_mov_b32 s57, 0x40000
SHA1_l:
    s_add_u32 s63, s96, 4096
    s_and_b32 s63, s63, 0x7fff
    buffer_load_dwordx4 v[64:67], v14, s[44:47], s63 offen offset:0 sc1
    buffer_load_dwordx4 v[68:71], v14, s[44:47], s63 offen offset:1024 sc1
    buffer_load_dwordx4 v[72:75], v14, s[44:47], s63 offen offset:2048 sc1
    buffer_load_dwordx4 v[76:79], v14, s[44:47], s63 offen offset:3072 sc1
    s_sub_u32 s57, s57, 1
    s_waitcnt vmcnt(0)
    s_cbranch_scc1 SHA1_r
    v_bitop3_b32 v4, v67, v71, v75 bitop3:0x80
    v_bitop3_b32 v4, v4, v79, s65 bitop3:0x80
    v_cmp_eq_u32 vcc, 0, v4
    s_cbranch_vccnz SHA1_l
    s_branch SHA1_r
SHA2_h:
    s_mov_b32 s57, 0x40000
SHA2_l:
    s_add_u32 s63, s96, 8192
    s_and_b32 s63, s63, 0x7fff
    buffer_load_dwordx4 v[80:83], v14, s[44:47], s63 offen offset:0 sc1
    buffer_load_dwordx4 v[84:87], v14, s[44:47], s63 offen offset:1024 sc1
    buffer_load_dwordx4 v[88:91], v14, s[44:47], s63 offen offset:2048 sc1
    buffer_load_dwordx4 v[92:95], v14, s[44:47], s63 offen offset:3072 sc1
    s_sub_u32 s57, s57, 1
    s_waitcnt vmcnt(0)
    s_cbranch_scc1 SHA2_r
    v_bitop3_b32 v4, v83, v87, v91 bitop3:0x80
    v_bitop3_b32 v4, v4, v95, s65 bitop3:0x80
    v_cmp_eq_u32 vcc, 0, v4
    s_cbranch_vccnz SHA2_l
    s_branch SHA2_r
SHA3_h:
    s_mov_b32 s57, 0x40000
SHA3_l:
    s_add_u32 s63, s96, 0
    s_and_b32 s63, s63, 0x7fff
    s_bitset1_b32 s63, 17
    buffer_load_dwordx4 v[48:51], v14, s[44:47], s63 offen offset:0 sc1
    buffer_load_dwordx4 v[52:55], v14, s[44:47], s63 offen offset:1024 sc1
    buffer_load_dwordx4 v[56:59], v14, s[44:47], s63 offen offset:2048 sc1
    buffer_load_dwordx4 v[60:63], v14, s[44:47], s63 offen offset:3072 sc1
    s_sub_u32 s57, s57, 1
    s_waitcnt vmcnt(0)
    s_cbranch_scc1 SHA3_r
    v_bitop3_b32 v4, v51, v55, v59 bitop3:0x80
    v_bitop3_b32 v4, v4, v63, s65 bitop3:0x80
    v_cmp_eq_u32 vcc, 0, v4
    s_cbranch_vccnz SHA3_l
    s_branch SHA3_r
SHA4_h:
    s_mov_b32 s57, 0x40000
SHA4_l:
    s_add_u32 s63, s96, 4096
    s_and_b32 s63, s63, 0x7fff
    s_bitset1_b32 s63, 17
    buffer_load_dwordx4 v[64:67], v14, s[44:47], s63 offen offset:0 sc1
    buffer_load_dwordx4 v[68:71], v14, s[44:47], s63 offen offset:1024 sc1
    buffer_load_dwordx4 v[72:75], v14, s[44:47], s63 offen offset:2048 sc1
    buffer_load_dwordx4 v[76:79], v14, s[44:47], s63 offen offset:3072 sc1
    s_sub_u32 s57, s57, 1
    s_waitcnt vmcnt(0)
    s_cbranch_scc1 SHA4_r
    v_bitop3_b32 v4, v67, v71, v75 bitop3:0x80
    v_bitop3_b32 v4, v4, v79, s65 bitop3:0x80
    v_cmp_eq_u32 vcc, 0, v4
    s_cbranch_vccnz SHA4_l
    s_branch SHA4_r
SHA5_h:
    s_mov_b32 s57, 0x40000
SHA5_l:
    s_add_u32 s63, s96, 8192
    s_and_b32 s63, s63, 0x7fff
    s_bitset1_b32 s63, 17
    buffer_load_dwordx4 v[80:83], v14, s[44:47], s63 offen offset:0 sc1
    buffer_load_dwordx4 v[84:87], v14, s[44:47], s63 offen offset:1024 sc1
    buffer_load_dwordx4 v[88:91], v14, s[44:47], s63 offen offset:2048 sc1
    buffer_load_dwordx4 v[92:95], v14, s[44:47], s63 offen offset:3072 sc1
    s_sub_u32 s57, s57, 1
    s_waitcnt vmcnt(0)
    s_cbranch_scc1 SHA5_r
    v_bitop3_b32 v4, v83, v87, v91 bitop3:0x80
    v_bitop3_b32 v4, v4, v95, s65 bitop3:0x80
    v_cmp_eq_u32 vcc, 0, v4
    s_cbranch_vccnz SHA5_l
    s_branch SHA5_r
SGA0_h:
    s_mov_b32 s57, 0x40000
SGA0_l:
    s_add_u32 s63, s97, 0
    s_sub_u32 s64, s63, 28672
    s_min_u32 s63, s63, s64
    buffer_load_dwordx4 v[48:51], v253, s[44:47], s63 offen offset:0 sc1
    buffer_load_dwordx4 v[52:55], v253, s[44:47], s63 offen offset:1024 sc1
    buffer_load_dwordx4 v[56:59], v253, s[44:47], s63 offen offset:2048 sc1
    buffer_load_dwordx4 v[60:63], v253, s[44:47], s63 offen offset:3072 sc1
    s_sub_u32 s57, s57, 1
    s_waitcnt vmcnt(0)
    s_cbranch_scc1 SGA0_r
    v_bitop3_b32 v4, v51, v55, v59 bitop3:0x80
    v_bitop3_b32 v4, v4, v63, 1 bitop3:0x80
    v_cmp_eq_u32 vcc, 0, v4
    s_cbranch_vccnz SGA0_l
    s_branch SGA0_r
SGA1_h:
    s_mov_b32 s57, 0x40000
SGA1_l:
    s_add_u32 s63, s97, 4096
    s_sub_u32 s64, s63, 28672
    s_min_u32 s63, s63, s64
    buffer_load_dwordx4 v[64:67], v253, s[44:47], s63 offen offset:0 sc1
    buffer_load_dwordx4 v[68:71], v253, s[44:47], s63 offen offset:1024 sc1
    buffer_load_dwordx4 v[72:75], v253, s[44:47], s63 offen offset:2048 sc1
    buffer_load_dwordx4 v[76:79], v253, s[44:47], s63 offen offset:3072 sc1
    s_sub_u32 s57, s57, 1
    s_waitcnt vmcnt(0)
    s_cbranch_scc1 SGA1_r
    v_bitop3_b32 v4, v67, v71, v75 bitop3:0x80
    v_bitop3_b32 v4, v4, v79, 1 bitop3:0x80
    v_cmp_eq_u32 vcc, 0, v4
    s_cbranch_vccnz SGA1_l
    s_branch SGA1_r
SGA2_h:
    s_mov_b32 s57, 0x40000
SGA2_l:
    s_add_u32 s63, s97, 8192
    s_sub_u32 s64, s63, 28672
    s_min_u32 s63, s63, s64
    buffer_load_dwordx4 v[80:83], v253, s[44:47], s63 offen offset:0 sc1
    buffer_load_dwordx4 v[84:87], v253, s[44:47], s63 offen offset:1024 sc1
    buffer_load_dwordx4 v[88:91], v253, s[44:47], s63 offen offset:2048 sc1
    buffer_load_dwordx4 v[92:95], v253, s[44:47], s63 offen offset:3072 sc1
    s_sub_u32 s57, s57, 1
    s_waitcnt vmcnt(0)
    s_cbranch_scc1 SGA2_r
    v_bitop3_b32 v4, v83, v87, v91 bitop3:0x80
    v_bitop3_b32 v4, v4, v95, 1 bitop3:0x80
    v_cmp_eq_u32 vcc, 0, v4
    s_cbranch_vccnz SGA2_l
    s_branch SGA2_r
SGA3_h:
    s_mov_b32 s57, 0x40000
SGA3_l:
    s_add_u32 s63, s97, 0
    s_sub_u32 s64, s63, 28672
    s_min_u32 s63, s63, s64
    s_add_u32 s63, s63, 114688
    buffer_load_dwordx4 v[48:51], v253, s[44:47], s63 offen offset:0 sc1
    buffer_load_dwordx4 v[52:55], v253, s[44:47], s63 offen offset:1024 sc1
    buffer_load_dwordx4 v[56:59], v253, s[44:47], s63 offen offset:2048 sc1
    buffer_load_dwordx4 v[60:63], v253, s[44:47], s63 offen offset:3072 sc1
    s_sub_u32 s57, s57, 1
    s_waitcnt vmcnt(0)
    s_cbranch_scc1 SGA3_r
    v_bitop3_b32 v4, v51, v55, v59 bitop3:0x80
    v_bitop3_b32 v4, v4, v63, 1 bitop3:0x80
    v_cmp_eq_u32 vcc, 0, v4
    s_cbranch_vccnz SGA3_l
    s_branch SGA3_r
SGA4_h:
    s_mov_b32 s57, 0x40000
SGA4_l:
    s_add_u32 s63, s97, 4096
    s_sub_u32 s64, s63, 28672
    s_min_u32 s63, s63, s64
    s_add_u32 s63, s63, 114688
    buffer_load_dwordx4 v[64:67], v253, s[44:47], s63 offen offset:0 sc1
    buffer_load_dwordx4 v[68:71], v253, s[44:47], s63 offen offset:1024 sc1
    buffer_load_dwordx4 v[72:75], v253, s[44:47], s63 offen offset:2048 sc1
    buffer_load_dwordx4 v[76:79], v253, s[44:47], s63 offen offset:3072 sc1
    s_sub_u32 s57, s57, 1
    s_waitcnt vmcnt(0)
    s_cbranch_scc1 SGA4_r
    v_bitop3_b32 v4, v67, v71, v75 bitop3:0x80
    v_bitop3_b32 v4, v4, v79, 1 bitop3:0x80
    v_cmp_eq_u32 vcc, 0, v4
    s_cbranch_vccnz SGA4_l
    s_branch SGA4_r
SGA5_h:
    s_mov_b32 s57, 0x40000
SGA5_l:
    s_add_u32 s63, s97, 8192
    s_sub_u32 s64, s63, 28672
    s_min_u32 s63, s63, s64
    s_add_u32 s63, s63, 114688
    buffer_load_dwordx4 v[80:83], v253, s[44:47], s63 offen offset:0 sc1
    buffer_load_dwordx4 v[84:87], v253, s[44:47], s63 offen offset:1024 sc1
    buffer_load_dwordx4 v[88:91], v253, s[44:47], s63 offen offset:2048 sc1
    buffer_load_dwordx4 v[92:95], v253, s[44:47], s63 offen offset:3072 sc1
    s_sub_u32 s57, s57, 1
    s_waitcnt vmcnt(0)
    s_cbranch_scc1 SGA5_r
    v_bitop3_b32 v4, v83, v87, v91 bitop3:0x80
    v_bitop3_b32 v4, v4, v95, 1 bitop3:0x80
    v_cmp_eq_u32 vcc, 0, v4
    s_cbranch_vccnz SGA5_l
    s_branch SGA5_r
B_I0:
    s_mov_b32 s57, 0x40000
B_WF:
    ds_read_b32 v13, v14
    s_sub_u32 s57, s57, 1
    s_waitcnt lgkmcnt(0)
    s_cbranch_scc1 B_WFX
    s_setprio 3
    v_cmp_ne_u32 vcc, 0, v13
    s_setprio 0
    s_cbranch_vccnz B_WFX
    s_sleep 8
    s_branch B_WF
B_WFX:
    s_branch B_J0
B_I13:
    s_branch B_J13
B_I15:
    s_branch B_J15
B_I17:
    s_branch B_J17
B_I19:
    s_branch B_J19
B_I20:
    s_branch B_J20
SIBg0_h:
    s_mov_b32 s57, 0x40000
    s_mov_b32 exec_hi, 0
SIBg0_l:
    s_and_b32 exec_lo, s6, 0x000000ff
    buffer_load_dword v13, v9, s[44:47], 0 offen sc1
    s_sub_u32 s57, s57, 1
    s_waitcnt vmcnt(0)
    s_cbranch_scc1 SIBg0_x
    v_and_b32 v13, 1, v13
    v_cmp_ne_u32 vcc, 0, v13
    s_nop 0
    s_andn2_b32 s6, s6, vcc_lo
    s_and_b32 s63, s6, 0x00000003
    s_cbranch_scc1 SIBg0_l
SIBg0_x:
    s_mov_b64 exec, -1
    s_branch SIBg0_r
SIBg1_h:
    s_mov_b32 s57, 0x40000
    s_mov_b32 exec_hi, 0
SIBg1_l:
    s_and_b32 exec_lo, s6, 0x000000ff
    buffer_load_dword v13, v9, s[44:47], 0 offen sc1
    s_sub_u32 s57, s57, 1
    s_waitcnt vmcnt(0)
    s_cbranch_scc1 SIBg1_x
    v_and_b32 v13, 1, v13
    v_cmp_ne_u32 vcc, 0, v13
    s_nop 0
    s_andn2_b32 s6, s6, vcc_lo
    s_and_b32 s63, s6, 0x0000000c
    s_cbranch_scc1 SIBg1_l
SIBg1_x:
    s_mov_b64 exec, -1
    s_branch SIBg1_r
SIBg2_h:
    s_mov_b32 s57, 0x40000
    s_mov_b32 exec_hi, 0
SIBg2_l:
    s_and_b32 exec_lo, s6, 0x000000ff
    buffer_load_dword v13, v9, s[44:47], 0 offen sc1
    s_sub_u32 s57, s57, 1
    s_waitcnt vmcnt(0)
    s_cbranch_scc1 SIBg2_x
    v_and_b32 v13, 1, v13
    v_cmp_ne_u32 vcc, 0, v13
    s_nop 0
    s_andn2_b32 s6, s6, vcc_lo
    s_and_b32 s63, s6, 0x00000030
    s_cbranch_scc1 SIBg2_l
SIBg2_x:
    s_mov_b64 exec, -1
    s_branch SIBg2_r
SIBg3_h:
    s_mov_b32 s57, 0x40000
    s_mov_b32 exec_hi, 0
SIBg3_l:
    s_and_b32 exec_lo, s6, 0x000000ff
    buffer_load_dword v13, v9, s[44:47], 0 offen sc1
    s_sub_u32 s57, s57, 1
    s_waitcnt vmcnt(0)
    s_cbranch_scc1 SIBg3_x
    v_and_b32 v13, 1, v13
    v_cmp_ne_u32 vcc, 0, v13
    s_nop 0
    s_andn2_b32 s6, s6, vcc_lo
    s_and_b32 s63, s6, 0x000000c0
    s_cbranch_scc1 SIBg3_l
SIBg3_x:
    s_mov_b64 exec, -1
    s_branch SIBg3_r
SHBg0_h:
    s_mov_b32 s57, 0x40000
    s_mov_b32 exec_hi, 0
SHBg0_l:
    s_and_b32 exec_lo, s6, 0x000003ff
    buffer_load_dword v13, v8, s[44:47], 0 offen sc1
    s_sub_u32 s57, s57, 1
    s_waitcnt vmcnt(0)
    s_cbranch_scc1 SHBg0_x
    v_and_b32 v13, s65, v13
    v_cmp_ne_u32 vcc, 0, v13
    s_nop 0
    s_andn2_b32 s6, s6, vcc_lo
    s_and_b32 s63, s6, 0x00000003
    s_cbranch_scc1 SHBg0_l
SHBg0_x:
    s_mov_b64 exec, -1
    s_branch SHBg0_r
SHBg1_h:
    s_mov_b32 s57, 0x40000
    s_mov_b32 exec_hi, 0
SHBg1_l:
    s_and_b32 exec_lo, s6, 0x000003ff
    buffer_load_dword v13, v8, s[44:47], 0 offen sc1
    s_sub_u32 s57, s57, 1
    s_waitcnt vmcnt(0)
    s_cbranch_scc1 SHBg1_x
    v_and_b32 v13, s65, v13
    v_cmp_ne_u32 vcc, 0, v13
    s_nop 0
    s_andn2_b32 s6, s6, vcc_lo
    s_and_b32 s63, s6, 0x0000000c
    s_cbranch_scc1 SHBg1_l
SHBg1_x:
    s_mov_b64 exec, -1
    s_branch SHBg1_r
SHBg2_h:
    s_mov_b32 s57, 0x40000
    s_mov_b32 exec_hi, 0
SHBg2_l:
    s_and_b32 exec_lo, s6, 0x000003ff
    buffer_load_dword v13, v8, s[44:47], 0 offen sc1
    s_sub_u32 s57, s57, 1
    s_waitcnt vmcnt(0)
    s_cbranch_scc1 SHBg2_x
    v_and_b32 v13, s65, v13
    v_cmp_ne_u32 vcc, 0, v13
    s_nop 0
    s_andn2_b32 s6, s6, vcc_lo
    s_and_b32 s63, s6, 0x00000030
    s_cbranch_scc1 SHBg2_l
SHBg2_x:
    s_mov_b64 exec, -1
    s_branch SHBg2_r
SHB0_h:
    s_mov_b32 s57, 0x40000
SHB0_l:
    s_add_u32 s63, s96, 12288
    s_and_b32 s63, s63, 0x7fff
    buffer_load_dwordx4 v[48:51], v4, s[44:47], s63 offen offset:0 sc1
    buffer_load_dwordx4 v[52:55], v4, s[44:47], s63 offen offset:1024 sc1
    buffer_load_dwordx4 v[56:59], v4, s[44:47], s63 offen offset:2048 sc1
    buffer_load_dwordx4 v[60:63], v4, s[44:47], s63 offen offset:3072 sc1
    s_sub_u32 s57, s57, 1
    s_waitcnt vmcnt(0)
    s_cbranch_scc1 SHB0_r
    v_bitop3_b32 v12, v51, v55, v59 bitop3:0x80
    v_bitop3_b32 v12, v12, v63, s65 bitop3:0x80
    v_cmp_eq_u32 vcc, 0, v12
    s_cbranch_vccnz SHB0_l
    s_branch SHB0_r
SHB1_h:
    s_mov_b32 s57, 0x40000
SHB1_l:
    s_add_u32 s63, s96, 16384
    s_and_b32 s63, s63, 0x7fff
    buffer_load_dwordx4 v[64:67], v4, s[44:47], s63 offen offset:0 sc1
    buffer_load_dwordx4 v[68:71], v4, s[44:47], s63 offen offset:1024 sc1
    buffer_load_dwordx4 v[72:75], v4, s[44:47], s63 offen offset:2048 sc1
    buffer_load_dwordx4 v[76:79], v4, s[44:47], s63 offen offset:3072 sc1
    s_sub_u32 s57, s57, 1
    s_waitcnt vmcnt(0)
    s_cbranch_scc1 SHB1_r
    v_bitop3_b32 v12, v67, v71, v75 bitop3:0x80
    v_bitop3_b32 v12, v12, v79, s65 bitop3:0x80
    v_cmp_eq_u32 vcc, 0, v12
    s_cbranch_vccnz SHB1_l
    s_branch SHB1_r
SHBg3_h:
    s_mov_b32 s57, 0x40000
    s_mov_b32 exec_hi, 0
SHBg3_l:
    s_and_b32 exec_lo, s6, 0x000003ff
    buffer_load_dword v13, v8, s[44:47], 0 offen sc1
    s_sub_u32 s57, s57, 1
    s_waitcnt vmcnt(0)
    s_cbranch_scc1 SHBg3_x
    v_and_b32 v13, s65, v13
    v_cmp_ne_u32 vcc, 0, v13
    s_nop 0
    s_andn2_b32 s6, s6, vcc_lo
    s_and_b32 s63, s6, 0x000000c0
    s_cbranch_scc1 SHBg3_l
SHBg3_x:
    s_mov_b64 exec, -1
    s_branch SHBg3_r
SHB2_h:
    s_mov_b32 s57, 0x40000
SHB2_l:
    s_add_u32 s63, s96, 20480
    s_and_b32 s63, s63, 0x7fff
    buffer_load_dwordx4 v[80:83], v4, s[44:47], s63 offen offset:0 sc1
    buffer_load_dwordx4 v[84:87], v4, s[44:47], s63 offen offset:1024 sc1
    buffer_load_dwordx4 v[88:91], v4, s[44:47], s63 offen offset:2048 sc1
    buffer_load_dwordx4 v[92:95], v4, s[44:47], s63 offen offset:3072 sc1
    s_sub_u32 s57, s57, 1
    s_waitcnt vmcnt(0)
    s_cbranch_scc1 SHB2_r
    v_bitop3_b32 v12, v83, v87, v91 bitop3:0x80
    v_bitop3_b32 v12, v12, v95, s65 bitop3:0x80
    v_cmp_eq_u32 vcc, 0, v12
    s_cbranch_vccnz SHB2_l
    s_branch SHB2_r
SHBg4_h:
    s_mov_b32 s57, 0x40000
    s_mov_b32 exec_hi, 0
SHBg4_l:
    s_and_b32 exec_lo, s6, 0x000003ff
    buffer_load_dword v13, v8, s[44:47], 0 offen sc1
    s_sub_u32 s57, s57, 1
    s_waitcnt vmcnt(0)
    s_cbranch_scc1 SHBg4_x
    v_and_b32 v13, s65, v13
    v_cmp_ne_u32 vcc, 0, v13
    s_nop 0
    s_andn2_b32 s6, s6, vcc_lo
    s_and_b32 s63, s6, 0x00000300
    s_cbranch_scc1 SHBg4_l
SHBg4_x:
    s_mov_b64 exec, -1
    s_branch SHBg4_r
SHB3_h:
    s_mov_b32 s57, 0x40000
SHB3_l:
    s_add_u32 s63, s96, 24576
    s_and_b32 s63, s63, 0x7fff
    buffer_load_dwordx4 v[48:51], v4, s[44:47], s63 offen offset:0 sc1
    buffer_load_dwordx4 v[52:55], v4, s[44:47], s63 offen offset:1024 sc1
    buffer_load_dwordx4 v[56:59], v4, s[44:47], s63 offen offset:2048 sc1
    buffer_load_dwordx4 v[60:63], v4, s[44:47], s63 offen offset:3072 sc1
    s_sub_u32 s57, s57, 1
    s_waitcnt vmcnt(0)
    s_cbranch_scc1 SHB3_r
    v_bitop3_b32 v12, v51, v55, v59 bitop3:0x80
    v_bitop3_b32 v12, v12, v63, s65 bitop3:0x80
    v_cmp_eq_u32 vcc, 0, v12
    s_cbranch_vccnz SHB3_l
    s_branch SHB3_r
SHB4_h:
    s_mov_b32 s57, 0x40000
SHB4_l:
    s_add_u32 s63, s96, 28672
    s_and_b32 s63, s63, 0x7fff
    buffer_load_dwordx4 v[64:67], v4, s[44:47], s63 offen offset:0 sc1
    buffer_load_dwordx4 v[68:71], v4, s[44:47], s63 offen offset:1024 sc1
    buffer_load_dwordx4 v[72:75], v4, s[44:47], s63 offen offset:2048 sc1
    buffer_load_dwordx4 v[76:79], v4, s[44:47], s63 offen offset:3072 sc1
    s_sub_u32 s57, s57, 1
    s_waitcnt vmcnt(0)
    s_cbranch_scc1 SHB4_r
    v_bitop3_b32 v12, v67, v71, v75 bitop3:0x80
    v_bitop3_b32 v12, v12, v79, s65 bitop3:0x80
    v_cmp_eq_u32 vcc, 0, v12
    s_cbranch_vccnz SHB4_l
    s_branch SHB4_r
SHB5_h:
    s_mov_b32 s57, 0x40000
SHB5_l:
    s_add_u32 s63, s96, 12288
    s_and_b32 s63, s63, 0x7fff
    s_bitset1_b32 s63, 17
    buffer_load_dwordx4 v[80:83], v4, s[44:47], s63 offen offset:0 sc1
    buffer_load_dwordx4 v[84:87], v4, s[44:47], s63 offen offset:1024 sc1
    buffer_load_dwordx4 v[88:91], v4, s[44:47], s63 offen offset:2048 sc1
    buffer_load_dwordx4 v[92:95], v4, s[44:47], s63 offen offset:3072 sc1
    s_sub_u32 s57, s57, 1
    s_waitcnt vmcnt(0)
    s_cbranch_scc1 SHB5_r
    v_bitop3_b32 v12, v83, v87, v91 bitop3:0x80
    v_bitop3_b32 v12, v12, v95, s65 bitop3:0x80
    v_cmp_eq_u32 vcc, 0, v12
    s_cbranch_vccnz SHB5_l
    s_branch SHB5_r
SHB6_h:
    s_mov_b32 s57, 0x40000
SHB6_l:
    s_add_u32 s63, s96, 16384
    s_and_b32 s63, s63, 0x7fff
    s_bitset1_b32 s63, 17
    buffer_load_dwordx4 v[48:51], v4, s[44:47], s63 offen offset:0 sc1
    buffer_load_dwordx4 v[52:55], v4, s[44:47], s63 offen offset:1024 sc1
    buffer_load_dwordx4 v[56:59], v4, s[44:47], s63 offen offset:2048 sc1
    buffer_load_dwordx4 v[60:63], v4, s[44:47], s63 offen offset:3072 sc1
    s_sub_u32 s57, s57, 1
    s_waitcnt vmcnt(0)
    s_cbranch_scc1 SHB6_r
    v_bitop3_b32 v12, v51, v55, v59 bitop3:0x80
    v_bitop3_b32 v12, v12, v63, s65 bitop3:0x80
    v_cmp_eq_u32 vcc, 0, v12
    s_cbranch_vccnz SHB6_l
    s_branch SHB6_r
SHB7_h:
    s_mov_b32 s57, 0x40000
SHB7_l:
    s_add_u32 s63, s96, 20480
    s_and_b32 s63, s63, 0x7fff
    s_bitset1_b32 s63, 17
    buffer_load_dwordx4 v[64:67], v4, s[44:47], s63 offen offset:0 sc1
    buffer_load_dwordx4 v[68:71], v4, s[44:47], s63 offen offset:1024 sc1
    buffer_load_dwordx4 v[72:75], v4, s[44:47], s63 offen offset:2048 sc1
    buffer_load_dwordx4 v[76:79], v4, s[44:47], s63 offen offset:3072 sc1
    s_sub_u32 s57, s57, 1
    s_waitcnt vmcnt(0)
    s_cbranch_scc1 SHB7_r
    v_bitop3_b32 v12, v67, v71, v75 bitop3:0x80
    v_bitop3_b32 v12, v12, v79, s65 bitop3:0x80
    v_cmp_eq_u32 vcc, 0, v12
    s_cbranch_vccnz SHB7_l
    s_branch SHB7_r
SHB8_h:
    s_mov_b32 s57, 0x40000
SHB8_l:
    s_add_u32 s63, s96, 24576
    s_and_b32 s63, s63, 0x7fff
    s_bitset1_b32 s63, 17
    buffer_load_dwordx4 v[80:83], v4, s[44:47], s63 offen offset:0 sc1
    buffer_load_dwordx4 v[84:87], v4, s[44:47], s63 offen offset:1024 sc1
    buffer_load_dwordx4 v[88:91], v4, s[44:47], s63 offen offset:2048 sc1
    buffer_load_dwordx4 v[92:95], v4, s[44:47], s63 offen offset:3072 sc1
    s_sub_u32 s57, s57, 1
    s_waitcnt vmcnt(0)
    s_cbranch_scc1 SHB8_r
    v_bitop3_b32 v12, v83, v87, v91 bitop3:0x80
    v_bitop3_b32 v12, v12, v95, s65 bitop3:0x80
    v_cmp_eq_u32 vcc, 0, v12
    s_cbranch_vccnz SHB8_l
    s_branch SHB8_r
SHB9_h:
    s_mov_b32 s57, 0x40000
SHB9_l:
    s_add_u32 s63, s96, 28672
    s_and_b32 s63, s63, 0x7fff
    s_bitset1_b32 s63, 17
    buffer_load_dwordx4 v[48:51], v4, s[44:47], s63 offen offset:0 sc1
    buffer_load_dwordx4 v[52:55], v4, s[44:47], s63 offen offset:1024 sc1
    buffer_load_dwordx4 v[56:59], v4, s[44:47], s63 offen offset:2048 sc1
    buffer_load_dwordx4 v[60:63], v4, s[44:47], s63 offen offset:3072 sc1
    s_sub_u32 s57, s57, 1
    s_waitcnt vmcnt(0)
    s_cbranch_scc1 SHB9_r
    v_bitop3_b32 v12, v51, v55, v59 bitop3:0x80
    v_bitop3_b32 v12, v12, v63, s65 bitop3:0x80
    v_cmp_eq_u32 vcc, 0, v12
    s_cbranch_vccnz SHB9_l
    s_branch SHB9_r
SGB0_h:
    s_mov_b32 s57, 0x40000
SGB0_l:
    s_add_u32 s63, s97, 12288
    s_sub_u32 s64, s63, 28672
    s_min_u32 s63, s63, s64
    buffer_load_dwordx4 v[64:67], v5, s[44:47], s63 offen offset:0 sc1
    buffer_load_dwordx4 v[68:71], v5, s[44:47], s63 offen offset:1024 sc1
    buffer_load_dwordx4 v[72:75], v5, s[44:47], s63 offen offset:2048 sc1
    buffer_load_dwordx4 v[76:79], v5, s[44:47], s63 offen offset:3072 sc1
    s_sub_u32 s57, s57, 1
    s_waitcnt vmcnt(0)
    s_cbranch_scc1 SGB0_r
    v_bitop3_b32 v12, v67, v71, v75 bitop3:0x80
    v_bitop3_b32 v12, v12, v79, 1 bitop3:0x80
    v_cmp_eq_u32 vcc, 0, v12
    s_cbranch_vccnz SGB0_l
    s_branch SGB0_r
SGB1_h:
    s_mov_b32 s57, 0x40000
SGB1_l:
    s_add_u32 s63, s97, 16384
    s_sub_u32 s64, s63, 28672
    s_min_u32 s63, s63, s64
    buffer_load_dwordx4 v[80:83], v5, s[44:47], s63 offen offset:0 sc1
    buffer_load_dwordx4 v[84:87], v5, s[44:47], s63 offen offset:1024 sc1
    buffer_load_dwordx4 v[88:91], v5, s[44:47], s63 offen offset:2048 sc1
    buffer_load_dwordx4 v[92:95], v5, s[44:47], s63 offen offset:3072 sc1
    s_sub_u32 s57, s57, 1
    s_waitcnt vmcnt(0)
    s_cbranch_scc1 SGB1_r
    v_bitop3_b32 v12, v83, v87, v91 bitop3:0x80
    v_bitop3_b32 v12, v12, v95, 1 bitop3:0x80
    v_cmp_eq_u32 vcc, 0, v12
    s_cbranch_vccnz SGB1_l
    s_branch SGB1_r
SGB2_h:
    s_mov_b32 s57, 0x40000
SGB2_l:
    s_add_u32 s63, s97, 20480
    s_sub_u32 s64, s63, 28672
    s_min_u32 s63, s63, s64
    buffer_load_dwordx4 v[48:51], v5, s[44:47], s63 offen offset:0 sc1
    buffer_load_dwordx4 v[52:55], v5, s[44:47], s63 offen offset:1024 sc1
    buffer_load_dwordx4 v[56:59], v5, s[44:47], s63 offen offset:2048 sc1
    buffer_load_dwordx4 v[60:63], v5, s[44:47], s63 offen offset:3072 sc1
    s_sub_u32 s57, s57, 1
    s_waitcnt vmcnt(0)
    s_cbranch_scc1 SGB2_r
    v_bitop3_b32 v12, v51, v55, v59 bitop3:0x80
    v_bitop3_b32 v12, v12, v63, 1 bitop3:0x80
    v_cmp_eq_u32 vcc, 0, v12
    s_cbranch_vccnz SGB2_l
    s_branch SGB2_r
SGB3_h:
    s_mov_b32 s57, 0x40000
SGB3_l:
    s_add_u32 s63, s97, 24576
    s_sub_u32 s64, s63, 28672
    s_min_u32 s63, s63, s64
    buffer_load_dwordx4 v[64:67], v5, s[44:47], s63 offen offset:0 sc1
    buffer_load_dwordx4 v[68:71], v5, s[44:47], s63 offen offset:1024 sc1
    buffer_load_dwordx4 v[72:75], v5, s[44:47], s63 offen offset:2048 sc1
    buffer_load_dwordx4 v[76:79], v5, s[44:47], s63 offen offset:3072 sc1
    s_sub_u32 s57, s57, 1
    s_waitcnt vmcnt(0)
    s_cbranch_scc1 SGB3_r
    v_bitop3_b32 v12, v67, v71, v75 bitop3:0x80
    v_bitop3_b32 v12, v12, v79, 1 bitop3:0x80
    v_cmp_eq_u32 vcc, 0, v12
    s_cbranch_vccnz SGB3_l
    s_branch SGB3_r
SGB4_h:
    s_mov_b32 s57, 0x40000
SGB4_l:
    s_add_u32 s63, s97, 12288
    s_sub_u32 s64, s63, 28672
    s_min_u32 s63, s63, s64
    s_add_u32 s63, s63, 114688
    buffer_load_dwordx4 v[80:83], v5, s[44:47], s63 offen offset:0 sc1
    buffer_load_dwordx4 v[84:87], v5, s[44:47], s63 offen offset:1024 sc1
    buffer_load_dwordx4 v[88:91], v5, s[44:47], s63 offen offset:2048 sc1
    buffer_load_dwordx4 v[92:95], v5, s[44:47], s63 offen offset:3072 sc1
    s_sub_u32 s57, s57, 1
    s_waitcnt vmcnt(0)
    s_cbranch_scc1 SGB4_r
    v_bitop3_b32 v12, v83, v87, v91 bitop3:0x80
    v_bitop3_b32 v12, v12, v95, 1 bitop3:0x80
    v_cmp_eq_u32 vcc, 0, v12
    s_cbranch_vccnz SGB4_l
    s_branch SGB4_r
SGB5_h:
    s_mov_b32 s57, 0x40000
SGB5_l:
    s_add_u32 s63, s97, 16384
    s_sub_u32 s64, s63, 28672
    s_min_u32 s63, s63, s64
    s_add_u32 s63, s63, 114688
    buffer_load_dwordx4 v[48:51], v5, s[44:47], s63 offen offset:0 sc1
    buffer_load_dwordx4 v[52:55], v5, s[44:47], s63 offen offset:1024 sc1
    buffer_load_dwordx4 v[56:59], v5, s[44:47], s63 offen offset:2048 sc1
    buffer_load_dwordx4 v[60:63], v5, s[44:47], s63 offen offset:3072 sc1
    s_sub_u32 s57, s57, 1
    s_waitcnt vmcnt(0)
    s_cbranch_scc1 SGB5_r
    v_bitop3_b32 v12, v51, v55, v59 bitop3:0x80
    v_bitop3_b32 v12, v12, v63, 1 bitop3:0x80
    v_cmp_eq_u32 vcc, 0, v12
    s_cbranch_vccnz SGB5_l
    s_branch SGB5_r
SGB6_h:
    s_mov_b32 s57, 0x40000
SGB6_l:
    s_add_u32 s63, s97, 20480
    s_sub_u32 s64, s63, 28672
    s_min_u32 s63, s63, s64
    s_add_u32 s63, s63, 114688
    buffer_load_dwordx4 v[64:67], v5, s[44:47], s63 offen offset:0 sc1
    buffer_load_dwordx4 v[68:71], v5, s[44:47], s63 offen offset:1024 sc1
    buffer_load_dwordx4 v[72:75], v5, s[44:47], s63 offen offset:2048 sc1
    buffer_load_dwordx4 v[76:79], v5, s[44:47], s63 offen offset:3072 sc1
    s_sub_u32 s57, s57, 1
    s_waitcnt vmcnt(0)
    s_cbranch_scc1 SGB6_r
    v_bitop3_b32 v12, v67, v71, v75 bitop3:0x80
    v_bitop3_b32 v12, v12, v79, 1 bitop3:0x80
    v_cmp_eq_u32 vcc, 0, v12
    s_cbranch_vccnz SGB6_l
    s_branch SGB6_r
SGB7_h:
    s_mov_b32 s57, 0x40000
SGB7_l:
    s_add_u32 s63, s97, 24576
    s_sub_u32 s64, s63, 28672
    s_min_u32 s63, s63, s64
    s_add_u32 s63, s63, 114688
    buffer_load_dwordx4 v[80:83], v5, s[44:47], s63 offen offset:0 sc1
    buffer_load_dwordx4 v[84:87], v5, s[44:47], s63 offen offset:1024 sc1
    buffer_load_dwordx4 v[88:91], v5, s[44:47], s63 offen offset:2048 sc1
    buffer_load_dwordx4 v[92:95], v5, s[44:47], s63 offen offset:3072 sc1
    s_sub_u32 s57, s57, 1
    s_waitcnt vmcnt(0)
    s_cbranch_scc1 SGB7_r
    v_bitop3_b32 v12, v83, v87, v91 bitop3:0x80
    v_bitop3_b32 v12, v12, v95, 1 bitop3:0x80
    v_cmp_eq_u32 vcc, 0, v12
    s_cbranch_vccnz SGB7_l
    s_branch SGB7_r
CODE_END:
.section .rodata,"a"
.p2align 6
.amdhsa_kernel sequential_preLN__mha_block__mixer_token_mlp__prompt_kernel
  .amdhsa_next_free_vgpr 256
  .amdhsa_next_free_sgpr 102
  .amdhsa_accum_offset 256
  .amdhsa_group_segment_fixed_size 0
  .amdhsa_kernarg_size 88
  .amdhsa_user_sgpr_count 2
  .amdhsa_user_sgpr_kernarg_segment_ptr 1
  .amdhsa_system_sgpr_workgroup_id_x 1
.end_amdhsa_kernel
```
